```python
import torch

def _softmax(x, axis=-1):
    return torch.softmax(x, dim=axis)
def _gelu(x):
    return torch.nn.functional.gelu(x, approximate="tanh")
def _silu(x):
    return torch.nn.functional.silu(x)
def _sigmoid(x):
    return torch.sigmoid(x)
def _layernorm(x, axis=-1, eps=1e-5):
    m = x.mean(dim=axis, keepdim=True)
    v = x.var(dim=axis, keepdim=True, unbiased=False)
    return (x - m) / torch.sqrt(v + eps)
def _scatter_add(tgt, idx, src, axis=0):
    return tgt.clone().index_add_(axis, idx, src)
def _segment_sum(src, seg, n):
    out = torch.zeros((n,) + src.shape[1:], dtype=src.dtype)
    return out.index_add_(0, seg, src)
def _pad(x, pw):
    flat = tuple(v for pair in reversed(pw) for v in pair)
    return torch.nn.functional.pad(x, flat)

kernel_name = 'parallel_sum__ssm_conv_s4__dense_activation_mish__prompt'

def setup_inputs():

    _w = (lambda a: (lambda t: t.to(torch.bfloat16) if t.is_floating_point() else t)(torch.as_tensor(a)))
    def _A_setup():
        B, L, D, N = 1, 2048, 576, 128
        A_re = -(lambda _x: torch.exp(torch.as_tensor(_x)))((lambda *s: torch.randn(*s, dtype=torch.bfloat16) * 6.4)(D, N))
        A_im = torch.pi * (lambda *s: torch.randn(*s, dtype=torch.bfloat16) * 0.05)(D, N)
        B_re = (lambda *s: torch.randn(*s, dtype=torch.bfloat16) * 0.1)(D, N)
        B_im = (lambda *s: torch.randn(*s, dtype=torch.bfloat16) * 0.1)(D, N)
        C_re = (lambda *s: torch.randn(*s, dtype=torch.bfloat16) * 0.1)(D, N)
        C_im = (lambda *s: torch.randn(*s, dtype=torch.bfloat16) * 0.1)(D, N)
        log_dt = (lambda *s: torch.randn(*s, dtype=torch.bfloat16) * 0.05)(D) * 0.5 - 4.0
        Dskip = (lambda *s: torch.randn(*s, dtype=torch.bfloat16) * 0.05)(D)
        return {
            "u": _w((lambda *s: torch.randn(*s, dtype=torch.bfloat16) * 0.05)(B, L, D)),
            "A_re": _w(A_re),
            "A_im": _w(A_im),
            "B_re": _w(B_re),
            "B_im": _w(B_im),
            "C_re": _w(C_re),
            "C_im": _w(C_im),
            "log_dt": _w(log_dt),
            "Dskip": _w(Dskip),
        }
    _A_in = _A_setup()

    def _B_setup():
        B, S, D, F = 1, 2048, 576, 4608
        return {
            "x": _w((lambda *s: torch.randn(*s, dtype=torch.bfloat16) * 0.05)(B, S, D)),
            "w1": _w((lambda *s: torch.randn(*s, dtype=torch.bfloat16) * 0.8)(D, F) * (D ** -0.5)),
            "b1": _w((lambda *s: torch.randn(*s, dtype=torch.bfloat16) * 0.2)(F)),
            "w2": _w((lambda *s: torch.randn(*s, dtype=torch.bfloat16) * 0.2)(F, D) * (F ** -0.5)),
        }
    _B_in = _B_setup()

    return {
        "A_u": _A_in["u"],
        "A_A_re": _A_in["A_re"],
        "A_A_im": _A_in["A_im"],
        "A_B_re": _A_in["B_re"],
        "A_B_im": _A_in["B_im"],
        "A_C_re": _A_in["C_re"],
        "A_C_im": _A_in["C_im"],
        "A_log_dt": _A_in["log_dt"],
        "A_Dskip": _A_in["Dskip"],
        "B_x": _B_in["x"],
        "B_w1": _B_in["w1"],
        "B_b1": _B_in["b1"],
        "B_w2": _B_in["w2"],
    }

def reference(A_u, A_A_re, A_A_im, A_B_re, A_B_im, A_C_re, A_C_im, A_log_dt, A_Dskip, B_x, B_w1, B_b1, B_w2):
    def _A_ref(u, A_re, A_im, B_re, B_im, C_re, C_im, log_dt, Dskip):
        Bsz, L, D = u.shape
        dt = torch.exp(log_dt)[:, None]
        A = A_re + 1j * A_im
        Bc = B_re + 1j * B_im
        Cc = C_re + 1j * C_im
        logdA = dt * A
        dB = dt * Bc
        l = (lambda x, dt: x.to(dt))(torch.arange(L), A_re.dtype)
        P = torch.exp(logdA[:, :, None] * l[None, None, :])
        K = torch.einsum("dn,dnl,dn->dl", Cc, P, dB).real
        L2 = 2 * L
        Kp = _pad(K, ((0, 0), (0, L)))
        up = (lambda x, *d: x.permute(*d))(u, 0, 2, 1)
        up = _pad(up, ((0, 0), (0, 0), (0, L)))
        Kf = (lambda x, axes=(-2,-1): torch.fft.rfft2(x.float(), dim=axes))(Kp[:, None, :], axes=(-2, -1))
        Uf = (lambda x, axes=(-2,-1): torch.fft.rfft2(x.float(), dim=axes))(up[:, :, None, :], axes=(-2, -1))
        Yf = Uf * Kf[None, :, :, :]
        y = (lambda x, s, axes=(-2,-1): torch.fft.irfft2(x, s=s, dim=axes).to(torch.bfloat16))(Yf, (1, L2), axes=(-2, -1))[:, :, 0, :L]
        y = (lambda x, *d: x.permute(*d))(y, 0, 2, 1) + u * Dskip[None, None, :]
        return y

    def _B_ref(x, w1, b1, w2):
        h = torch.einsum("bsd,df->bsf", x, w1) + b1
        sp = torch.log1p(torch.exp(-torch.abs(h))) + torch.where(h > 0, h, torch.zeros_like(h))
        act = h * torch.tanh(sp)
        return torch.einsum("bsf,fd->bsd", act, w2)

    x = A_u
    xn = _layernorm(x, axis=-1)
    return x + _A_ref(xn, A_A_re, A_A_im, A_B_re, A_B_im, A_C_re, A_C_im, A_log_dt, A_Dskip) + _B_ref(xn, B_w1, B_b1, B_w2)
```

```asm
; @launch kernel=k1_kernel grid=(2147,1,1) block=(256,1,1) lds=18432
; @launch kernel=k2f_kernel grid=(256,1,1) block=(256,1,1) lds=157184
; @launch kernel=k3c_kernel grid=(1024,1,1) block=(256,1,1) lds=40960
.amdgcn_target "amdgcn-amd-amdhsa--gfx950"
.text
.globl k1_kernel
.p2align 8
.type k1_kernel,@function
k1_kernel:
    s_cmp_lg_u32 s2, 0
    s_cbranch_scc1 STK0
    s_load_dwordx2 s[96:97], s[0:1], 120
    s_memrealtime s[98:99]
    s_waitcnt lgkmcnt(0)
    v_mov_b32 v1, 130433072
    v_mov_b32 v2, s98
    global_store_dword v1, v2, s[96:97]
STK0:
    s_load_dwordx2 s[4:5], s[0:1], 120
    s_mov_b32 s90, 0x7fff
    s_cmp_lt_u32 s2, 576
    s_cbranch_scc1 K1_KGEN
    s_sub_u32 s2, s2, 576
    s_cmp_ge_u32 s2, 1571
    s_cbranch_scc1 K1_END
    s_cmp_ge_u32 s2, 275
    s_cbranch_scc1 K1_TR
    s_cmp_ge_u32 s2, 256
    s_cbranch_scc1 K1_TAB
    s_load_dwordx2 s[6:7], s[0:1], 0
    s_waitcnt lgkmcnt(0)
    s_add_u32 s8, s6, 0
    s_addc_u32 s9, s7, 0
    s_and_b32 s9, s9, 0xffff
    s_mov_b32 s10, 2359296
    s_mov_b32 s11, 0x00020000
    s_add_u32 s12, s4, 0
    s_addc_u32 s13, s5, 0
    s_and_b32 s13, s13, 0xffff
    s_mov_b32 s14, 2359296
    s_mov_b32 s15, 0x00020000
    s_add_u32 s16, s4, 150673408
    s_addc_u32 s17, s5, 0
    s_and_b32 s17, s17, 0xffff
    s_mov_b32 s18, 2949120
    s_mov_b32 s19, 0x00020000
    v_lshrrev_b32 v1, 6, v0
    v_and_b32 v2, 63, v0
    s_mul_i32 s20, s2, 9216
    v_mul_u32_u24 v4, 2304, v1
    v_lshl_add_u32 v4, v2, 2, v4
    v_cmp_gt_u32 s[22:23], 32, v2
    buffer_load_dword v8, v4, s[8:11], s20 offen offset:0
    buffer_load_dword v9, v4, s[8:11], s20 offen offset:256
    buffer_load_dword v10, v4, s[8:11], s20 offen offset:512
    buffer_load_dword v11, v4, s[8:11], s20 offen offset:768
    v_mov_b32 v12, 0
    buffer_load_dword v13, v4, s[8:11], s20 offen offset:1152
    buffer_load_dword v14, v4, s[8:11], s20 offen offset:1408
    buffer_load_dword v15, v4, s[8:11], s20 offen offset:1664
    buffer_load_dword v16, v4, s[8:11], s20 offen offset:1920
    v_mov_b32 v17, 0
    s_mov_b64 s[24:25], exec
    s_mov_b64 exec, s[22:23]
    buffer_load_dword v12, v4, s[8:11], s20 offen offset:1024
    buffer_load_dword v17, v4, s[8:11], s20 offen offset:2176
    s_mov_b64 exec, s[24:25]
    s_waitcnt vmcnt(0)
    v_lshlrev_b32 v18, 16, v8
    v_and_b32 v19, 0xffff0000, v8
    v_lshlrev_b32 v20, 16, v9
    v_and_b32 v21, 0xffff0000, v9
    v_lshlrev_b32 v22, 16, v10
    v_and_b32 v23, 0xffff0000, v10
    v_lshlrev_b32 v24, 16, v11
    v_and_b32 v25, 0xffff0000, v11
    v_lshlrev_b32 v26, 16, v12
    v_and_b32 v27, 0xffff0000, v12
    v_lshlrev_b32 v28, 16, v13
    v_and_b32 v29, 0xffff0000, v13
    v_lshlrev_b32 v30, 16, v14
    v_and_b32 v31, 0xffff0000, v14
    v_lshlrev_b32 v32, 16, v15
    v_and_b32 v33, 0xffff0000, v15
    v_lshlrev_b32 v34, 16, v16
    v_and_b32 v35, 0xffff0000, v16
    v_lshlrev_b32 v36, 16, v17
    v_and_b32 v37, 0xffff0000, v17
    v_add_f32 v38, v18, v19
    v_add_f32 v38, v38, v20
    v_add_f32 v38, v38, v21
    v_add_f32 v38, v38, v22
    v_add_f32 v38, v38, v23
    v_add_f32 v38, v38, v24
    v_add_f32 v38, v38, v25
    v_add_f32 v38, v38, v26
    v_add_f32 v38, v38, v27
    v_add_f32 v39, v28, v29
    v_add_f32 v39, v39, v30
    v_add_f32 v39, v39, v31
    v_add_f32 v39, v39, v32
    v_add_f32 v39, v39, v33
    v_add_f32 v39, v39, v34
    v_add_f32 v39, v39, v35
    v_add_f32 v39, v39, v36
    v_add_f32 v39, v39, v37
    s_nop 1
    v_add_f32_dpp v38, v38, v38 row_shr:1 row_mask:0xf bank_mask:0xf bound_ctrl:0
    v_add_f32_dpp v39, v39, v39 row_shr:1 row_mask:0xf bank_mask:0xf bound_ctrl:0
    s_nop 1
    v_add_f32_dpp v38, v38, v38 row_shr:2 row_mask:0xf bank_mask:0xf bound_ctrl:0
    v_add_f32_dpp v39, v39, v39 row_shr:2 row_mask:0xf bank_mask:0xf bound_ctrl:0
    s_nop 1
    v_add_f32_dpp v38, v38, v38 row_shr:4 row_mask:0xf bank_mask:0xf bound_ctrl:0
    v_add_f32_dpp v39, v39, v39 row_shr:4 row_mask:0xf bank_mask:0xf bound_ctrl:0
    s_nop 1
    v_add_f32_dpp v38, v38, v38 row_shr:8 row_mask:0xf bank_mask:0xf bound_ctrl:0
    v_add_f32_dpp v39, v39, v39 row_shr:8 row_mask:0xf bank_mask:0xf bound_ctrl:0
    s_nop 1
    v_add_f32_dpp v38, v38, v38 row_bcast:15 row_mask:0xa bank_mask:0xf bound_ctrl:0
    v_add_f32_dpp v39, v39, v39 row_bcast:15 row_mask:0xa bank_mask:0xf bound_ctrl:0
    s_nop 1
    v_add_f32_dpp v38, v38, v38 row_bcast:31 row_mask:0xc bank_mask:0xf bound_ctrl:0
    v_add_f32_dpp v39, v39, v39 row_bcast:31 row_mask:0xc bank_mask:0xf bound_ctrl:0
    s_nop 1
    v_readlane_b32 s40, v38, 63
    v_readlane_b32 s41, v39, 63
    v_mov_b32 v38, s40
    v_mov_b32 v39, s41
    s_mov_b32 s26, 0x3ae38e39
    v_mul_f32 v38, s26, v38
    v_mul_f32 v39, s26, v39
    v_mov_b32 v40, 0
    v_sub_f32 v7, v18, v38
    v_fmac_f32 v40, v7, v7
    v_sub_f32 v7, v19, v38
    v_fmac_f32 v40, v7, v7
    v_sub_f32 v7, v20, v38
    v_fmac_f32 v40, v7, v7
    v_sub_f32 v7, v21, v38
    v_fmac_f32 v40, v7, v7
    v_sub_f32 v7, v22, v38
    v_fmac_f32 v40, v7, v7
    v_sub_f32 v7, v23, v38
    v_fmac_f32 v40, v7, v7
    v_sub_f32 v7, v24, v38
    v_fmac_f32 v40, v7, v7
    v_sub_f32 v7, v25, v38
    v_fmac_f32 v40, v7, v7
    v_sub_f32 v7, v26, v38
    v_cndmask_b32 v7, 0, v7, s[22:23]
    v_fmac_f32 v40, v7, v7
    v_sub_f32 v7, v27, v38
    v_cndmask_b32 v7, 0, v7, s[22:23]
    v_fmac_f32 v40, v7, v7
    v_mov_b32 v41, 0
    v_sub_f32 v7, v28, v39
    v_fmac_f32 v41, v7, v7
    v_sub_f32 v7, v29, v39
    v_fmac_f32 v41, v7, v7
    v_sub_f32 v7, v30, v39
    v_fmac_f32 v41, v7, v7
    v_sub_f32 v7, v31, v39
    v_fmac_f32 v41, v7, v7
    v_sub_f32 v7, v32, v39
    v_fmac_f32 v41, v7, v7
    v_sub_f32 v7, v33, v39
    v_fmac_f32 v41, v7, v7
    v_sub_f32 v7, v34, v39
    v_fmac_f32 v41, v7, v7
    v_sub_f32 v7, v35, v39
    v_fmac_f32 v41, v7, v7
    v_sub_f32 v7, v36, v39
    v_cndmask_b32 v7, 0, v7, s[22:23]
    v_fmac_f32 v41, v7, v7
    v_sub_f32 v7, v37, v39
    v_cndmask_b32 v7, 0, v7, s[22:23]
    v_fmac_f32 v41, v7, v7
    s_nop 1
    v_add_f32_dpp v40, v40, v40 row_shr:1 row_mask:0xf bank_mask:0xf bound_ctrl:0
    v_add_f32_dpp v41, v41, v41 row_shr:1 row_mask:0xf bank_mask:0xf bound_ctrl:0
    s_nop 1
    v_add_f32_dpp v40, v40, v40 row_shr:2 row_mask:0xf bank_mask:0xf bound_ctrl:0
    v_add_f32_dpp v41, v41, v41 row_shr:2 row_mask:0xf bank_mask:0xf bound_ctrl:0
    s_nop 1
    v_add_f32_dpp v40, v40, v40 row_shr:4 row_mask:0xf bank_mask:0xf bound_ctrl:0
    v_add_f32_dpp v41, v41, v41 row_shr:4 row_mask:0xf bank_mask:0xf bound_ctrl:0
    s_nop 1
    v_add_f32_dpp v40, v40, v40 row_shr:8 row_mask:0xf bank_mask:0xf bound_ctrl:0
    v_add_f32_dpp v41, v41, v41 row_shr:8 row_mask:0xf bank_mask:0xf bound_ctrl:0
    s_nop 1
    v_add_f32_dpp v40, v40, v40 row_bcast:15 row_mask:0xa bank_mask:0xf bound_ctrl:0
    v_add_f32_dpp v41, v41, v41 row_bcast:15 row_mask:0xa bank_mask:0xf bound_ctrl:0
    s_nop 1
    v_add_f32_dpp v40, v40, v40 row_bcast:31 row_mask:0xc bank_mask:0xf bound_ctrl:0
    v_add_f32_dpp v41, v41, v41 row_bcast:31 row_mask:0xc bank_mask:0xf bound_ctrl:0
    s_nop 1
    v_readlane_b32 s40, v40, 63
    v_readlane_b32 s41, v41, 63
    v_mov_b32 v40, s40
    v_mov_b32 v41, s41
    v_mul_f32 v40, s26, v40
    v_bfe_u32 v7, v38, 16, 1
    v_add3_u32 v7, v38, v7, s90
    v_and_b32 v38, 0xffff0000, v7
    v_bfe_u32 v7, v40, 16, 1
    v_add3_u32 v7, v40, v7, s90
    v_and_b32 v40, 0xffff0000, v7
    v_add_f32 v40, 0x3727c5ac, v40
    v_bfe_u32 v7, v40, 16, 1
    v_add3_u32 v7, v40, v7, s90
    v_and_b32 v40, 0xffff0000, v7
    v_sqrt_f32 v40, v40
    s_nop 0
    v_bfe_u32 v7, v40, 16, 1
    v_add3_u32 v7, v40, v7, s90
    v_and_b32 v40, 0xffff0000, v7
    v_rcp_f32 v42, v40
    s_nop 0
    v_mul_f32 v41, s26, v41
    v_bfe_u32 v7, v39, 16, 1
    v_add3_u32 v7, v39, v7, s90
    v_and_b32 v39, 0xffff0000, v7
    v_bfe_u32 v7, v41, 16, 1
    v_add3_u32 v7, v41, v7, s90
    v_and_b32 v41, 0xffff0000, v7
    v_add_f32 v41, 0x3727c5ac, v41
    v_bfe_u32 v7, v41, 16, 1
    v_add3_u32 v7, v41, v7, s90
    v_and_b32 v41, 0xffff0000, v7
    v_sqrt_f32 v41, v41
    s_nop 0
    v_bfe_u32 v7, v41, 16, 1
    v_add3_u32 v7, v41, v7, s90
    v_and_b32 v41, 0xffff0000, v7
    v_rcp_f32 v43, v41
    s_nop 0
    v_mul_u32_u24 v5, 2336, v1
    v_lshl_add_u32 v5, v2, 2, v5
    v_sub_f32 v18, v18, v38
    v_bfe_u32 v7, v18, 16, 1
    v_add3_u32 v7, v18, v7, s90
    v_and_b32 v18, 0xffff0000, v7
    v_mul_f32 v7, v18, v42
    v_fma_f32 v18, -v7, v40, v18
    v_fma_f32 v18, v18, v42, v7
    v_sub_f32 v19, v19, v38
    v_bfe_u32 v7, v19, 16, 1
    v_add3_u32 v7, v19, v7, s90
    v_and_b32 v19, 0xffff0000, v7
    v_mul_f32 v7, v19, v42
    v_fma_f32 v19, -v7, v40, v19
    v_fma_f32 v19, v19, v42, v7
    v_sub_f32 v20, v20, v38
    v_bfe_u32 v7, v20, 16, 1
    v_add3_u32 v7, v20, v7, s90
    v_and_b32 v20, 0xffff0000, v7
    v_mul_f32 v7, v20, v42
    v_fma_f32 v20, -v7, v40, v20
    v_fma_f32 v20, v20, v42, v7
    v_sub_f32 v21, v21, v38
    v_bfe_u32 v7, v21, 16, 1
    v_add3_u32 v7, v21, v7, s90
    v_and_b32 v21, 0xffff0000, v7
    v_mul_f32 v7, v21, v42
    v_fma_f32 v21, -v7, v40, v21
    v_fma_f32 v21, v21, v42, v7
    v_sub_f32 v22, v22, v38
    v_bfe_u32 v7, v22, 16, 1
    v_add3_u32 v7, v22, v7, s90
    v_and_b32 v22, 0xffff0000, v7
    v_mul_f32 v7, v22, v42
    v_fma_f32 v22, -v7, v40, v22
    v_fma_f32 v22, v22, v42, v7
    v_sub_f32 v23, v23, v38
    v_bfe_u32 v7, v23, 16, 1
    v_add3_u32 v7, v23, v7, s90
    v_and_b32 v23, 0xffff0000, v7
    v_mul_f32 v7, v23, v42
    v_fma_f32 v23, -v7, v40, v23
    v_fma_f32 v23, v23, v42, v7
    v_sub_f32 v24, v24, v38
    v_bfe_u32 v7, v24, 16, 1
    v_add3_u32 v7, v24, v7, s90
    v_and_b32 v24, 0xffff0000, v7
    v_mul_f32 v7, v24, v42
    v_fma_f32 v24, -v7, v40, v24
    v_fma_f32 v24, v24, v42, v7
    v_sub_f32 v25, v25, v38
    v_bfe_u32 v7, v25, 16, 1
    v_add3_u32 v7, v25, v7, s90
    v_and_b32 v25, 0xffff0000, v7
    v_mul_f32 v7, v25, v42
    v_fma_f32 v25, -v7, v40, v25
    v_fma_f32 v25, v25, v42, v7
    v_sub_f32 v26, v26, v38
    v_bfe_u32 v7, v26, 16, 1
    v_add3_u32 v7, v26, v7, s90
    v_and_b32 v26, 0xffff0000, v7
    v_mul_f32 v7, v26, v42
    v_fma_f32 v26, -v7, v40, v26
    v_fma_f32 v26, v26, v42, v7
    v_sub_f32 v27, v27, v38
    v_bfe_u32 v7, v27, 16, 1
    v_add3_u32 v7, v27, v7, s90
    v_and_b32 v27, 0xffff0000, v7
    v_mul_f32 v7, v27, v42
    v_fma_f32 v27, -v7, v40, v27
    v_fma_f32 v27, v27, v42, v7
    v_cvt_pk_bf16_f32 v8, v18, v19
    v_cvt_pk_bf16_f32 v9, v20, v21
    v_cvt_pk_bf16_f32 v10, v22, v23
    v_cvt_pk_bf16_f32 v11, v24, v25
    v_cvt_pk_bf16_f32 v12, v26, v27
    v_sub_f32 v28, v28, v39
    v_bfe_u32 v7, v28, 16, 1
    v_add3_u32 v7, v28, v7, s90
    v_and_b32 v28, 0xffff0000, v7
    v_mul_f32 v7, v28, v43
    v_fma_f32 v28, -v7, v41, v28
    v_fma_f32 v28, v28, v43, v7
    v_sub_f32 v29, v29, v39
    v_bfe_u32 v7, v29, 16, 1
    v_add3_u32 v7, v29, v7, s90
    v_and_b32 v29, 0xffff0000, v7
    v_mul_f32 v7, v29, v43
    v_fma_f32 v29, -v7, v41, v29
    v_fma_f32 v29, v29, v43, v7
    v_sub_f32 v30, v30, v39
    v_bfe_u32 v7, v30, 16, 1
    v_add3_u32 v7, v30, v7, s90
    v_and_b32 v30, 0xffff0000, v7
    v_mul_f32 v7, v30, v43
    v_fma_f32 v30, -v7, v41, v30
    v_fma_f32 v30, v30, v43, v7
    v_sub_f32 v31, v31, v39
    v_bfe_u32 v7, v31, 16, 1
    v_add3_u32 v7, v31, v7, s90
    v_and_b32 v31, 0xffff0000, v7
    v_mul_f32 v7, v31, v43
    v_fma_f32 v31, -v7, v41, v31
    v_fma_f32 v31, v31, v43, v7
    v_sub_f32 v32, v32, v39
    v_bfe_u32 v7, v32, 16, 1
    v_add3_u32 v7, v32, v7, s90
    v_and_b32 v32, 0xffff0000, v7
    v_mul_f32 v7, v32, v43
    v_fma_f32 v32, -v7, v41, v32
    v_fma_f32 v32, v32, v43, v7
    v_sub_f32 v33, v33, v39
    v_bfe_u32 v7, v33, 16, 1
    v_add3_u32 v7, v33, v7, s90
    v_and_b32 v33, 0xffff0000, v7
    v_mul_f32 v7, v33, v43
    v_fma_f32 v33, -v7, v41, v33
    v_fma_f32 v33, v33, v43, v7
    v_sub_f32 v34, v34, v39
    v_bfe_u32 v7, v34, 16, 1
    v_add3_u32 v7, v34, v7, s90
    v_and_b32 v34, 0xffff0000, v7
    v_mul_f32 v7, v34, v43
    v_fma_f32 v34, -v7, v41, v34
    v_fma_f32 v34, v34, v43, v7
    v_sub_f32 v35, v35, v39
    v_bfe_u32 v7, v35, 16, 1
    v_add3_u32 v7, v35, v7, s90
    v_and_b32 v35, 0xffff0000, v7
    v_mul_f32 v7, v35, v43
    v_fma_f32 v35, -v7, v41, v35
    v_fma_f32 v35, v35, v43, v7
    v_sub_f32 v36, v36, v39
    v_bfe_u32 v7, v36, 16, 1
    v_add3_u32 v7, v36, v7, s90
    v_and_b32 v36, 0xffff0000, v7
    v_mul_f32 v7, v36, v43
    v_fma_f32 v36, -v7, v41, v36
    v_fma_f32 v36, v36, v43, v7
    v_sub_f32 v37, v37, v39
    v_bfe_u32 v7, v37, 16, 1
    v_add3_u32 v7, v37, v7, s90
    v_and_b32 v37, 0xffff0000, v7
    v_mul_f32 v7, v37, v43
    v_fma_f32 v37, -v7, v41, v37
    v_fma_f32 v37, v37, v43, v7
    v_cvt_pk_bf16_f32 v13, v28, v29
    v_cvt_pk_bf16_f32 v14, v30, v31
    v_cvt_pk_bf16_f32 v15, v32, v33
    v_cvt_pk_bf16_f32 v16, v34, v35
    v_cvt_pk_bf16_f32 v17, v36, v37
    ds_write_b32 v5, v8 offset:0
    ds_write_b32 v5, v9 offset:256
    ds_write_b32 v5, v10 offset:512
    ds_write_b32 v5, v11 offset:768
    ds_write_b32 v5, v13 offset:1168
    ds_write_b32 v5, v14 offset:1424
    ds_write_b32 v5, v15 offset:1680
    ds_write_b32 v5, v16 offset:1936
    s_mov_b64 exec, s[22:23]
    ds_write_b32 v5, v12 offset:1024
    ds_write_b32 v5, v17 offset:2192
    s_mov_b64 exec, s[24:25]
    s_lshr_b32 s27, s2, 2
    s_and_b32 s28, s2, 3
    s_mul_i32 s29, s27, 36864
    s_mul_i32 s30, s28, 128
    s_add_u32 s29, s29, s30
    s_mul_i32 s30, s2, 9216
    s_mov_b32 s36, 83886080
    s_waitcnt lgkmcnt(0)
    s_barrier
    v_add_u32 v8, 0, v0
    v_lshlrev_b32 v9, 1, v8
    v_and_b32 v10, 7, v8
    v_lshrrev_b32 v11, 3, v8
    v_mul_u32_u24 v4, 1168, v10
    v_lshl_add_u32 v4, v11, 4, v4
    ds_read_b128 v[12:15], v4
    ds_read_u16 v16, v9 offset:0
    ds_read_u16 v17, v9 offset:1168
    ds_read_u16 v18, v9 offset:2336
    ds_read_u16 v19, v9 offset:3504
    ds_read_u16 v20, v9 offset:4672
    ds_read_u16 v21, v9 offset:5840
    ds_read_u16 v22, v9 offset:7008
    ds_read_u16 v23, v9 offset:8176
    v_lshlrev_b32 v10, 4, v10
    v_lshl_add_u32 v10, v11, 9, v10
    v_lshlrev_b32 v9, 4, v8
    v_add_u32 v24, 256, v0
    v_lshlrev_b32 v25, 1, v24
    v_and_b32 v26, 7, v24
    v_lshrrev_b32 v27, 3, v24
    v_mul_u32_u24 v4, 1168, v26
    v_lshl_add_u32 v4, v27, 4, v4
    ds_read_b128 v[28:31], v4
    ds_read_u16 v32, v25 offset:0
    ds_read_u16 v33, v25 offset:1168
    ds_read_u16 v34, v25 offset:2336
    ds_read_u16 v35, v25 offset:3504
    ds_read_u16 v36, v25 offset:4672
    ds_read_u16 v37, v25 offset:5840
    ds_read_u16 v38, v25 offset:7008
    ds_read_u16 v39, v25 offset:8176
    v_lshlrev_b32 v26, 4, v26
    v_lshl_add_u32 v26, v27, 9, v26
    v_lshlrev_b32 v25, 4, v24
    v_add_u32 v40, 512, v0
    v_cmp_gt_u32 vcc, 576, v40
    s_and_saveexec_b64 s[24:25], vcc
    v_lshlrev_b32 v41, 1, v40
    v_and_b32 v42, 7, v40
    v_lshrrev_b32 v43, 3, v40
    v_mul_u32_u24 v4, 1168, v42
    v_lshl_add_u32 v4, v43, 4, v4
    ds_read_b128 v[44:47], v4
    ds_read_u16 v48, v41 offset:0
    ds_read_u16 v49, v41 offset:1168
    ds_read_u16 v50, v41 offset:2336
    ds_read_u16 v51, v41 offset:3504
    ds_read_u16 v52, v41 offset:4672
    ds_read_u16 v53, v41 offset:5840
    ds_read_u16 v54, v41 offset:7008
    ds_read_u16 v55, v41 offset:8176
    v_lshlrev_b32 v42, 4, v42
    v_lshl_add_u32 v42, v43, 9, v42
    v_lshlrev_b32 v41, 4, v40
    s_mov_b64 s[34:35], exec
    s_mov_b64 exec, s[24:25]
    s_waitcnt lgkmcnt(15)
    buffer_store_dwordx4 v[12:15], v10, s[12:15], s29 offen sc1
    s_waitcnt lgkmcnt(15)
    v_lshl_add_u32 v16, v16, 16, s36
    v_lshl_add_u32 v17, v17, 16, s36
    v_cvt_pk_f16_f32 v16, v16, v17
    v_lshl_add_u32 v18, v18, 16, s36
    v_lshl_add_u32 v19, v19, 16, s36
    v_cvt_pk_f16_f32 v17, v18, v19
    v_lshl_add_u32 v20, v20, 16, s36
    v_lshl_add_u32 v21, v21, 16, s36
    v_cvt_pk_f16_f32 v18, v20, v21
    v_lshl_add_u32 v22, v22, 16, s36
    v_lshl_add_u32 v23, v23, 16, s36
    v_cvt_pk_f16_f32 v19, v22, v23
    buffer_store_dwordx4 v[16:19], v9, s[16:19], s30 offen sc1
    s_waitcnt lgkmcnt(15)
    buffer_store_dwordx4 v[28:31], v26, s[12:15], s29 offen sc1
    s_waitcnt lgkmcnt(9)
    v_lshl_add_u32 v32, v32, 16, s36
    v_lshl_add_u32 v33, v33, 16, s36
    v_cvt_pk_f16_f32 v32, v32, v33
    v_lshl_add_u32 v34, v34, 16, s36
    v_lshl_add_u32 v35, v35, 16, s36
    v_cvt_pk_f16_f32 v33, v34, v35
    v_lshl_add_u32 v36, v36, 16, s36
    v_lshl_add_u32 v37, v37, 16, s36
    v_cvt_pk_f16_f32 v34, v36, v37
    v_lshl_add_u32 v38, v38, 16, s36
    v_lshl_add_u32 v39, v39, 16, s36
    v_cvt_pk_f16_f32 v35, v38, v39
    buffer_store_dwordx4 v[32:35], v25, s[16:19], s30 offen sc1
    s_mov_b64 exec, s[34:35]
    s_waitcnt lgkmcnt(8)
    buffer_store_dwordx4 v[44:47], v42, s[12:15], s29 offen sc1
    s_waitcnt lgkmcnt(0)
    v_lshl_add_u32 v48, v48, 16, s36
    v_lshl_add_u32 v49, v49, 16, s36
    v_cvt_pk_f16_f32 v48, v48, v49
    v_lshl_add_u32 v50, v50, 16, s36
    v_lshl_add_u32 v51, v51, 16, s36
    v_cvt_pk_f16_f32 v49, v50, v51
    v_lshl_add_u32 v52, v52, 16, s36
    v_lshl_add_u32 v53, v53, 16, s36
    v_cvt_pk_f16_f32 v50, v52, v53
    v_lshl_add_u32 v54, v54, 16, s36
    v_lshl_add_u32 v55, v55, 16, s36
    v_cvt_pk_f16_f32 v51, v54, v55
    buffer_store_dwordx4 v[48:51], v41, s[16:19], s30 offen sc1
    s_branch K1_END
K1_TR:
    s_load_dwordx2 s[6:7], s[0:1], 80
    s_load_dwordx2 s[28:29], s[0:1], 96
    s_sub_u32 s3, s2, 275
    s_cmp_ge_u32 s3, 648
    s_cselect_b32 s30, 648, 0
    s_sub_u32 s3, s3, s30
    s_mul_hi_u32 s20, s3, 0x1c71c71d
    s_mul_i32 s21, s20, 9
    s_sub_u32 s21, s3, s21
    s_lshl_b32 s21, s21, 8
    v_add_u32 v1, s21, v0
    s_mul_i32 s22, s20, 147456
    v_lshlrev_b32 v2, 4, v1
    v_and_b32 v3, 31, v1
    v_lshrrev_b32 v4, 5, v1
    s_mov_b32 s23, 73728
    v_mul_lo_u32 v4, v4, s23
    s_lshl_b32 s24, s20, 7
    v_lshl_add_u32 v4, v3, 1, v4
    v_lshrrev_b32 v7, 7, v1
    v_lshlrev_b32 v7, 6, v7
    v_lshl_add_u32 v7, v3, 1, v7
    v_bfe_u32 v5, v1, 5, 2
    v_lshrrev_b32 v6, 1, v5
    v_and_b32 v5, 1, v5
    v_lshlrev_b32 v6, 4, v6
    v_lshl_add_u32 v5, v5, 2, v6
    v_mul_u32_u24 v5, 1152, v5
    v_add_u32 v7, v7, v5
    s_mul_i32 s25, s20, 73728
    s_waitcnt lgkmcnt(0)
    s_cmp_lg_u32 s30, 0
    s_cbranch_scc1 K1_I2
    s_add_u32 s8, s6, 0
    s_addc_u32 s9, s7, 0
    s_and_b32 s9, s9, 0xffff
    s_mov_b32 s10, 5308416
    s_mov_b32 s11, 0x00020000
    s_add_u32 s26, s24, 0
    buffer_load_ushort v8, v4, s[8:11], s26 offen
    buffer_load_ushort v24, v4, s[8:11], s26 offen offset:64
    s_add_u32 s26, s24, 9216
    buffer_load_ushort v9, v4, s[8:11], s26 offen
    buffer_load_ushort v25, v4, s[8:11], s26 offen offset:64
    s_add_u32 s26, s24, 18432
    buffer_load_ushort v10, v4, s[8:11], s26 offen
    buffer_load_ushort v26, v4, s[8:11], s26 offen offset:64
    s_add_u32 s26, s24, 27648
    buffer_load_ushort v11, v4, s[8:11], s26 offen
    buffer_load_ushort v27, v4, s[8:11], s26 offen offset:64
    s_add_u32 s26, s24, 36864
    buffer_load_ushort v12, v4, s[8:11], s26 offen
    buffer_load_ushort v28, v4, s[8:11], s26 offen offset:64
    s_add_u32 s26, s24, 46080
    buffer_load_ushort v13, v4, s[8:11], s26 offen
    buffer_load_ushort v29, v4, s[8:11], s26 offen offset:64
    s_add_u32 s26, s24, 55296
    buffer_load_ushort v14, v4, s[8:11], s26 offen
    buffer_load_ushort v30, v4, s[8:11], s26 offen offset:64
    s_add_u32 s26, s24, 64512
    buffer_load_ushort v15, v4, s[8:11], s26 offen
    buffer_load_ushort v31, v4, s[8:11], s26 offen offset:64
    s_branch K1_I3
K1_I2:
    s_add_u32 s8, s28, 0
    s_addc_u32 s9, s29, 0
    s_and_b32 s9, s9, 0xffff
    s_mov_b32 s10, 5308416
    s_mov_b32 s11, 0x00020000
    s_add_u32 s26, s25, 0
    buffer_load_ushort v8, v7, s[8:11], s26 offen
    s_add_u32 s26, s25, 1152
    buffer_load_ushort v9, v7, s[8:11], s26 offen
    s_add_u32 s26, s25, 2304
    buffer_load_ushort v10, v7, s[8:11], s26 offen
    s_add_u32 s26, s25, 3456
    buffer_load_ushort v11, v7, s[8:11], s26 offen
    s_add_u32 s26, s25, 9216
    buffer_load_ushort v12, v7, s[8:11], s26 offen
    s_add_u32 s26, s25, 10368
    buffer_load_ushort v13, v7, s[8:11], s26 offen
    s_add_u32 s26, s25, 11520
    buffer_load_ushort v14, v7, s[8:11], s26 offen
    s_add_u32 s26, s25, 12672
    buffer_load_ushort v15, v7, s[8:11], s26 offen
    s_add_u32 s26, s25, 36864
    buffer_load_ushort v24, v7, s[8:11], s26 offen
    s_add_u32 s26, s25, 38016
    buffer_load_ushort v25, v7, s[8:11], s26 offen
    s_add_u32 s26, s25, 39168
    buffer_load_ushort v26, v7, s[8:11], s26 offen
    s_add_u32 s26, s25, 40320
    buffer_load_ushort v27, v7, s[8:11], s26 offen
    s_add_u32 s26, s25, 46080
    buffer_load_ushort v28, v7, s[8:11], s26 offen
    s_add_u32 s26, s25, 47232
    buffer_load_ushort v29, v7, s[8:11], s26 offen
    s_add_u32 s26, s25, 48384
    buffer_load_ushort v30, v7, s[8:11], s26 offen
    s_add_u32 s26, s25, 49536
    buffer_load_ushort v31, v7, s[8:11], s26 offen
    s_add_u32 s22, s22, 36864
K1_I3:
    s_add_u32 s12, s4, 41959424
    s_addc_u32 s13, s5, 0
    s_and_b32 s13, s13, 0xffff
    s_mov_b32 s14, 10616832
    s_mov_b32 s15, 0x00020000
    s_add_u32 s23, s22, 73728
    s_waitcnt vmcnt(0)
    v_lshl_or_b32 v16, v9, 16, v8
    v_lshl_or_b32 v17, v11, 16, v10
    v_lshl_or_b32 v18, v13, 16, v12
    v_lshl_or_b32 v19, v15, 16, v14
    buffer_store_dwordx4 v[16:19], v2, s[12:15], s22 offen sc1
    s_waitcnt vmcnt(1)
    v_lshl_or_b32 v20, v25, 16, v24
    v_lshl_or_b32 v21, v27, 16, v26
    v_lshl_or_b32 v22, v29, 16, v28
    v_lshl_or_b32 v23, v31, 16, v30
    buffer_store_dwordx4 v[20:23], v2, s[12:15], s23 offen sc1
    s_branch K1_END
K1_TAB:
    s_load_dwordx2 s[6:7], s[0:1], 88
    s_waitcnt lgkmcnt(0)
    s_sub_u32 s3, s2, 256
    s_lshl_b32 s3, s3, 8
    v_add_u32 v1, s3, v0
    s_add_u32 s8, s6, 0
    s_addc_u32 s9, s7, 0
    s_and_b32 s9, s9, 0xffff
    s_mov_b32 s10, 9216
    s_mov_b32 s11, 0x00020000
    s_add_u32 s12, s4, 130449408
    s_addc_u32 s13, s5, 0
    s_and_b32 s13, s13, 0xffff
    s_mov_b32 s14, 18432
    s_mov_b32 s15, 0x00020000
    s_add_u32 s16, s4, 130437120
    s_addc_u32 s17, s5, 0
    s_and_b32 s17, s17, 0xffff
    s_mov_b32 s18, 9728
    s_mov_b32 s19, 0x00020000
    v_lshlrev_b32 v2, 1, v1
    buffer_load_ushort v3, v2, s[8:11], 0 offen
    v_cmp_le_u32 vcc, 2432, v1
    v_mov_b32 v4, 14720
    v_mov_b32 v5, 45056
    v_cndmask_b32 v4, v4, v5, vcc
    v_add_u32 v4, v4, v1
    v_lshlrev_b32 v4, 16, v4
    v_mov_b32 v5, 0
    v_bfe_u32 v8, v4, 16, 1
    v_add3_u32 v8, v4, v8, s90
    v_and_b32 v4, 0xffff0000, v8
    v_add_f32 v4, v4, v5
    v_bfe_u32 v8, v4, 16, 1
    v_add3_u32 v8, v4, v8, s90
    v_and_b32 v4, 0xffff0000, v8
    v_and_b32 v9, 0x7fffffff, v4
    v_mul_f32 v9, 0xbfb8aa3b, v9
    v_exp_f32 v9, v9
    s_nop 0
    v_bfe_u32 v8, v9, 16, 1
    v_add3_u32 v8, v9, v8, s90
    v_and_b32 v9, 0xffff0000, v8
    v_add_f32 v10, 1.0, v9
    v_log_f32 v11, v10
    v_subrev_f32 v10, 1.0, v10
    v_rcp_f32 v12, v10
    v_mul_f32 v11, 0x3f317218, v11
    v_mul_f32 v11, v11, v9
    v_mul_f32 v11, v11, v12
    v_cmp_eq_f32 vcc, 0, v10
    s_nop 1
    v_cndmask_b32 v11, v11, v9, vcc
    v_bfe_u32 v8, v11, 16, 1
    v_add3_u32 v8, v11, v8, s90
    v_and_b32 v11, 0xffff0000, v8
    v_max_f32 v10, 0, v4
    v_add_f32 v11, v11, v10
    v_bfe_u32 v8, v11, 16, 1
    v_add3_u32 v8, v11, v8, s90
    v_and_b32 v11, 0xffff0000, v8
    v_mul_f32 v11, 0xc038aa3b, v11
    v_exp_f32 v11, v11
    s_nop 0
    v_add_f32 v10, 1.0, v11
    v_rcp_f32 v10, v10
    v_sub_f32 v11, 1.0, v11
    v_mul_f32 v11, v11, v10
    v_bfe_u32 v8, v11, 16, 1
    v_add3_u32 v8, v11, v8, s90
    v_and_b32 v11, 0xffff0000, v8
    v_mul_f32 v4, v4, v11
    v_lshrrev_b32 v11, 16, v11
    buffer_store_short v11, v2, s[16:19], 0 offen sc1
    s_waitcnt vmcnt(0)
    v_lshlrev_b32 v3, 16, v3
    v_lshlrev_b32 v2, 2, v1
    buffer_store_dword v3, v2, s[12:15], 0 offen sc1
    s_branch K1_END
K1_KGEN:
    s_load_dwordx8 s[8:15], s[0:1], 8
    s_load_dwordx4 s[16:19], s[0:1], 40
    s_load_dwordx2 s[20:21], s[0:1], 56
    s_waitcnt lgkmcnt(0)
    s_lshl_b32 s22, s2, 8
    v_lshlrev_b32 v1, 1, v0
    v_add_u32 v1, s22, v1
    v_cmp_gt_u32 vcc, 128, v0
    s_and_saveexec_b64 s[24:25], vcc
    global_load_ushort v2, v1, s[8:9]
    global_load_ushort v3, v1, s[10:11]
    global_load_ushort v4, v1, s[12:13]
    global_load_ushort v5, v1, s[14:15]
    global_load_ushort v6, v1, s[16:17]
    global_load_ushort v7, v1, s[18:19]
    s_lshl_b32 s23, s2, 1
    v_mov_b32 v8, s23
    global_load_ushort v8, v8, s[20:21]
    s_mov_b64 exec, s[24:25]
    v_and_b32 v12, 63, v0
    v_lshrrev_b32 v13, 6, v0
    v_and_b32 v14, 15, v12
    v_lshrrev_b32 v15, 4, v12
    v_lshl_add_u32 v16, v13, 5, v15
    v_lshlrev_b32 v16, 4, v16
    v_and_b32 v17, 7, v14
    v_lshrrev_b32 v18, 3, v14
    v_lshl_add_u32 v20, v18, 7, v17
    v_and_b32 v17, 3, v14
    v_lshlrev_b32 v17, 1, v17
    v_bfe_u32 v18, v14, 2, 1
    v_lshl_add_u32 v17, v18, 7, v17
    v_add_u32 v17, 256, v17
    v_and_b32 v18, 1, v14
    v_lshlrev_b32 v18, 2, v18
    v_bfe_u32 v19, v14, 1, 2
    v_lshl_add_u32 v18, v19, 7, v18
    v_add_u32 v18, 512, v18
    v_cmp_gt_u32 vcc, 8, v14
    v_cndmask_b32 v21, v18, v17, vcc
    v_lshlrev_b32 v17, 7, v14
    v_add_u32 v17, 1024, v17
    v_mov_b32 v18, 2056
    v_cmp_gt_u32 vcc, 9, v14
    v_cndmask_b32 v22, v18, v17, vcc
    v_lshlrev_b32 v23, 3, v14
    v_cmp_gt_u32 vcc, 16, v0
    s_and_saveexec_b64 s[24:25], vcc
    v_lshlrev_b32 v17, 2, v14
    ds_write_b32 v17, v20 offset:5760
    ds_write_b32 v17, v21 offset:5824
    ds_write_b32 v17, v22 offset:5888
    s_mov_b64 exec, s[24:25]
    v_cvt_f32_u32 v20, v20
    v_cvt_f32_u32 v21, v21
    v_cvt_f32_u32 v22, v22
    v_cvt_f32_u32 v23, v23
    v_cmp_gt_u32 vcc, 128, v0
    s_and_saveexec_b64 s[24:25], vcc
    s_waitcnt vmcnt(0)
    v_lshlrev_b32 v2, 16, v2
    v_lshlrev_b32 v3, 16, v3
    v_lshlrev_b32 v4, 16, v4
    v_lshlrev_b32 v5, 16, v5
    v_lshlrev_b32 v6, 16, v6
    v_lshlrev_b32 v7, 16, v7
    v_lshlrev_b32 v8, 16, v8
    v_mul_f32 v8, 0x3fb8aa3b, v8
    v_exp_f32 v8, v8
    s_nop 0
    v_bfe_u32 v9, v8, 16, 1
    v_add3_u32 v9, v8, v9, s90
    v_and_b32 v8, 0xffff0000, v9
    v_mul_f32 v2, v8, v2
    v_mul_f32 v3, v8, v3
    v_mul_f32 v4, v8, v4
    v_mul_f32 v5, v8, v5
    v_mul_f32 v10, v6, v4
    v_fma_f32 v10, -v7, v5, v10
    v_mul_f32 v11, v6, v5
    v_fma_f32 v11, v7, v4, v11
    v_mul_f32 v8, 0x3fb8aa3b, v2
    v_mul_f32 v9, 0x3e22f983, v3
    v_lshlrev_b32 v1, 4, v0
    ds_write_b128 v1, v[8:11]
    v_add_f32_e64 v17, |v10|, |v11|
    v_lshlrev_b32 v18, 2, v13
    s_nop 1
    v_add_f32_dpp v17, v17, v17 row_shr:1 row_mask:0xf bank_mask:0xf bound_ctrl:0
    s_nop 1
    v_add_f32_dpp v17, v17, v17 row_shr:2 row_mask:0xf bank_mask:0xf bound_ctrl:0
    s_nop 1
    v_add_f32_dpp v17, v17, v17 row_shr:4 row_mask:0xf bank_mask:0xf bound_ctrl:0
    s_nop 1
    v_add_f32_dpp v17, v17, v17 row_shr:8 row_mask:0xf bank_mask:0xf bound_ctrl:0
    s_nop 1
    v_add_f32_dpp v17, v17, v17 row_bcast:15 row_mask:0xa bank_mask:0xf bound_ctrl:0
    s_nop 1
    v_add_f32_dpp v17, v17, v17 row_bcast:31 row_mask:0xc bank_mask:0xf bound_ctrl:0
    s_nop 1
    v_readlane_b32 s30, v17, 63
    s_nop 3
    v_mov_b32 v17, s30
    ds_write_b32 v18, v17 offset:5952
    s_mov_b64 exec, s[24:25]
    s_waitcnt lgkmcnt(0)
    s_barrier
    ds_read_b128 v[36:39], v16 offset:0
    ds_read_b128 v[40:43], v16 offset:64
    ds_read_b128 v[44:47], v16 offset:128
    ds_read_b128 v[48:51], v16 offset:192
    s_waitcnt lgkmcnt(3)
    v_mul_f32 v52, v36, v20
    v_mul_f32 v53, v37, v20
    v_mul_f32 v55, v36, v21
    v_mul_f32 v56, v37, v21
    v_mul_f32 v58, v36, v22
    v_mul_f32 v59, v37, v22
    v_mul_f32 v61, v36, v23
    v_mul_f32 v62, v37, v23
    v_fract_f32 v62, v62
    v_fract_f32 v53, v53
    v_fract_f32 v56, v56
    v_fract_f32 v59, v59
    v_exp_f32 v61, v61
    v_sin_f32 v63, v62
    v_cos_f32 v62, v62
    v_exp_f32 v52, v52
    v_sin_f32 v54, v53
    v_cos_f32 v53, v53
    v_exp_f32 v55, v55
    v_sin_f32 v57, v56
    v_cos_f32 v56, v56
    v_exp_f32 v58, v58
    v_sin_f32 v60, v59
    v_cos_f32 v59, v59
    v_mul_f32 v62, v61, v62
    v_mul_f32 v63, v61, v63
    v_mul_f32 v53, v52, v53
    v_mul_f32 v54, v52, v54
    v_mul_f32 v56, v55, v56
    v_mul_f32 v57, v55, v57
    v_mul_f32 v59, v58, v59
    v_mul_f32 v60, v58, v60
    v_mul_f32 v61, v39, v63
    v_mul_f32 v52, v39, v62
    v_fma_f32 v61, v38, v62, -v61
    v_fma_f32 v62, -v38, v63, -v52
    ds_read_b128 v[36:39], v16 offset:256
    s_nop 1
    v_mfma_f32_16x16x4_f32 v[24:27], v53, v61, 0
    v_mfma_f32_16x16x4_f32 v[28:31], v56, v61, 0
    v_mfma_f32_16x16x4_f32 v[32:35], v59, v61, 0
    v_mfma_f32_16x16x4_f32 v[24:27], v54, v62, v[24:27]
    v_mfma_f32_16x16x4_f32 v[28:31], v57, v62, v[28:31]
    v_mfma_f32_16x16x4_f32 v[32:35], v60, v62, v[32:35]
    s_nop 1
    s_waitcnt lgkmcnt(3)
    v_mul_f32 v52, v40, v20
    v_mul_f32 v53, v41, v20
    v_mul_f32 v55, v40, v21
    v_mul_f32 v56, v41, v21
    v_mul_f32 v58, v40, v22
    v_mul_f32 v59, v41, v22
    v_mul_f32 v61, v40, v23
    v_mul_f32 v62, v41, v23
    v_fract_f32 v62, v62
    v_fract_f32 v53, v53
    v_fract_f32 v56, v56
    v_fract_f32 v59, v59
    v_exp_f32 v61, v61
    v_sin_f32 v63, v62
    v_cos_f32 v62, v62
    v_exp_f32 v52, v52
    v_sin_f32 v54, v53
    v_cos_f32 v53, v53
    v_exp_f32 v55, v55
    v_sin_f32 v57, v56
    v_cos_f32 v56, v56
    v_exp_f32 v58, v58
    v_sin_f32 v60, v59
    v_cos_f32 v59, v59
    v_mul_f32 v62, v61, v62
    v_mul_f32 v63, v61, v63
    v_mul_f32 v53, v52, v53
    v_mul_f32 v54, v52, v54
    v_mul_f32 v56, v55, v56
    v_mul_f32 v57, v55, v57
    v_mul_f32 v59, v58, v59
    v_mul_f32 v60, v58, v60
    v_mul_f32 v61, v43, v63
    v_mul_f32 v52, v43, v62
    v_fma_f32 v61, v42, v62, -v61
    v_fma_f32 v62, -v42, v63, -v52
    ds_read_b128 v[40:43], v16 offset:320
    s_nop 1
    v_mfma_f32_16x16x4_f32 v[24:27], v53, v61, v[24:27]
    v_mfma_f32_16x16x4_f32 v[28:31], v56, v61, v[28:31]
    v_mfma_f32_16x16x4_f32 v[32:35], v59, v61, v[32:35]
    v_mfma_f32_16x16x4_f32 v[24:27], v54, v62, v[24:27]
    v_mfma_f32_16x16x4_f32 v[28:31], v57, v62, v[28:31]
    v_mfma_f32_16x16x4_f32 v[32:35], v60, v62, v[32:35]
    s_nop 1
    s_waitcnt lgkmcnt(3)
    v_mul_f32 v52, v44, v20
    v_mul_f32 v53, v45, v20
    v_mul_f32 v55, v44, v21
    v_mul_f32 v56, v45, v21
    v_mul_f32 v58, v44, v22
    v_mul_f32 v59, v45, v22
    v_mul_f32 v61, v44, v23
    v_mul_f32 v62, v45, v23
    v_fract_f32 v62, v62
    v_fract_f32 v53, v53
    v_fract_f32 v56, v56
    v_fract_f32 v59, v59
    v_exp_f32 v61, v61
    v_sin_f32 v63, v62
    v_cos_f32 v62, v62
    v_exp_f32 v52, v52
    v_sin_f32 v54, v53
    v_cos_f32 v53, v53
    v_exp_f32 v55, v55
    v_sin_f32 v57, v56
    v_cos_f32 v56, v56
    v_exp_f32 v58, v58
    v_sin_f32 v60, v59
    v_cos_f32 v59, v59
    v_mul_f32 v62, v61, v62
    v_mul_f32 v63, v61, v63
    v_mul_f32 v53, v52, v53
    v_mul_f32 v54, v52, v54
    v_mul_f32 v56, v55, v56
    v_mul_f32 v57, v55, v57
    v_mul_f32 v59, v58, v59
    v_mul_f32 v60, v58, v60
    v_mul_f32 v61, v47, v63
    v_mul_f32 v52, v47, v62
    v_fma_f32 v61, v46, v62, -v61
    v_fma_f32 v62, -v46, v63, -v52
    ds_read_b128 v[44:47], v16 offset:384
    s_nop 1
    v_mfma_f32_16x16x4_f32 v[24:27], v53, v61, v[24:27]
    v_mfma_f32_16x16x4_f32 v[28:31], v56, v61, v[28:31]
    v_mfma_f32_16x16x4_f32 v[32:35], v59, v61, v[32:35]
    v_mfma_f32_16x16x4_f32 v[24:27], v54, v62, v[24:27]
    v_mfma_f32_16x16x4_f32 v[28:31], v57, v62, v[28:31]
    v_mfma_f32_16x16x4_f32 v[32:35], v60, v62, v[32:35]
    s_nop 1
    s_waitcnt lgkmcnt(3)
    v_mul_f32 v52, v48, v20
    v_mul_f32 v53, v49, v20
    v_mul_f32 v55, v48, v21
    v_mul_f32 v56, v49, v21
    v_mul_f32 v58, v48, v22
    v_mul_f32 v59, v49, v22
    v_mul_f32 v61, v48, v23
    v_mul_f32 v62, v49, v23
    v_fract_f32 v62, v62
    v_fract_f32 v53, v53
    v_fract_f32 v56, v56
    v_fract_f32 v59, v59
    v_exp_f32 v61, v61
    v_sin_f32 v63, v62
    v_cos_f32 v62, v62
    v_exp_f32 v52, v52
    v_sin_f32 v54, v53
    v_cos_f32 v53, v53
    v_exp_f32 v55, v55
    v_sin_f32 v57, v56
    v_cos_f32 v56, v56
    v_exp_f32 v58, v58
    v_sin_f32 v60, v59
    v_cos_f32 v59, v59
    v_mul_f32 v62, v61, v62
    v_mul_f32 v63, v61, v63
    v_mul_f32 v53, v52, v53
    v_mul_f32 v54, v52, v54
    v_mul_f32 v56, v55, v56
    v_mul_f32 v57, v55, v57
    v_mul_f32 v59, v58, v59
    v_mul_f32 v60, v58, v60
    v_mul_f32 v61, v51, v63
    v_mul_f32 v52, v51, v62
    v_fma_f32 v61, v50, v62, -v61
    v_fma_f32 v62, -v50, v63, -v52
    ds_read_b128 v[48:51], v16 offset:448
    s_nop 1
    v_mfma_f32_16x16x4_f32 v[24:27], v53, v61, v[24:27]
    v_mfma_f32_16x16x4_f32 v[28:31], v56, v61, v[28:31]
    v_mfma_f32_16x16x4_f32 v[32:35], v59, v61, v[32:35]
    v_mfma_f32_16x16x4_f32 v[24:27], v54, v62, v[24:27]
    v_mfma_f32_16x16x4_f32 v[28:31], v57, v62, v[28:31]
    v_mfma_f32_16x16x4_f32 v[32:35], v60, v62, v[32:35]
    s_nop 1
    s_waitcnt lgkmcnt(3)
    v_mul_f32 v52, v36, v20
    v_mul_f32 v53, v37, v20
    v_mul_f32 v55, v36, v21
    v_mul_f32 v56, v37, v21
    v_mul_f32 v58, v36, v22
    v_mul_f32 v59, v37, v22
    v_mul_f32 v61, v36, v23
    v_mul_f32 v62, v37, v23
    v_fract_f32 v62, v62
    v_fract_f32 v53, v53
    v_fract_f32 v56, v56
    v_fract_f32 v59, v59
    v_exp_f32 v61, v61
    v_sin_f32 v63, v62
    v_cos_f32 v62, v62
    v_exp_f32 v52, v52
    v_sin_f32 v54, v53
    v_cos_f32 v53, v53
    v_exp_f32 v55, v55
    v_sin_f32 v57, v56
    v_cos_f32 v56, v56
    v_exp_f32 v58, v58
    v_sin_f32 v60, v59
    v_cos_f32 v59, v59
    v_mul_f32 v62, v61, v62
    v_mul_f32 v63, v61, v63
    v_mul_f32 v53, v52, v53
    v_mul_f32 v54, v52, v54
    v_mul_f32 v56, v55, v56
    v_mul_f32 v57, v55, v57
    v_mul_f32 v59, v58, v59
    v_mul_f32 v60, v58, v60
    v_mul_f32 v61, v39, v63
    v_mul_f32 v52, v39, v62
    v_fma_f32 v61, v38, v62, -v61
    v_fma_f32 v62, -v38, v63, -v52
    s_nop 1
    v_mfma_f32_16x16x4_f32 v[24:27], v53, v61, v[24:27]
    v_mfma_f32_16x16x4_f32 v[28:31], v56, v61, v[28:31]
    v_mfma_f32_16x16x4_f32 v[32:35], v59, v61, v[32:35]
    v_mfma_f32_16x16x4_f32 v[24:27], v54, v62, v[24:27]
    v_mfma_f32_16x16x4_f32 v[28:31], v57, v62, v[28:31]
    v_mfma_f32_16x16x4_f32 v[32:35], v60, v62, v[32:35]
    s_nop 1
    s_waitcnt lgkmcnt(2)
    v_mul_f32 v52, v40, v20
    v_mul_f32 v53, v41, v20
    v_mul_f32 v55, v40, v21
    v_mul_f32 v56, v41, v21
    v_mul_f32 v58, v40, v22
    v_mul_f32 v59, v41, v22
    v_mul_f32 v61, v40, v23
    v_mul_f32 v62, v41, v23
    v_fract_f32 v62, v62
    v_fract_f32 v53, v53
    v_fract_f32 v56, v56
    v_fract_f32 v59, v59
    v_exp_f32 v61, v61
    v_sin_f32 v63, v62
    v_cos_f32 v62, v62
    v_exp_f32 v52, v52
    v_sin_f32 v54, v53
    v_cos_f32 v53, v53
    v_exp_f32 v55, v55
    v_sin_f32 v57, v56
    v_cos_f32 v56, v56
    v_exp_f32 v58, v58
    v_sin_f32 v60, v59
    v_cos_f32 v59, v59
    v_mul_f32 v62, v61, v62
    v_mul_f32 v63, v61, v63
    v_mul_f32 v53, v52, v53
    v_mul_f32 v54, v52, v54
    v_mul_f32 v56, v55, v56
    v_mul_f32 v57, v55, v57
    v_mul_f32 v59, v58, v59
    v_mul_f32 v60, v58, v60
    v_mul_f32 v61, v43, v63
    v_mul_f32 v52, v43, v62
    v_fma_f32 v61, v42, v62, -v61
    v_fma_f32 v62, -v42, v63, -v52
    s_nop 1
    v_mfma_f32_16x16x4_f32 v[24:27], v53, v61, v[24:27]
    v_mfma_f32_16x16x4_f32 v[28:31], v56, v61, v[28:31]
    v_mfma_f32_16x16x4_f32 v[32:35], v59, v61, v[32:35]
    v_mfma_f32_16x16x4_f32 v[24:27], v54, v62, v[24:27]
    v_mfma_f32_16x16x4_f32 v[28:31], v57, v62, v[28:31]
    v_mfma_f32_16x16x4_f32 v[32:35], v60, v62, v[32:35]
    s_nop 1
    s_waitcnt lgkmcnt(1)
    v_mul_f32 v52, v44, v20
    v_mul_f32 v53, v45, v20
    v_mul_f32 v55, v44, v21
    v_mul_f32 v56, v45, v21
    v_mul_f32 v58, v44, v22
    v_mul_f32 v59, v45, v22
    v_mul_f32 v61, v44, v23
    v_mul_f32 v62, v45, v23
    v_fract_f32 v62, v62
    v_fract_f32 v53, v53
    v_fract_f32 v56, v56
    v_fract_f32 v59, v59
    v_exp_f32 v61, v61
    v_sin_f32 v63, v62
    v_cos_f32 v62, v62
    v_exp_f32 v52, v52
    v_sin_f32 v54, v53
    v_cos_f32 v53, v53
    v_exp_f32 v55, v55
    v_sin_f32 v57, v56
    v_cos_f32 v56, v56
    v_exp_f32 v58, v58
    v_sin_f32 v60, v59
    v_cos_f32 v59, v59
    v_mul_f32 v62, v61, v62
    v_mul_f32 v63, v61, v63
    v_mul_f32 v53, v52, v53
    v_mul_f32 v54, v52, v54
    v_mul_f32 v56, v55, v56
    v_mul_f32 v57, v55, v57
    v_mul_f32 v59, v58, v59
    v_mul_f32 v60, v58, v60
    v_mul_f32 v61, v47, v63
    v_mul_f32 v52, v47, v62
    v_fma_f32 v61, v46, v62, -v61
    v_fma_f32 v62, -v46, v63, -v52
    s_nop 1
    v_mfma_f32_16x16x4_f32 v[24:27], v53, v61, v[24:27]
    v_mfma_f32_16x16x4_f32 v[28:31], v56, v61, v[28:31]
    v_mfma_f32_16x16x4_f32 v[32:35], v59, v61, v[32:35]
    v_mfma_f32_16x16x4_f32 v[24:27], v54, v62, v[24:27]
    v_mfma_f32_16x16x4_f32 v[28:31], v57, v62, v[28:31]
    v_mfma_f32_16x16x4_f32 v[32:35], v60, v62, v[32:35]
    s_nop 1
    s_waitcnt lgkmcnt(0)
    v_mul_f32 v52, v48, v20
    v_mul_f32 v53, v49, v20
    v_mul_f32 v55, v48, v21
    v_mul_f32 v56, v49, v21
    v_mul_f32 v58, v48, v22
    v_mul_f32 v59, v49, v22
    v_mul_f32 v61, v48, v23
    v_mul_f32 v62, v49, v23
    v_fract_f32 v62, v62
    v_fract_f32 v53, v53
    v_fract_f32 v56, v56
    v_fract_f32 v59, v59
    v_exp_f32 v61, v61
    v_sin_f32 v63, v62
    v_cos_f32 v62, v62
    v_exp_f32 v52, v52
    v_sin_f32 v54, v53
    v_cos_f32 v53, v53
    v_exp_f32 v55, v55
    v_sin_f32 v57, v56
    v_cos_f32 v56, v56
    v_exp_f32 v58, v58
    v_sin_f32 v60, v59
    v_cos_f32 v59, v59
    v_mul_f32 v62, v61, v62
    v_mul_f32 v63, v61, v63
    v_mul_f32 v53, v52, v53
    v_mul_f32 v54, v52, v54
    v_mul_f32 v56, v55, v56
    v_mul_f32 v57, v55, v57
    v_mul_f32 v59, v58, v59
    v_mul_f32 v60, v58, v60
    v_mul_f32 v61, v51, v63
    v_mul_f32 v52, v51, v62
    v_fma_f32 v61, v50, v62, -v61
    v_fma_f32 v62, -v50, v63, -v52
    s_nop 1
    v_mfma_f32_16x16x4_f32 v[24:27], v53, v61, v[24:27]
    v_mfma_f32_16x16x4_f32 v[28:31], v56, v61, v[28:31]
    v_mfma_f32_16x16x4_f32 v[32:35], v59, v61, v[32:35]
    v_mfma_f32_16x16x4_f32 v[24:27], v54, v62, v[24:27]
    v_mfma_f32_16x16x4_f32 v[28:31], v57, v62, v[28:31]
    v_mfma_f32_16x16x4_f32 v[32:35], v60, v62, v[32:35]
    s_nop 1
    s_nop 7
    s_nop 7
    v_mul_u32_u24 v17, 3072, v13
    v_lshl_add_u32 v17, v12, 4, v17
    ds_write_b128 v17, v[24:27] offset:6144
    ds_write_b128 v17, v[28:31] offset:7168
    ds_write_b128 v17, v[32:35] offset:8192
    s_mov_b32 s26, 4294902276
    s_mov_b32 s27, 0x3f7f3f7f
    s_mov_b32 s28, 0x00020002
    s_waitcnt lgkmcnt(0)
    s_barrier
    v_cmp_gt_u32 vcc, 192, v0
    s_and_saveexec_b64 s[24:25], vcc
    v_lshlrev_b32 v17, 10, v13
    v_lshl_add_u32 v17, v12, 4, v17
    ds_read_b128 v[24:27], v17 offset:6144
    ds_read_b128 v[28:31], v17 offset:9216
    ds_read_b128 v[32:35], v17 offset:12288
    ds_read_b128 v[36:39], v17 offset:15360
    v_lshlrev_b32 v18, 6, v13
    v_lshl_add_u32 v18, v15, 4, v18
    ds_read_b128 v[40:43], v18 offset:5760
    v_lshlrev_b32 v19, 3, v14
    v_mov_b32 v18, 0x4501
    s_waitcnt lgkmcnt(0)
    v_add_f32 v24, v24, v28
    v_add_f32 v32, v32, v36
    v_add_f32 v24, v24, v32
    v_add_u32 v40, v40, v19
    v_cvt_f32_u32 v44, v40
    v_lshrrev_b32 v44, 16, v44
    v_max_u32 v44, 0x3f7f, v44
    v_cmp_lt_u32 vcc, 2048, v40
    v_cndmask_b32 v44, v44, v18, vcc
    v_lshl_add_u32 v40, v44, 2, s26
    ds_write_b32 v40, v24 offset:0
    v_add_f32 v25, v25, v29
    v_add_f32 v33, v33, v37
    v_add_f32 v25, v25, v33
    v_add_u32 v41, v41, v19
    v_cvt_f32_u32 v44, v41
    v_lshrrev_b32 v44, 16, v44
    v_max_u32 v44, 0x3f7f, v44
    v_cmp_lt_u32 vcc, 2048, v41
    v_cndmask_b32 v44, v44, v18, vcc
    v_lshl_add_u32 v41, v44, 2, s26
    ds_write_b32 v41, v25 offset:0
    v_add_f32 v26, v26, v30
    v_add_f32 v34, v34, v38
    v_add_f32 v26, v26, v34
    v_add_u32 v42, v42, v19
    v_cvt_f32_u32 v44, v42
    v_lshrrev_b32 v44, 16, v44
    v_max_u32 v44, 0x3f7f, v44
    v_cmp_lt_u32 vcc, 2048, v42
    v_cndmask_b32 v44, v44, v18, vcc
    v_lshl_add_u32 v42, v44, 2, s26
    ds_write_b32 v42, v26 offset:0
    v_add_f32 v27, v27, v31
    v_add_f32 v35, v35, v39
    v_add_f32 v27, v27, v35
    v_add_u32 v43, v43, v19
    v_cvt_f32_u32 v44, v43
    v_lshrrev_b32 v44, 16, v44
    v_max_u32 v44, 0x3f7f, v44
    v_cmp_lt_u32 vcc, 2048, v43
    v_cndmask_b32 v44, v44, v18, vcc
    v_lshl_add_u32 v43, v44, 2, s26
    ds_write_b32 v43, v27 offset:0
    s_mov_b64 exec, s[24:25]
    v_lshlrev_b32 v1, 3, v0
    v_sub_u32 v1, 2047, v1
    v_cvt_f32_u32 v2, v1
    s_add_u32 s8, s4, 130467840
    s_addc_u32 s9, s5, 0
    s_and_b32 s9, s9, 0xffff
    s_mov_b32 s10, 2433024
    s_mov_b32 s11, 0x00020000
    s_mul_i32 s22, s2, 4224
    v_subrev_f32 v4, 1.0, v2
    v_cvt_pk_bf16_f32 v5, v2, v4
    v_pk_sub_u16 v5, v5, s27 clamp
    v_pk_lshlrev_b16 v5, s28, v5
    v_and_b32 v44, 0xffff, v5
    v_lshrrev_b32 v45, 16, v5
    v_subrev_f32 v3, 2.0, v2
    v_subrev_f32 v4, 0x40400000, v2
    v_cvt_pk_bf16_f32 v5, v3, v4
    v_pk_sub_u16 v5, v5, s27 clamp
    v_pk_lshlrev_b16 v5, s28, v5
    v_and_b32 v46, 0xffff, v5
    v_lshrrev_b32 v47, 16, v5
    v_subrev_f32 v3, 4.0, v2
    v_subrev_f32 v4, 0x40a00000, v2
    v_cvt_pk_bf16_f32 v5, v3, v4
    v_pk_sub_u16 v5, v5, s27 clamp
    v_pk_lshlrev_b16 v5, s28, v5
    v_and_b32 v48, 0xffff, v5
    v_lshrrev_b32 v49, 16, v5
    v_subrev_f32 v3, 0x40c00000, v2
    v_subrev_f32 v4, 0x40e00000, v2
    v_cvt_pk_bf16_f32 v5, v3, v4
    v_pk_sub_u16 v5, v5, s27 clamp
    v_pk_lshlrev_b16 v5, s28, v5
    v_and_b32 v50, 0xffff, v5
    v_lshrrev_b32 v51, 16, v5
    v_mov_b32 v2, 0
    ds_read_b64 v[32:33], v2 offset:5952
    s_waitcnt lgkmcnt(0)
    s_barrier
    ds_read_b32 v24, v44 offset:0
    ds_read_b32 v25, v45 offset:0
    ds_read_b32 v26, v46 offset:0
    ds_read_b32 v27, v47 offset:0
    ds_read_b32 v28, v48 offset:0
    ds_read_b32 v29, v49 offset:0
    ds_read_b32 v30, v50 offset:0
    ds_read_b32 v31, v51 offset:0
    v_add_f32 v32, v32, v33
    v_lshrrev_b32 v32, 23, v32
    v_max_u32 v32, 32, v32
    v_sub_u32 v33, 268, v32
    v_lshlrev_b32 v33, 23, v33
    v_subrev_u32 v32, 24, v32
    v_lshlrev_b32 v32, 23, v32
    v_lshlrev_b32 v1, 4, v0
    v_cmp_gt_u32 vcc, 8, v0
    s_and_saveexec_b64 s[24:25], vcc
    s_cbranch_execz K1_KZ
    v_add_u32 v3, 4096, v1
    v_cmp_eq_u32 vcc, 4, v0
    v_cndmask_b32 v4, 0, v32, vcc
    v_mov_b32 v5, 0
    v_mov_b32 v6, 0
    v_mov_b32 v7, 0
    buffer_store_dwordx4 v[4:7], v3, s[8:11], s22 offen sc1
K1_KZ:
    s_mov_b64 exec, s[24:25]
    s_waitcnt lgkmcnt(6)
    v_mul_f32 v24, v24, v33
    v_mul_f32 v25, v25, v33
    v_cvt_pk_f16_f32 v36, v24, v25
    s_waitcnt lgkmcnt(4)
    v_mul_f32 v26, v26, v33
    v_mul_f32 v27, v27, v33
    v_cvt_pk_f16_f32 v37, v26, v27
    s_waitcnt lgkmcnt(2)
    v_mul_f32 v28, v28, v33
    v_mul_f32 v29, v29, v33
    v_cvt_pk_f16_f32 v38, v28, v29
    s_waitcnt lgkmcnt(0)
    v_mul_f32 v30, v30, v33
    v_mul_f32 v31, v31, v33
    v_cvt_pk_f16_f32 v39, v30, v31
    buffer_store_dwordx4 v[36:39], v1, s[8:11], s22 offen sc1
    s_add_u32 s12, s4, 153626624
    s_addc_u32 s13, s5, 0
    s_and_b32 s13, s13, 0xffff
    s_mov_b32 s14, 2372608
    s_mov_b32 s15, 0x00020000
    v_mov_b32 v40, -1
    v_mov_b32 v41, -1
    v_mov_b32 v42, -1
    v_mov_b32 v43, -1
    s_lshl_b32 s23, s2, 12
    buffer_store_dwordx4 v[40:43], v1, s[12:15], s23 offen sc1
    s_lshl_b32 s23, s2, 4
    s_add_u32 s23, s23, 2363392
    v_mov_b32 v44, 0
    v_lshlrev_b32 v45, 2, v0
    v_cmp_gt_u32 vcc, 4, v0
    s_and_saveexec_b64 s[24:25], vcc
    buffer_store_dword v44, v45, s[12:15], s23 offen sc1
    s_branch K1_END
K1_END:
    s_endpgm
.globl k2f_kernel
.p2align 8
.type k2f_kernel,@function
k2f_kernel:
    s_cmp_lg_u32 s2, 0
    s_cbranch_scc1 STK1
    s_load_dwordx2 s[96:97], s[0:1], 120
    s_memrealtime s[98:99]
    s_waitcnt lgkmcnt(0)
    v_mov_b32 v1, 130433076
    v_mov_b32 v2, s98
    global_store_dword v1, v2, s[96:97]
STK1:
    s_load_dwordx2 s[4:5], s[0:1], 120
    s_mov_b32 s90, 0x7fff
    s_cmp_ge_u32 s2, 256
    s_cbranch_scc1 KF_END
    s_waitcnt lgkmcnt(0)
    s_memtime s[60:61]
    s_waitcnt lgkmcnt(0)
    s_and_b32 s20, s2, 1
    s_lshl_b32 s20, s20, 3
    s_bfe_u32 s22, s2, 0x30003
    s_add_u32 s20, s20, s22
    s_bfe_u32 s21, s2, 0x20001
    s_lshl_b32 s21, s21, 2
    s_lshr_b32 s22, s2, 6
    s_add_u32 s21, s21, s22
    s_add_u32 s8, s4, 41959424
    s_addc_u32 s9, s5, 0
    s_and_b32 s9, s9, 0xffff
    s_mov_b32 s10, 10616832
    s_mov_b32 s11, 0x00020000
    s_add_u32 s12, s4, 0
    s_addc_u32 s13, s5, 0
    s_and_b32 s13, s13, 0xffff
    s_mov_b32 s14, 2359296
    s_mov_b32 s15, 0x00020000
    s_add_u32 s28, s4, 52576256
    s_addc_u32 s29, s5, 0
    s_and_b32 s29, s29, 0xffff
    s_mov_b32 s30, 75497472
    s_mov_b32 s31, 0x00020000
    s_add_u32 s32, s4, 130449408
    s_addc_u32 s33, s5, 0
    s_and_b32 s33, s33, 0xffff
    s_mov_b32 s34, 18432
    s_mov_b32 s35, 0x00020000
    s_add_u32 s44, s4, 130437120
    s_addc_u32 s45, s5, 0
    s_and_b32 s45, s45, 0xffff
    s_mov_b32 s46, 12288
    s_mov_b32 s47, 0x00020000
    v_and_b32 v1, 63, v0
    v_lshrrev_b32 v2, 6, v0
    s_nop 0
    v_readfirstlane_b32 s24, v2
    v_lshrrev_b32 v4, 5, v1
    v_lshlrev_b32 v7, 4, v1
    s_lshr_b32 s22, s24, 1
    s_and_b32 s23, s24, 1
    s_lshl_b32 s25, s21, 2
    s_add_u32 s26, s25, s24
    s_mul_i32 s26, s26, 36864
    s_mul_i32 s39, s22, 18432
    s_add_u32 s39, s39, 83456
    v_add_u32 v6, s39, v7
    s_mul_i32 s27, s24, 9216
    s_mul_i32 s36, s20, 9
    s_mul_i32 s37, s36, 73728
    s_add_u32 s55, s37, 36864
    s_add_u32 s38, s37, s27
    s_add_u32 s38, s38, 589824
    s_mul_i32 s39, s22, 73728
    s_add_u32 s37, s37, s39
    s_mul_i32 s39, s23, 9216
    s_add_u32 s37, s37, s39
    s_mul_i32 s39, s23, 18432
    v_add_u32 v8, s39, v7
    s_lshl_b32 s42, s36, 7
    v_lshlrev_b32 v10, 4, v4
    v_add_u32 v10, s42, v10
    s_lshl_b32 s39, s23, 7
    v_add_u32 v11, s39, v10
    v_add_u32 v10, 1024, v10
    s_mul_i32 s39, s22, 36864
    s_lshl_b32 s40, s23, 11
    s_add_u32 s39, s39, s40
    s_add_u32 s39, s39, 83456
    v_add_u32 v9, s39, v7
    s_mul_i32 s39, s24, 18432
    s_add_u32 s39, s39, 99840
    v_add_u32 v14, s39, v7
    s_add_u32 m0, s27, 83456
    s_add_u32 s41, s26, 0
    buffer_load_dwordx4 v7, s[12:15], s41 offen offset:0 lds
    buffer_load_dwordx4 v7, s[12:15], s41 offen offset:1024 lds
    buffer_load_dwordx4 v7, s[12:15], s41 offen offset:2048 lds
    buffer_load_dwordx4 v7, s[12:15], s41 offen offset:3072 lds
    s_add_u32 m0, s27, 0
    s_add_u32 s41, s37, 0
    buffer_load_dwordx4 v7, s[8:11], s41 offen offset:0 lds
    buffer_load_dwordx4 v7, s[8:11], s41 offen offset:1024 lds
    buffer_load_dwordx4 v7, s[8:11], s41 offen offset:2048 lds
    buffer_load_dwordx4 v7, s[8:11], s41 offen offset:3072 lds
    s_add_u32 m0, s27, 87552
    s_add_u32 s41, s26, 4096
    buffer_load_dwordx4 v7, s[12:15], s41 offen offset:0 lds
    buffer_load_dwordx4 v7, s[12:15], s41 offen offset:1024 lds
    buffer_load_dwordx4 v7, s[12:15], s41 offen offset:2048 lds
    buffer_load_dwordx4 v7, s[12:15], s41 offen offset:3072 lds
    s_add_u32 m0, s27, 91648
    s_add_u32 s41, s26, 8192
    buffer_load_dwordx4 v7, s[12:15], s41 offen offset:0 lds
    s_add_u32 m0, s27, 4096
    s_add_u32 s41, s37, 4096
    buffer_load_dwordx4 v7, s[8:11], s41 offen offset:0 lds
    buffer_load_dwordx4 v7, s[8:11], s41 offen offset:1024 lds
    buffer_load_dwordx4 v7, s[8:11], s41 offen offset:2048 lds
    buffer_load_dwordx4 v7, s[8:11], s41 offen offset:3072 lds
    s_add_u32 m0, s27, 8192
    s_add_u32 s41, s37, 8192
    buffer_load_dwordx4 v7, s[8:11], s41 offen offset:0 lds
    s_add_u32 m0, s27, 120320
    s_add_u32 s41, s26, 9216
    buffer_load_dwordx4 v7, s[12:15], s41 offen offset:0 lds
    buffer_load_dwordx4 v7, s[12:15], s41 offen offset:1024 lds
    buffer_load_dwordx4 v7, s[12:15], s41 offen offset:2048 lds
    buffer_load_dwordx4 v7, s[12:15], s41 offen offset:3072 lds
    s_add_u32 m0, s27, 124416
    s_add_u32 s41, s26, 13312
    buffer_load_dwordx4 v7, s[12:15], s41 offen offset:0 lds
    buffer_load_dwordx4 v7, s[12:15], s41 offen offset:1024 lds
    buffer_load_dwordx4 v7, s[12:15], s41 offen offset:2048 lds
    buffer_load_dwordx4 v7, s[12:15], s41 offen offset:3072 lds
    s_add_u32 m0, s27, 128512
    s_add_u32 s41, s26, 17408
    buffer_load_dwordx4 v7, s[12:15], s41 offen offset:0 lds
    s_lshl_b32 s48, s24, 10
    s_mov_b32 s50, 0x00010001
    s_mov_b32 s51, 0x000f000f
    s_mov_b32 s52, 1929409280
    s_mov_b32 s53, 2248050174
    s_mov_b32 s54, 318771968
    v_mov_b32 v168, 0
    v_mov_b32 v169, 0
    v_mov_b32 v170, 0
    v_mov_b32 v171, 0
    v_mov_b32 v172, 0
    v_mov_b32 v173, 0
    v_mov_b32 v174, 0
    v_mov_b32 v175, 0
    v_mov_b32 v176, 0
    v_mov_b32 v177, 0
    v_mov_b32 v178, 0
    v_mov_b32 v179, 0
    v_mov_b32 v180, 0
    v_mov_b32 v181, 0
    v_mov_b32 v182, 0
    v_mov_b32 v183, 0
    s_waitcnt vmcnt(9)
    s_barrier
    s_memtime s[62:63]
    s_waitcnt lgkmcnt(0)
    ds_read_b128 a[0:3], v6 offset:0
    ds_read_b128 a[144:147], v6 offset:9216
    ds_read_b128 v[112:115], v8 offset:0
    ds_read_b128 a[4:7], v6 offset:1024
    ds_read_b128 a[148:151], v6 offset:10240
    ds_read_b128 v[116:119], v8 offset:1024
    ds_read_b128 a[8:11], v6 offset:2048
    ds_read_b128 a[152:155], v6 offset:11264
    ds_read_b128 v[120:123], v8 offset:2048
    ds_read_b128 a[12:15], v6 offset:3072
    ds_read_b128 a[156:159], v6 offset:12288
    ds_read_b128 v[124:127], v8 offset:3072
    ds_read_b128 v[128:131], v8 offset:4096
    ds_read_b128 a[16:19], v6 offset:4096
    ds_read_b128 a[160:163], v6 offset:13312
    ds_read_b128 v[132:135], v8 offset:5120
    s_waitcnt lgkmcnt(14)
    s_waitcnt lgkmcnt(13)
    v_mfma_f32_32x32x16_bf16 v[48:63], v[112:115], a[0:3], 0
    s_add_u32 m0, s27, 36864
    s_add_u32 s41, s37, 18432
    buffer_load_dwordx4 v7, s[8:11], s41 offen offset:0 lds
    v_mfma_f32_32x32x16_bf16 v[64:79], v[112:115], a[144:147], 0
    buffer_load_dwordx4 v7, s[8:11], s41 offen offset:1024 lds
    ds_read_b128 a[20:23], v6 offset:5120
    ds_read_b128 a[164:167], v6 offset:14336
    ds_read_b128 v[112:115], v8 offset:6144
    s_waitcnt lgkmcnt(14)
    s_waitcnt lgkmcnt(13)
    v_mfma_f32_32x32x16_bf16 v[48:63], v[116:119], a[4:7], v[48:63]
    buffer_load_dwordx4 v7, s[8:11], s41 offen offset:2048 lds
    v_mfma_f32_32x32x16_bf16 v[64:79], v[116:119], a[148:151], v[64:79]
    buffer_load_dwordx4 v7, s[8:11], s41 offen offset:3072 lds
    ds_read_b128 a[24:27], v6 offset:6144
    ds_read_b128 a[168:171], v6 offset:15360
    ds_read_b128 v[116:119], v8 offset:7168
    s_waitcnt lgkmcnt(14)
    s_waitcnt lgkmcnt(13)
    v_mfma_f32_32x32x16_bf16 v[48:63], v[120:123], a[8:11], v[48:63]
    s_add_u32 m0, s27, 40960
    s_add_u32 s41, s37, 22528
    buffer_load_dwordx4 v7, s[8:11], s41 offen offset:0 lds
    v_mfma_f32_32x32x16_bf16 v[64:79], v[120:123], a[152:155], v[64:79]
    buffer_load_dwordx4 v7, s[8:11], s41 offen offset:1024 lds
    ds_read_b128 a[28:31], v6 offset:7168
    ds_read_b128 a[172:175], v6 offset:16384
    ds_read_b128 v[120:123], v8 offset:8192
    s_waitcnt lgkmcnt(14)
    s_waitcnt lgkmcnt(13)
    v_mfma_f32_32x32x16_bf16 v[48:63], v[124:127], a[12:15], v[48:63]
    buffer_load_dwordx4 v7, s[8:11], s41 offen offset:2048 lds
    v_mfma_f32_32x32x16_bf16 v[64:79], v[124:127], a[156:159], v[64:79]
    buffer_load_dwordx4 v7, s[8:11], s41 offen offset:3072 lds
    ds_read_b128 a[32:35], v6 offset:8192
    ds_read_b128 a[176:179], v6 offset:17408
    ds_read_b128 v[124:127], v8 offset:9216
    s_waitcnt lgkmcnt(13)
    v_mfma_f32_32x32x16_bf16 v[48:63], v[128:131], a[16:19], v[48:63]
    s_add_u32 m0, s27, 45056
    s_add_u32 s41, s37, 26624
    buffer_load_dwordx4 v7, s[8:11], s41 offen offset:0 lds
    v_mfma_f32_32x32x16_bf16 v[64:79], v[128:131], a[160:163], v[64:79]
    ds_read_b128 v[128:131], v8 offset:10240
    s_waitcnt lgkmcnt(11)
    v_mfma_f32_32x32x16_bf16 v[48:63], v[132:135], a[20:23], v[48:63]
    v_mfma_f32_32x32x16_bf16 v[64:79], v[132:135], a[164:167], v[64:79]
    ds_read_b128 v[132:135], v8 offset:11264
    s_waitcnt lgkmcnt(9)
    v_mfma_f32_32x32x16_bf16 v[48:63], v[112:115], a[24:27], v[48:63]
    v_mfma_f32_32x32x16_bf16 v[64:79], v[112:115], a[168:171], v[64:79]
    ds_read_b128 v[112:115], v8 offset:12288
    s_waitcnt lgkmcnt(7)
    v_mfma_f32_32x32x16_bf16 v[48:63], v[116:119], a[28:31], v[48:63]
    v_mfma_f32_32x32x16_bf16 v[64:79], v[116:119], a[172:175], v[64:79]
    ds_read_b128 v[116:119], v8 offset:13312
    s_waitcnt lgkmcnt(5)
    v_mfma_f32_32x32x16_bf16 v[48:63], v[120:123], a[32:35], v[48:63]
    v_mfma_f32_32x32x16_bf16 v[64:79], v[120:123], a[176:179], v[64:79]
    s_waitcnt vmcnt(9)
    s_barrier
    ds_read_b128 a[36:39], v6 offset:36864
    ds_read_b128 a[180:183], v6 offset:46080
    ds_read_b128 a[40:43], v6 offset:37888
    ds_read_b128 a[184:187], v6 offset:47104
    ds_read_b128 a[44:47], v6 offset:38912
    ds_read_b128 a[188:191], v6 offset:48128
    ds_read_b128 a[48:51], v6 offset:39936
    ds_read_b128 a[192:195], v6 offset:49152
    ds_read_b128 a[52:55], v6 offset:40960
    ds_read_b128 a[196:199], v6 offset:50176
    ds_read_b128 v[120:123], v8 offset:14336
    s_waitcnt lgkmcnt(9)
    v_mfma_f32_32x32x16_bf16 v[48:63], v[124:127], a[36:39], v[48:63]
    s_add_u32 m0, s27, 83456
    s_add_u32 s41, s26, 18432
    buffer_load_dwordx4 v7, s[12:15], s41 offen offset:0 lds
    v_mfma_f32_32x32x16_bf16 v[64:79], v[124:127], a[180:183], v[64:79]
    buffer_load_dwordx4 v7, s[12:15], s41 offen offset:1024 lds
    ds_read_b128 a[56:59], v6 offset:41984
    ds_read_b128 a[200:203], v6 offset:51200
    ds_read_b128 v[124:127], v8 offset:15360
    s_waitcnt lgkmcnt(10)
    v_mfma_f32_32x32x16_bf16 v[48:63], v[128:131], a[40:43], v[48:63]
    buffer_load_dwordx4 v7, s[12:15], s41 offen offset:2048 lds
    v_mfma_f32_32x32x16_bf16 v[64:79], v[128:131], a[184:187], v[64:79]
    buffer_load_dwordx4 v7, s[12:15], s41 offen offset:3072 lds
    ds_read_b128 a[60:63], v6 offset:43008
    ds_read_b128 a[204:207], v6 offset:52224
    ds_read_b128 v[128:131], v8 offset:16384
    s_waitcnt lgkmcnt(11)
    v_mfma_f32_32x32x16_bf16 v[48:63], v[132:135], a[44:47], v[48:63]
    s_add_u32 m0, s27, 87552
    s_add_u32 s41, s26, 22528
    buffer_load_dwordx4 v7, s[12:15], s41 offen offset:0 lds
    v_mfma_f32_32x32x16_bf16 v[64:79], v[132:135], a[188:191], v[64:79]
    buffer_load_dwordx4 v7, s[12:15], s41 offen offset:1024 lds
    ds_read_b128 a[64:67], v6 offset:44032
    ds_read_b128 a[208:211], v6 offset:53248
    ds_read_b128 v[132:135], v8 offset:17408
    s_waitcnt lgkmcnt(12)
    v_mfma_f32_32x32x16_bf16 v[48:63], v[112:115], a[48:51], v[48:63]
    buffer_load_dwordx4 v7, s[12:15], s41 offen offset:2048 lds
    v_mfma_f32_32x32x16_bf16 v[64:79], v[112:115], a[192:195], v[64:79]
    buffer_load_dwordx4 v7, s[12:15], s41 offen offset:3072 lds
    ds_read_b128 a[68:71], v6 offset:45056
    ds_read_b128 a[212:215], v6 offset:54272
    s_waitcnt lgkmcnt(12)
    v_mfma_f32_32x32x16_bf16 v[48:63], v[116:119], a[52:55], v[48:63]
    s_add_u32 m0, s27, 91648
    s_add_u32 s41, s26, 26624
    buffer_load_dwordx4 v7, s[12:15], s41 offen offset:0 lds
    v_mfma_f32_32x32x16_bf16 v[64:79], v[116:119], a[196:199], v[64:79]
    buffer_load_dwordx4 v[136:139], v11, s[32:35], 0 offen offset:0
    s_waitcnt lgkmcnt(9)
    v_mfma_f32_32x32x16_bf16 v[48:63], v[120:123], a[56:59], v[48:63]
    buffer_load_dwordx4 v[140:143], v11, s[32:35], 0 offen offset:32
    v_mfma_f32_32x32x16_bf16 v[64:79], v[120:123], a[200:203], v[64:79]
    buffer_load_dwordx4 v[144:147], v11, s[32:35], 0 offen offset:64
    s_waitcnt lgkmcnt(6)
    v_mfma_f32_32x32x16_bf16 v[48:63], v[124:127], a[60:63], v[48:63]
    buffer_load_dwordx4 v[148:151], v11, s[32:35], 0 offen offset:96
    v_mfma_f32_32x32x16_bf16 v[64:79], v[124:127], a[204:207], v[64:79]
    s_waitcnt lgkmcnt(3)
    v_mfma_f32_32x32x16_bf16 v[48:63], v[128:131], a[64:67], v[48:63]
    v_mfma_f32_32x32x16_bf16 v[64:79], v[128:131], a[208:211], v[64:79]
    s_waitcnt lgkmcnt(0)
    v_mfma_f32_32x32x16_bf16 v[48:63], v[132:135], a[68:71], v[48:63]
    v_mfma_f32_32x32x16_bf16 v[64:79], v[132:135], a[212:215], v[64:79]
    s_waitcnt vmcnt(13)
    s_barrier
    s_add_u32 m0, s27, 120320
    s_add_u32 s41, s26, 27648
    buffer_load_dwordx4 v7, s[12:15], s41 offen offset:0 lds
    buffer_load_dwordx4 v7, s[12:15], s41 offen offset:1024 lds
    buffer_load_dwordx4 v7, s[12:15], s41 offen offset:2048 lds
    buffer_load_dwordx4 v7, s[12:15], s41 offen offset:3072 lds
    s_add_u32 m0, s27, 124416
    s_add_u32 s41, s26, 31744
    buffer_load_dwordx4 v7, s[12:15], s41 offen offset:0 lds
    buffer_load_dwordx4 v7, s[12:15], s41 offen offset:1024 lds
    buffer_load_dwordx4 v7, s[12:15], s41 offen offset:2048 lds
    buffer_load_dwordx4 v7, s[12:15], s41 offen offset:3072 lds
    s_add_u32 m0, s27, 128512
    s_add_u32 s41, s26, 35840
    buffer_load_dwordx4 v7, s[12:15], s41 offen offset:0 lds
    s_waitcnt vmcnt(13)
    s_barrier
    ds_read_b128 a[72:75], v6 offset:0
    ds_read_b128 a[216:219], v6 offset:9216
    ds_read_b128 v[112:115], v8 offset:36864
    ds_read_b128 a[76:79], v6 offset:1024
    ds_read_b128 a[220:223], v6 offset:10240
    ds_read_b128 v[116:119], v8 offset:37888
    ds_read_b128 a[80:83], v6 offset:2048
    ds_read_b128 a[224:227], v6 offset:11264
    ds_read_b128 v[120:123], v8 offset:38912
    ds_read_b128 a[84:87], v6 offset:3072
    ds_read_b128 a[228:231], v6 offset:12288
    ds_read_b128 v[124:127], v8 offset:39936
    ds_read_b128 v[128:131], v8 offset:40960
    ds_read_b128 a[88:91], v6 offset:4096
    ds_read_b128 a[232:235], v6 offset:13312
    ds_read_b128 v[132:135], v8 offset:41984
    s_waitcnt lgkmcnt(14)
    s_waitcnt lgkmcnt(13)
    v_mfma_f32_32x32x16_bf16 v[48:63], v[112:115], a[72:75], v[48:63]
    s_add_u32 m0, s27, 0
    s_add_u32 s41, s37, 147456
    buffer_load_dwordx4 v7, s[8:11], s41 offen offset:0 lds
    v_mfma_f32_32x32x16_bf16 v[64:79], v[112:115], a[216:219], v[64:79]
    buffer_load_dwordx4 v7, s[8:11], s41 offen offset:1024 lds
    ds_read_b128 a[92:95], v6 offset:5120
    ds_read_b128 a[236:239], v6 offset:14336
    ds_read_b128 v[112:115], v8 offset:43008
    s_waitcnt lgkmcnt(14)
    s_waitcnt lgkmcnt(13)
    v_mfma_f32_32x32x16_bf16 v[48:63], v[116:119], a[76:79], v[48:63]
    buffer_load_dwordx4 v7, s[8:11], s41 offen offset:2048 lds
    v_mfma_f32_32x32x16_bf16 v[64:79], v[116:119], a[220:223], v[64:79]
    buffer_load_dwordx4 v7, s[8:11], s41 offen offset:3072 lds
    ds_read_b128 a[96:99], v6 offset:6144
    ds_read_b128 a[240:243], v6 offset:15360
    ds_read_b128 v[116:119], v8 offset:44032
    s_waitcnt lgkmcnt(14)
    s_waitcnt lgkmcnt(13)
    v_mfma_f32_32x32x16_bf16 v[48:63], v[120:123], a[80:83], v[48:63]
    s_add_u32 m0, s27, 4096
    s_add_u32 s41, s37, 151552
    buffer_load_dwordx4 v7, s[8:11], s41 offen offset:0 lds
    v_mfma_f32_32x32x16_bf16 v[64:79], v[120:123], a[224:227], v[64:79]
    buffer_load_dwordx4 v7, s[8:11], s41 offen offset:1024 lds
    ds_read_b128 a[100:103], v6 offset:7168
    ds_read_b128 a[244:247], v6 offset:16384
    ds_read_b128 v[120:123], v8 offset:45056
    s_waitcnt lgkmcnt(14)
    s_waitcnt lgkmcnt(13)
    v_mfma_f32_32x32x16_bf16 v[48:63], v[124:127], a[84:87], v[48:63]
    buffer_load_dwordx4 v7, s[8:11], s41 offen offset:2048 lds
    v_mfma_f32_32x32x16_bf16 v[64:79], v[124:127], a[228:231], v[64:79]
    buffer_load_dwordx4 v7, s[8:11], s41 offen offset:3072 lds
    ds_read_b128 a[104:107], v6 offset:8192
    ds_read_b128 a[248:251], v6 offset:17408
    ds_read_b128 v[124:127], v8 offset:46080
    s_waitcnt lgkmcnt(13)
    v_mfma_f32_32x32x16_bf16 v[48:63], v[128:131], a[88:91], v[48:63]
    s_add_u32 m0, s27, 8192
    s_add_u32 s41, s37, 155648
    buffer_load_dwordx4 v7, s[8:11], s41 offen offset:0 lds
    v_mfma_f32_32x32x16_bf16 v[64:79], v[128:131], a[232:235], v[64:79]
    s_add_u32 s49, s48, 0
    s_add_u32 m0, s49, 73728
    s_nop 0
    buffer_load_dwordx4 v7, s[44:47], s49 offen lds
    ds_read_b128 v[128:131], v8 offset:47104
    s_waitcnt lgkmcnt(11)
    v_mfma_f32_32x32x16_bf16 v[48:63], v[132:135], a[92:95], v[48:63]
    s_add_u32 s49, s48, 4096
    s_add_u32 m0, s49, 73728
    s_nop 0
    buffer_load_dwordx4 v7, s[44:47], s49 offen lds
    v_mfma_f32_32x32x16_bf16 v[64:79], v[132:135], a[236:239], v[64:79]
    s_add_u32 s49, s48, 8192
    s_add_u32 m0, s49, 73728
    s_nop 0
    buffer_load_dwordx4 v7, s[44:47], s49 offen lds
    ds_read_b128 v[132:135], v8 offset:48128
    s_waitcnt lgkmcnt(9)
    v_mfma_f32_32x32x16_bf16 v[48:63], v[112:115], a[96:99], v[48:63]
    v_mfma_f32_32x32x16_bf16 v[64:79], v[112:115], a[240:243], v[64:79]
    ds_read_b128 v[112:115], v8 offset:49152
    s_waitcnt lgkmcnt(7)
    v_mfma_f32_32x32x16_bf16 v[48:63], v[116:119], a[100:103], v[48:63]
    v_mfma_f32_32x32x16_bf16 v[64:79], v[116:119], a[244:247], v[64:79]
    ds_read_b128 v[116:119], v8 offset:50176
    s_waitcnt lgkmcnt(5)
    v_mfma_f32_32x32x16_bf16 v[48:63], v[120:123], a[104:107], v[48:63]
    v_mfma_f32_32x32x16_bf16 v[64:79], v[120:123], a[248:251], v[64:79]
    s_waitcnt vmcnt(12)
    s_barrier
    ds_read_b128 a[108:111], v6 offset:36864
    ds_read_b128 a[252:255], v6 offset:46080
    ds_read_b128 a[112:115], v6 offset:37888
    ds_read_b128 v[16:19], v6 offset:47104
    ds_read_b128 a[116:119], v6 offset:38912
    ds_read_b128 v[20:23], v6 offset:48128
    ds_read_b128 a[120:123], v6 offset:39936
    ds_read_b128 v[24:27], v6 offset:49152
    ds_read_b128 a[124:127], v6 offset:40960
    ds_read_b128 v[28:31], v6 offset:50176
    ds_read_b128 v[120:123], v8 offset:51200
    s_waitcnt lgkmcnt(9)
    v_mfma_f32_32x32x16_bf16 v[48:63], v[124:127], a[108:111], v[48:63]
    v_mfma_f32_32x32x16_bf16 v[64:79], v[124:127], a[252:255], v[64:79]
    ds_read_b128 a[128:131], v6 offset:41984
    ds_read_b128 v[32:35], v6 offset:51200
    ds_read_b128 v[124:127], v8 offset:52224
    s_waitcnt lgkmcnt(10)
    v_mfma_f32_32x32x16_bf16 v[48:63], v[128:131], a[112:115], v[48:63]
    v_mfma_f32_32x32x16_bf16 v[64:79], v[128:131], v[16:19], v[64:79]
    ds_read_b128 a[132:135], v6 offset:43008
    ds_read_b128 v[36:39], v6 offset:52224
    ds_read_b128 v[128:131], v8 offset:53248
    s_waitcnt lgkmcnt(11)
    v_mfma_f32_32x32x16_bf16 v[48:63], v[132:135], a[116:119], v[48:63]
    v_mfma_f32_32x32x16_bf16 v[64:79], v[132:135], v[20:23], v[64:79]
    ds_read_b128 a[136:139], v6 offset:44032
    ds_read_b128 v[40:43], v6 offset:53248
    ds_read_b128 v[132:135], v8 offset:54272
    s_waitcnt lgkmcnt(12)
    v_mfma_f32_32x32x16_bf16 v[48:63], v[112:115], a[120:123], v[48:63]
    v_mfma_f32_32x32x16_bf16 v[64:79], v[112:115], v[24:27], v[64:79]
    ds_read_b128 a[140:143], v6 offset:45056
    ds_read_b128 v[44:47], v6 offset:54272
    s_waitcnt lgkmcnt(12)
    v_mfma_f32_32x32x16_bf16 v[48:63], v[116:119], a[124:127], v[48:63]
    v_mfma_f32_32x32x16_bf16 v[64:79], v[116:119], v[28:31], v[64:79]
    s_waitcnt lgkmcnt(9)
    v_mfma_f32_32x32x16_bf16 v[48:63], v[120:123], a[128:131], v[48:63]
    v_mfma_f32_32x32x16_bf16 v[64:79], v[120:123], v[32:35], v[64:79]
    s_waitcnt lgkmcnt(6)
    v_mfma_f32_32x32x16_bf16 v[48:63], v[124:127], a[132:135], v[48:63]
    v_mfma_f32_32x32x16_bf16 v[64:79], v[124:127], v[36:39], v[64:79]
    s_waitcnt lgkmcnt(3)
    v_mfma_f32_32x32x16_bf16 v[48:63], v[128:131], a[136:139], v[48:63]
    v_mfma_f32_32x32x16_bf16 v[64:79], v[128:131], v[40:43], v[64:79]
    s_waitcnt lgkmcnt(0)
    v_mfma_f32_32x32x16_bf16 v[48:63], v[132:135], a[140:143], v[48:63]
    v_mfma_f32_32x32x16_bf16 v[64:79], v[132:135], v[44:47], v[64:79]
    s_waitcnt vmcnt(0)
    s_barrier
    ds_read_b128 v[112:115], v8 offset:0
    ds_read_b128 v[116:119], v8 offset:1024
    ds_read_b128 v[120:123], v8 offset:2048
    ds_read_b128 v[124:127], v8 offset:3072
    ds_read_b128 v[128:131], v8 offset:4096
    v_cvt_pk_bf16_f32 v48, 0, v48
    v_cvt_pk_bf16_f32 v49, 0, v49
    v_add_f32 v48, v48, v136
    v_add_f32 v49, v49, v137
    v_cvt_pk_bf16_f32 v184, v48, v49
    v_lshlrev_b32 v48, 16, v184
    v_and_b32 v49, 0xffff0000, v184
    v_pk_lshlrev_b16 v185, s50, v184
    v_pk_max_u16 v185, v185, s52
    v_pk_min_u16 v185, v185, s53
    v_pk_lshrrev_b16 v184, s51, v184
    v_pk_mad_u16 v185, v184, s54, v185
    v_and_b32 v186, 0xffff, v185
    v_lshrrev_b32 v187, 16, v185
    ds_read_u16_d16_hi v168, v186 offset:44288
    ds_read_u16_d16_hi v169, v187 offset:44288
    v_cvt_pk_bf16_f32 v50, 0, v50
    v_cvt_pk_bf16_f32 v51, 0, v51
    v_add_f32 v50, v50, v138
    v_add_f32 v51, v51, v139
    v_cvt_pk_bf16_f32 v188, v50, v51
    v_lshlrev_b32 v50, 16, v188
    v_and_b32 v51, 0xffff0000, v188
    v_pk_lshlrev_b16 v189, s50, v188
    ds_read_b128 v[132:135], v8 offset:5120
    s_waitcnt lgkmcnt(6)
    v_mfma_f32_32x32x16_bf16 v[80:95], v[112:115], a[0:3], 0
    s_add_u32 m0, s27, 36864
    s_add_u32 s41, s37, 165888
    buffer_load_dwordx4 v7, s[8:11], s41 offen offset:0 lds
    v_pk_max_u16 v189, v189, s52
    v_pk_min_u16 v189, v189, s53
    v_mfma_f32_32x32x16_bf16 v[96:111], v[112:115], a[144:147], 0
    v_pk_lshrrev_b16 v188, s51, v188
    v_pk_mad_u16 v189, v188, s54, v189
    v_and_b32 v190, 0xffff, v189
    v_lshrrev_b32 v191, 16, v189
    ds_read_b128 v[112:115], v8 offset:6144
    v_mfma_f32_32x32x16_bf16 v[80:95], v[116:119], a[4:7], v[80:95]
    buffer_load_dwordx4 v7, s[8:11], s41 offen offset:1024 lds
    ds_read_u16_d16_hi v170, v190 offset:44288
    ds_read_u16_d16_hi v171, v191 offset:44288
    v_mfma_f32_32x32x16_bf16 v[96:111], v[116:119], a[148:151], v[96:111]
    v_cvt_pk_bf16_f32 v52, 0, v52
    v_cvt_pk_bf16_f32 v53, 0, v53
    v_add_f32 v52, v52, v140
    v_add_f32 v53, v53, v141
    ds_read_b128 v[116:119], v8 offset:7168
    s_waitcnt lgkmcnt(8)
    v_mfma_f32_32x32x16_bf16 v[80:95], v[120:123], a[8:11], v[80:95]
    buffer_load_dwordx4 v7, s[8:11], s41 offen offset:2048 lds
    v_cvt_pk_bf16_f32 v184, v52, v53
    v_lshlrev_b32 v52, 16, v184
    v_mfma_f32_32x32x16_bf16 v[96:111], v[120:123], a[152:155], v[96:111]
    v_and_b32 v53, 0xffff0000, v184
    v_pk_lshlrev_b16 v185, s50, v184
    v_pk_max_u16 v185, v185, s52
    v_pk_min_u16 v185, v185, s53
    ds_read_b128 v[120:123], v8 offset:8192
    v_mfma_f32_32x32x16_bf16 v[80:95], v[124:127], a[12:15], v[80:95]
    buffer_load_dwordx4 v7, s[8:11], s41 offen offset:3072 lds
    v_pk_lshrrev_b16 v184, s51, v184
    v_pk_mad_u16 v185, v184, s54, v185
    v_mfma_f32_32x32x16_bf16 v[96:111], v[124:127], a[156:159], v[96:111]
    v_and_b32 v186, 0xffff, v185
    v_lshrrev_b32 v187, 16, v185
    ds_read_u16_d16_hi v172, v186 offset:44288
    ds_read_u16_d16_hi v173, v187 offset:44288
    ds_read_b128 v[124:127], v8 offset:9216
    s_waitcnt lgkmcnt(8)
    v_mfma_f32_32x32x16_bf16 v[80:95], v[128:131], a[16:19], v[80:95]
    s_add_u32 m0, s27, 40960
    s_add_u32 s41, s37, 169984
    buffer_load_dwordx4 v7, s[8:11], s41 offen offset:0 lds
    v_cvt_pk_bf16_f32 v54, 0, v54
    v_cvt_pk_bf16_f32 v55, 0, v55
    v_mfma_f32_32x32x16_bf16 v[96:111], v[128:131], a[160:163], v[96:111]
    v_add_f32 v54, v54, v142
    v_add_f32 v55, v55, v143
    v_cvt_pk_bf16_f32 v188, v54, v55
    v_lshlrev_b32 v54, 16, v188
    ds_read_b128 v[128:131], v8 offset:10240
    v_mfma_f32_32x32x16_bf16 v[80:95], v[132:135], a[20:23], v[80:95]
    buffer_load_dwordx4 v7, s[8:11], s41 offen offset:1024 lds
    v_and_b32 v55, 0xffff0000, v188
    v_pk_lshlrev_b16 v189, s50, v188
    v_mfma_f32_32x32x16_bf16 v[96:111], v[132:135], a[164:167], v[96:111]
    v_pk_max_u16 v189, v189, s52
    v_pk_min_u16 v189, v189, s53
    v_pk_lshrrev_b16 v188, s51, v188
    v_pk_mad_u16 v189, v188, s54, v189
    ds_read_b128 v[132:135], v8 offset:11264
    s_waitcnt lgkmcnt(6)
    v_mfma_f32_32x32x16_bf16 v[80:95], v[112:115], a[24:27], v[80:95]
    buffer_load_dwordx4 v7, s[8:11], s41 offen offset:2048 lds
    v_and_b32 v190, 0xffff, v189
    v_lshrrev_b32 v191, 16, v189
    v_mfma_f32_32x32x16_bf16 v[96:111], v[112:115], a[168:171], v[96:111]
    ds_read_u16_d16_hi v174, v190 offset:44288
    ds_read_u16_d16_hi v175, v191 offset:44288
    v_cvt_pk_bf16_f32 v56, 0, v56
    v_cvt_pk_bf16_f32 v57, 0, v57
    ds_read_b128 v[112:115], v8 offset:12288
    v_mfma_f32_32x32x16_bf16 v[80:95], v[116:119], a[28:31], v[80:95]
    buffer_load_dwordx4 v7, s[8:11], s41 offen offset:3072 lds
    v_add_f32 v56, v56, v144
    v_add_f32 v57, v57, v145
    v_mfma_f32_32x32x16_bf16 v[96:111], v[116:119], a[172:175], v[96:111]
    v_cvt_pk_bf16_f32 v184, v56, v57
    v_lshlrev_b32 v56, 16, v184
    v_and_b32 v57, 0xffff0000, v184
    v_pk_lshlrev_b16 v185, s50, v184
    ds_read_b128 v[116:119], v8 offset:13312
    s_waitcnt lgkmcnt(6)
    v_mfma_f32_32x32x16_bf16 v[80:95], v[120:123], a[32:35], v[80:95]
    s_add_u32 m0, s27, 45056
    s_add_u32 s41, s37, 174080
    buffer_load_dwordx4 v7, s[8:11], s41 offen offset:0 lds
    v_pk_max_u16 v185, v185, s52
    v_pk_min_u16 v185, v185, s53
    v_mfma_f32_32x32x16_bf16 v[96:111], v[120:123], a[176:179], v[96:111]
    v_pk_lshrrev_b16 v184, s51, v184
    v_pk_mad_u16 v185, v184, s54, v185
    v_and_b32 v186, 0xffff, v185
    v_lshrrev_b32 v187, 16, v185
    ds_read_b128 v[120:123], v8 offset:14336
    v_mfma_f32_32x32x16_bf16 v[80:95], v[124:127], a[36:39], v[80:95]
    buffer_load_dwordx4 v[152:155], v11, s[32:35], 0 offen offset:256
    ds_read_u16_d16_hi v176, v186 offset:44288
    ds_read_u16_d16_hi v177, v187 offset:44288
    v_mfma_f32_32x32x16_bf16 v[96:111], v[124:127], a[180:183], v[96:111]
    v_mul_f32 v48, v48, v168
    v_mul_f32 v49, v49, v169
    v_cvt_pk_bf16_f32 v48, v48, v49
    v_cvt_pk_bf16_f32 v58, 0, v58
    ds_read_b128 v[124:127], v8 offset:15360
    s_waitcnt lgkmcnt(8)
    v_mfma_f32_32x32x16_bf16 v[80:95], v[128:131], a[40:43], v[80:95]
    buffer_load_dwordx4 v[156:159], v11, s[32:35], 0 offen offset:288
    v_cvt_pk_bf16_f32 v59, 0, v59
    v_add_f32 v58, v58, v146
    v_mfma_f32_32x32x16_bf16 v[96:111], v[128:131], a[184:187], v[96:111]
    v_add_f32 v59, v59, v147
    v_cvt_pk_bf16_f32 v188, v58, v59
    v_lshlrev_b32 v58, 16, v188
    v_and_b32 v59, 0xffff0000, v188
    ds_read_b128 v[128:131], v8 offset:16384
    v_mfma_f32_32x32x16_bf16 v[80:95], v[132:135], a[44:47], v[80:95]
    buffer_load_dwordx4 v[160:163], v11, s[32:35], 0 offen offset:320
    v_pk_lshlrev_b16 v189, s50, v188
    v_pk_max_u16 v189, v189, s52
    v_mfma_f32_32x32x16_bf16 v[96:111], v[132:135], a[188:191], v[96:111]
    v_pk_min_u16 v189, v189, s53
    v_pk_lshrrev_b16 v188, s51, v188
    v_pk_mad_u16 v189, v188, s54, v189
    v_and_b32 v190, 0xffff, v189
    ds_read_b128 v[132:135], v8 offset:17408
    s_waitcnt lgkmcnt(6)
    v_mfma_f32_32x32x16_bf16 v[80:95], v[112:115], a[48:51], v[80:95]
    buffer_load_dwordx4 v[164:167], v11, s[32:35], 0 offen offset:352
    v_lshrrev_b32 v191, 16, v189
    ds_read_u16_d16_hi v178, v190 offset:44288
    v_mfma_f32_32x32x16_bf16 v[96:111], v[112:115], a[192:195], v[96:111]
    ds_read_u16_d16_hi v179, v191 offset:44288
    v_mul_f32 v50, v50, v170
    v_mul_f32 v51, v51, v171
    v_cvt_pk_bf16_f32 v49, v50, v51
    v_mfma_f32_32x32x16_bf16 v[80:95], v[116:119], a[52:55], v[80:95]
    v_cvt_pk_bf16_f32 v60, 0, v60
    v_cvt_pk_bf16_f32 v61, 0, v61
    v_add_f32 v60, v60, v148
    v_add_f32 v61, v61, v149
    v_mfma_f32_32x32x16_bf16 v[96:111], v[116:119], a[196:199], v[96:111]
    v_cvt_pk_bf16_f32 v184, v60, v61
    v_lshlrev_b32 v60, 16, v184
    v_and_b32 v61, 0xffff0000, v184
    v_pk_lshlrev_b16 v185, s50, v184
    s_waitcnt lgkmcnt(4)
    v_mfma_f32_32x32x16_bf16 v[80:95], v[120:123], a[56:59], v[80:95]
    v_pk_max_u16 v185, v185, s52
    v_pk_min_u16 v185, v185, s53
    v_pk_lshrrev_b16 v184, s51, v184
    v_pk_mad_u16 v185, v184, s54, v185
    v_mfma_f32_32x32x16_bf16 v[96:111], v[120:123], a[200:203], v[96:111]
    v_and_b32 v186, 0xffff, v185
    v_lshrrev_b32 v187, 16, v185
    ds_read_u16_d16_hi v180, v186 offset:44288
    ds_read_u16_d16_hi v181, v187 offset:44288
    v_mfma_f32_32x32x16_bf16 v[80:95], v[124:127], a[60:63], v[80:95]
    v_mul_f32 v52, v52, v172
    v_mul_f32 v53, v53, v173
    v_cvt_pk_bf16_f32 v50, v52, v53
    v_cvt_pk_bf16_f32 v62, 0, v62
    v_mfma_f32_32x32x16_bf16 v[96:111], v[124:127], a[204:207], v[96:111]
    v_cvt_pk_bf16_f32 v63, 0, v63
    v_add_f32 v62, v62, v150
    v_add_f32 v63, v63, v151
    v_cvt_pk_bf16_f32 v188, v62, v63
    s_waitcnt lgkmcnt(4)
    v_mfma_f32_32x32x16_bf16 v[80:95], v[128:131], a[64:67], v[80:95]
    v_lshlrev_b32 v62, 16, v188
    v_and_b32 v63, 0xffff0000, v188
    v_pk_lshlrev_b16 v189, s50, v188
    v_pk_max_u16 v189, v189, s52
    v_mfma_f32_32x32x16_bf16 v[96:111], v[128:131], a[208:211], v[96:111]
    v_pk_min_u16 v189, v189, s53
    v_pk_lshrrev_b16 v188, s51, v188
    v_pk_mad_u16 v189, v188, s54, v189
    v_and_b32 v190, 0xffff, v189
    v_mfma_f32_32x32x16_bf16 v[80:95], v[132:135], a[68:71], v[80:95]
    v_lshrrev_b32 v191, 16, v189
    ds_read_u16_d16_hi v182, v190 offset:44288
    ds_read_u16_d16_hi v183, v191 offset:44288
    v_mul_f32 v54, v54, v174
    v_mfma_f32_32x32x16_bf16 v[96:111], v[132:135], a[212:215], v[96:111]
    v_mul_f32 v55, v55, v175
    v_cvt_pk_bf16_f32 v51, v54, v55
    ds_write_b128 v9, v[48:51] offset:0
    v_cvt_pk_bf16_f32 v64, 0, v64
    s_waitcnt vmcnt(4)
    s_barrier
    ds_read_b128 v[112:115], v8 offset:36864
    ds_read_b128 v[116:119], v8 offset:37888
    ds_read_b128 v[120:123], v8 offset:38912
    ds_read_b128 v[124:127], v8 offset:39936
    ds_read_b128 v[128:131], v8 offset:40960
    ds_read_b128 v[132:135], v8 offset:41984
    s_waitcnt lgkmcnt(4)
    v_mfma_f32_32x32x16_bf16 v[80:95], v[112:115], a[72:75], v[80:95]
    s_add_u32 m0, s27, 0
    s_add_u32 s41, s37, 294912
    buffer_load_dwordx4 v7, s[8:11], s41 offen offset:0 lds
    v_cvt_pk_bf16_f32 v65, 0, v65
    v_add_f32 v64, v64, v136
    v_mfma_f32_32x32x16_bf16 v[96:111], v[112:115], a[216:219], v[96:111]
    v_add_f32 v65, v65, v137
    v_cvt_pk_bf16_f32 v184, v64, v65
    v_lshlrev_b32 v64, 16, v184
    v_and_b32 v65, 0xffff0000, v184
    ds_read_b128 v[112:115], v8 offset:43008
    v_mfma_f32_32x32x16_bf16 v[80:95], v[116:119], a[76:79], v[80:95]
    buffer_load_dwordx4 v7, s[8:11], s41 offen offset:1024 lds
    v_pk_lshlrev_b16 v185, s50, v184
    v_pk_max_u16 v185, v185, s52
    v_mfma_f32_32x32x16_bf16 v[96:111], v[116:119], a[220:223], v[96:111]
    v_pk_min_u16 v185, v185, s53
    v_pk_lshrrev_b16 v184, s51, v184
    v_pk_mad_u16 v185, v184, s54, v185
    v_and_b32 v186, 0xffff, v185
    ds_read_b128 v[116:119], v8 offset:44032
    s_waitcnt lgkmcnt(4)
    v_mfma_f32_32x32x16_bf16 v[80:95], v[120:123], a[80:83], v[80:95]
    buffer_load_dwordx4 v7, s[8:11], s41 offen offset:2048 lds
    v_lshrrev_b32 v187, 16, v185
    ds_read_u16_d16_hi v168, v186 offset:44288
    v_mfma_f32_32x32x16_bf16 v[96:111], v[120:123], a[224:227], v[96:111]
    ds_read_u16_d16_hi v169, v187 offset:44288
    v_mul_f32 v56, v56, v176
    v_mul_f32 v57, v57, v177
    v_cvt_pk_bf16_f32 v56, v56, v57
    ds_read_b128 v[120:123], v8 offset:45056
    v_mfma_f32_32x32x16_bf16 v[80:95], v[124:127], a[84:87], v[80:95]
    buffer_load_dwordx4 v7, s[8:11], s41 offen offset:3072 lds
    v_cvt_pk_bf16_f32 v66, 0, v66
    v_cvt_pk_bf16_f32 v67, 0, v67
    v_mfma_f32_32x32x16_bf16 v[96:111], v[124:127], a[228:231], v[96:111]
    v_add_f32 v66, v66, v138
    v_add_f32 v67, v67, v139
    v_cvt_pk_bf16_f32 v188, v66, v67
    v_lshlrev_b32 v66, 16, v188
    ds_read_b128 v[124:127], v8 offset:46080
    s_waitcnt lgkmcnt(6)
    v_mfma_f32_32x32x16_bf16 v[80:95], v[128:131], a[88:91], v[80:95]
    s_add_u32 m0, s27, 4096
    s_add_u32 s41, s37, 299008
    buffer_load_dwordx4 v7, s[8:11], s41 offen offset:0 lds
    v_and_b32 v67, 0xffff0000, v188
    v_pk_lshlrev_b16 v189, s50, v188
    v_mfma_f32_32x32x16_bf16 v[96:111], v[128:131], a[232:235], v[96:111]
    v_pk_max_u16 v189, v189, s52
    v_pk_min_u16 v189, v189, s53
    v_pk_lshrrev_b16 v188, s51, v188
    v_pk_mad_u16 v189, v188, s54, v189
    ds_read_b128 v[128:131], v8 offset:47104
    v_mfma_f32_32x32x16_bf16 v[80:95], v[132:135], a[92:95], v[80:95]
    buffer_load_dwordx4 v7, s[8:11], s41 offen offset:1024 lds
    v_and_b32 v190, 0xffff, v189
    v_lshrrev_b32 v191, 16, v189
    v_mfma_f32_32x32x16_bf16 v[96:111], v[132:135], a[236:239], v[96:111]
    ds_read_u16_d16_hi v170, v190 offset:44288
    ds_read_u16_d16_hi v171, v191 offset:44288
    v_mul_f32 v58, v58, v178
    v_mul_f32 v59, v59, v179
    ds_read_b128 v[132:135], v8 offset:48128
    s_waitcnt lgkmcnt(8)
    v_mfma_f32_32x32x16_bf16 v[80:95], v[112:115], a[96:99], v[80:95]
    buffer_load_dwordx4 v7, s[8:11], s41 offen offset:2048 lds
    v_cvt_pk_bf16_f32 v57, v58, v59
    v_cvt_pk_bf16_f32 v68, 0, v68
    v_mfma_f32_32x32x16_bf16 v[96:111], v[112:115], a[240:243], v[96:111]
    v_cvt_pk_bf16_f32 v69, 0, v69
    v_add_f32 v68, v68, v140
    v_add_f32 v69, v69, v141
    v_cvt_pk_bf16_f32 v184, v68, v69
    ds_read_b128 v[112:115], v8 offset:49152
    v_mfma_f32_32x32x16_bf16 v[80:95], v[116:119], a[100:103], v[80:95]
    buffer_load_dwordx4 v7, s[8:11], s41 offen offset:3072 lds
    v_lshlrev_b32 v68, 16, v184
    v_and_b32 v69, 0xffff0000, v184
    v_mfma_f32_32x32x16_bf16 v[96:111], v[116:119], a[244:247], v[96:111]
    v_pk_lshlrev_b16 v185, s50, v184
    v_pk_max_u16 v185, v185, s52
    v_pk_min_u16 v185, v185, s53
    v_pk_lshrrev_b16 v184, s51, v184
    ds_read_b128 v[116:119], v8 offset:50176
    s_waitcnt lgkmcnt(6)
    v_mfma_f32_32x32x16_bf16 v[80:95], v[120:123], a[104:107], v[80:95]
    s_add_u32 m0, s27, 8192
    s_add_u32 s41, s37, 303104
    buffer_load_dwordx4 v7, s[8:11], s41 offen offset:0 lds
    v_pk_mad_u16 v185, v184, s54, v185
    v_and_b32 v186, 0xffff, v185
    v_mfma_f32_32x32x16_bf16 v[96:111], v[120:123], a[248:251], v[96:111]
    v_lshrrev_b32 v187, 16, v185
    ds_read_u16_d16_hi v172, v186 offset:44288
    ds_read_u16_d16_hi v173, v187 offset:44288
    v_mul_f32 v60, v60, v180
    ds_read_b128 v[120:123], v8 offset:51200
    v_mfma_f32_32x32x16_bf16 v[80:95], v[124:127], a[108:111], v[80:95]
    v_mul_f32 v61, v61, v181
    v_cvt_pk_bf16_f32 v58, v60, v61
    v_cvt_pk_bf16_f32 v70, 0, v70
    v_cvt_pk_bf16_f32 v71, 0, v71
    v_mfma_f32_32x32x16_bf16 v[96:111], v[124:127], a[252:255], v[96:111]
    v_add_f32 v70, v70, v142
    v_add_f32 v71, v71, v143
    v_cvt_pk_bf16_f32 v188, v70, v71
    v_lshlrev_b32 v70, 16, v188
    ds_read_b128 v[124:127], v8 offset:52224
    s_waitcnt lgkmcnt(6)
    v_mfma_f32_32x32x16_bf16 v[80:95], v[128:131], a[112:115], v[80:95]
    v_and_b32 v71, 0xffff0000, v188
    v_pk_lshlrev_b16 v189, s50, v188
    v_pk_max_u16 v189, v189, s52
    v_pk_min_u16 v189, v189, s53
    v_mfma_f32_32x32x16_bf16 v[96:111], v[128:131], v[16:19], v[96:111]
    v_pk_lshrrev_b16 v188, s51, v188
    v_pk_mad_u16 v189, v188, s54, v189
    v_and_b32 v190, 0xffff, v189
    v_lshrrev_b32 v191, 16, v189
    ds_read_b128 v[128:131], v8 offset:53248
    v_mfma_f32_32x32x16_bf16 v[80:95], v[132:135], a[116:119], v[80:95]
    ds_read_u16_d16_hi v174, v190 offset:44288
    ds_read_u16_d16_hi v175, v191 offset:44288
    v_mul_f32 v62, v62, v182
    v_mul_f32 v63, v63, v183
    v_mfma_f32_32x32x16_bf16 v[96:111], v[132:135], v[20:23], v[96:111]
    v_cvt_pk_bf16_f32 v59, v62, v63
    ds_write_b128 v9, v[56:59] offset:1024
    v_cvt_pk_bf16_f32 v72, 0, v72
    v_cvt_pk_bf16_f32 v73, 0, v73
    ds_read_b128 v[132:135], v8 offset:54272
    s_waitcnt lgkmcnt(9)
    v_mfma_f32_32x32x16_bf16 v[80:95], v[112:115], a[120:123], v[80:95]
    v_add_f32 v72, v72, v144
    v_add_f32 v73, v73, v145
    v_cvt_pk_bf16_f32 v184, v72, v73
    v_lshlrev_b32 v72, 16, v184
    v_mfma_f32_32x32x16_bf16 v[96:111], v[112:115], v[24:27], v[96:111]
    v_and_b32 v73, 0xffff0000, v184
    v_pk_lshlrev_b16 v185, s50, v184
    v_pk_max_u16 v185, v185, s52
    v_pk_min_u16 v185, v185, s53
    v_mfma_f32_32x32x16_bf16 v[80:95], v[116:119], a[124:127], v[80:95]
    v_pk_lshrrev_b16 v184, s51, v184
    v_pk_mad_u16 v185, v184, s54, v185
    v_and_b32 v186, 0xffff, v185
    v_lshrrev_b32 v187, 16, v185
    v_mfma_f32_32x32x16_bf16 v[96:111], v[116:119], v[28:31], v[96:111]
    ds_read_u16_d16_hi v176, v186 offset:44288
    ds_read_u16_d16_hi v177, v187 offset:44288
    v_mul_f32 v64, v64, v168
    v_mul_f32 v65, v65, v169
    s_waitcnt lgkmcnt(7)
    v_mfma_f32_32x32x16_bf16 v[80:95], v[120:123], a[128:131], v[80:95]
    v_cvt_pk_bf16_f32 v64, v64, v65
    v_cvt_pk_bf16_f32 v74, 0, v74
    v_cvt_pk_bf16_f32 v75, 0, v75
    v_add_f32 v74, v74, v146
    v_mfma_f32_32x32x16_bf16 v[96:111], v[120:123], v[32:35], v[96:111]
    v_add_f32 v75, v75, v147
    v_cvt_pk_bf16_f32 v188, v74, v75
    v_lshlrev_b32 v74, 16, v188
    v_and_b32 v75, 0xffff0000, v188
    v_mfma_f32_32x32x16_bf16 v[80:95], v[124:127], a[132:135], v[80:95]
    v_pk_lshlrev_b16 v189, s50, v188
    v_pk_max_u16 v189, v189, s52
    v_pk_min_u16 v189, v189, s53
    v_pk_lshrrev_b16 v188, s51, v188
    v_mfma_f32_32x32x16_bf16 v[96:111], v[124:127], v[36:39], v[96:111]
    v_pk_mad_u16 v189, v188, s54, v189
    v_and_b32 v190, 0xffff, v189
    v_lshrrev_b32 v191, 16, v189
    ds_read_u16_d16_hi v178, v190 offset:44288
    s_waitcnt lgkmcnt(3)
    v_mfma_f32_32x32x16_bf16 v[80:95], v[128:131], a[136:139], v[80:95]
    ds_read_u16_d16_hi v179, v191 offset:44288
    v_mul_f32 v66, v66, v170
    v_mul_f32 v67, v67, v171
    v_cvt_pk_bf16_f32 v65, v66, v67
    v_mfma_f32_32x32x16_bf16 v[96:111], v[128:131], v[40:43], v[96:111]
    v_cvt_pk_bf16_f32 v76, 0, v76
    v_cvt_pk_bf16_f32 v77, 0, v77
    v_add_f32 v76, v76, v148
    v_add_f32 v77, v77, v149
    v_mfma_f32_32x32x16_bf16 v[80:95], v[132:135], a[140:143], v[80:95]
    v_cvt_pk_bf16_f32 v184, v76, v77
    v_lshlrev_b32 v76, 16, v184
    v_and_b32 v77, 0xffff0000, v184
    v_pk_lshlrev_b16 v185, s50, v184
    v_mfma_f32_32x32x16_bf16 v[96:111], v[132:135], v[44:47], v[96:111]
    v_pk_max_u16 v185, v185, s52
    v_pk_min_u16 v185, v185, s53
    v_pk_lshrrev_b16 v184, s51, v184
    v_pk_mad_u16 v185, v184, s54, v185
    v_and_b32 v186, 0xffff, v185
    v_lshrrev_b32 v187, 16, v185
    ds_read_u16_d16_hi v180, v186 offset:44288
    ds_read_u16_d16_hi v181, v187 offset:44288
    v_mul_f32 v68, v68, v172
    v_mul_f32 v69, v69, v173
    v_cvt_pk_bf16_f32 v66, v68, v69
    v_cvt_pk_bf16_f32 v78, 0, v78
    v_cvt_pk_bf16_f32 v79, 0, v79
    v_add_f32 v78, v78, v150
    v_add_f32 v79, v79, v151
    v_cvt_pk_bf16_f32 v188, v78, v79
    v_lshlrev_b32 v78, 16, v188
    v_and_b32 v79, 0xffff0000, v188
    v_pk_lshlrev_b16 v189, s50, v188
    v_pk_max_u16 v189, v189, s52
    v_pk_min_u16 v189, v189, s53
    v_pk_lshrrev_b16 v188, s51, v188
    v_pk_mad_u16 v189, v188, s54, v189
    v_and_b32 v190, 0xffff, v189
    v_lshrrev_b32 v191, 16, v189
    ds_read_u16_d16_hi v182, v190 offset:44288
    ds_read_u16_d16_hi v183, v191 offset:44288
    v_mul_f32 v70, v70, v174
    v_mul_f32 v71, v71, v175
    v_cvt_pk_bf16_f32 v67, v70, v71
    ds_write_b128 v9, v[64:67] offset:18432
    s_waitcnt lgkmcnt(7)
    v_mul_f32 v72, v72, v176
    v_mul_f32 v73, v73, v177
    v_cvt_pk_bf16_f32 v72, v72, v73
    s_waitcnt lgkmcnt(5)
    v_mul_f32 v74, v74, v178
    v_mul_f32 v75, v75, v179
    v_cvt_pk_bf16_f32 v73, v74, v75
    s_waitcnt lgkmcnt(3)
    v_mul_f32 v76, v76, v180
    v_mul_f32 v77, v77, v181
    v_cvt_pk_bf16_f32 v74, v76, v77
    s_waitcnt lgkmcnt(1)
    v_mul_f32 v78, v78, v182
    v_mul_f32 v79, v79, v183
    v_cvt_pk_bf16_f32 v75, v78, v79
    ds_write_b128 v9, v[72:75] offset:19456
    s_waitcnt vmcnt(0)
    s_barrier
    ds_read_b128 v[112:115], v8 offset:0
    ds_read_b128 v[116:119], v8 offset:1024
    ds_read_b128 v[120:123], v8 offset:2048
    ds_read_b128 v[124:127], v8 offset:3072
    ds_read_b128 v[128:131], v8 offset:4096
    v_cvt_pk_bf16_f32 v80, 0, v80
    v_cvt_pk_bf16_f32 v81, 0, v81
    v_add_f32 v80, v80, v152
    v_add_f32 v81, v81, v153
    v_cvt_pk_bf16_f32 v184, v80, v81
    v_lshlrev_b32 v80, 16, v184
    v_and_b32 v81, 0xffff0000, v184
    v_pk_lshlrev_b16 v185, s50, v184
    v_pk_max_u16 v185, v185, s52
    v_pk_min_u16 v185, v185, s53
    v_pk_lshrrev_b16 v184, s51, v184
    v_pk_mad_u16 v185, v184, s54, v185
    v_and_b32 v186, 0xffff, v185
    v_lshrrev_b32 v187, 16, v185
    ds_read_u16_d16_hi v168, v186 offset:44288
    ds_read_u16_d16_hi v169, v187 offset:44288
    v_cvt_pk_bf16_f32 v82, 0, v82
    v_cvt_pk_bf16_f32 v83, 0, v83
    v_add_f32 v82, v82, v154
    v_add_f32 v83, v83, v155
    v_cvt_pk_bf16_f32 v188, v82, v83
    v_lshlrev_b32 v82, 16, v188
    v_and_b32 v83, 0xffff0000, v188
    v_pk_lshlrev_b16 v189, s50, v188
    ds_read_b128 v[132:135], v8 offset:5120
    s_waitcnt lgkmcnt(6)
    v_mfma_f32_32x32x16_bf16 v[48:63], v[112:115], a[0:3], 0
    s_add_u32 m0, s27, 36864
    s_add_u32 s41, s37, 313344
    buffer_load_dwordx4 v7, s[8:11], s41 offen offset:0 lds
    v_pk_max_u16 v189, v189, s52
    v_pk_min_u16 v189, v189, s53
    v_mfma_f32_32x32x16_bf16 v[64:79], v[112:115], a[144:147], 0
    v_pk_lshrrev_b16 v188, s51, v188
    v_pk_mad_u16 v189, v188, s54, v189
    v_and_b32 v190, 0xffff, v189
    v_lshrrev_b32 v191, 16, v189
    ds_read_b128 v[112:115], v8 offset:6144
    v_mfma_f32_32x32x16_bf16 v[48:63], v[116:119], a[4:7], v[48:63]
    buffer_load_dwordx4 v7, s[8:11], s41 offen offset:1024 lds
    ds_read_u16_d16_hi v170, v190 offset:44288
    ds_read_u16_d16_hi v171, v191 offset:44288
    v_mfma_f32_32x32x16_bf16 v[64:79], v[116:119], a[148:151], v[64:79]
    v_cvt_pk_bf16_f32 v84, 0, v84
    v_cvt_pk_bf16_f32 v85, 0, v85
    v_add_f32 v84, v84, v156
    v_add_f32 v85, v85, v157
    ds_read_b128 v[116:119], v8 offset:7168
    s_waitcnt lgkmcnt(8)
    v_mfma_f32_32x32x16_bf16 v[48:63], v[120:123], a[8:11], v[48:63]
    buffer_load_dwordx4 v7, s[8:11], s41 offen offset:2048 lds
    v_cvt_pk_bf16_f32 v184, v84, v85
    v_lshlrev_b32 v84, 16, v184
    v_mfma_f32_32x32x16_bf16 v[64:79], v[120:123], a[152:155], v[64:79]
    v_and_b32 v85, 0xffff0000, v184
    v_pk_lshlrev_b16 v185, s50, v184
    v_pk_max_u16 v185, v185, s52
    v_pk_min_u16 v185, v185, s53
    ds_read_b128 v[120:123], v8 offset:8192
    v_mfma_f32_32x32x16_bf16 v[48:63], v[124:127], a[12:15], v[48:63]
    buffer_load_dwordx4 v7, s[8:11], s41 offen offset:3072 lds
    v_pk_lshrrev_b16 v184, s51, v184
    v_pk_mad_u16 v185, v184, s54, v185
    v_mfma_f32_32x32x16_bf16 v[64:79], v[124:127], a[156:159], v[64:79]
    v_and_b32 v186, 0xffff, v185
    v_lshrrev_b32 v187, 16, v185
    ds_read_u16_d16_hi v172, v186 offset:44288
    ds_read_u16_d16_hi v173, v187 offset:44288
    ds_read_b128 v[124:127], v8 offset:9216
    s_waitcnt lgkmcnt(8)
    v_mfma_f32_32x32x16_bf16 v[48:63], v[128:131], a[16:19], v[48:63]
    s_add_u32 m0, s27, 40960
    s_add_u32 s41, s37, 317440
    buffer_load_dwordx4 v7, s[8:11], s41 offen offset:0 lds
    v_cvt_pk_bf16_f32 v86, 0, v86
    v_cvt_pk_bf16_f32 v87, 0, v87
    v_mfma_f32_32x32x16_bf16 v[64:79], v[128:131], a[160:163], v[64:79]
    v_add_f32 v86, v86, v158
    v_add_f32 v87, v87, v159
    v_cvt_pk_bf16_f32 v188, v86, v87
    v_lshlrev_b32 v86, 16, v188
    ds_read_b128 v[128:131], v8 offset:10240
    v_mfma_f32_32x32x16_bf16 v[48:63], v[132:135], a[20:23], v[48:63]
    buffer_load_dwordx4 v7, s[8:11], s41 offen offset:1024 lds
    v_and_b32 v87, 0xffff0000, v188
    v_pk_lshlrev_b16 v189, s50, v188
    v_mfma_f32_32x32x16_bf16 v[64:79], v[132:135], a[164:167], v[64:79]
    v_pk_max_u16 v189, v189, s52
    v_pk_min_u16 v189, v189, s53
    v_pk_lshrrev_b16 v188, s51, v188
    v_pk_mad_u16 v189, v188, s54, v189
    ds_read_b128 v[132:135], v8 offset:11264
    s_waitcnt lgkmcnt(6)
    v_mfma_f32_32x32x16_bf16 v[48:63], v[112:115], a[24:27], v[48:63]
    buffer_load_dwordx4 v7, s[8:11], s41 offen offset:2048 lds
    v_and_b32 v190, 0xffff, v189
    v_lshrrev_b32 v191, 16, v189
    v_mfma_f32_32x32x16_bf16 v[64:79], v[112:115], a[168:171], v[64:79]
    ds_read_u16_d16_hi v174, v190 offset:44288
    ds_read_u16_d16_hi v175, v191 offset:44288
    v_cvt_pk_bf16_f32 v88, 0, v88
    v_cvt_pk_bf16_f32 v89, 0, v89
    ds_read_b128 v[112:115], v8 offset:12288
    v_mfma_f32_32x32x16_bf16 v[48:63], v[116:119], a[28:31], v[48:63]
    buffer_load_dwordx4 v7, s[8:11], s41 offen offset:3072 lds
    v_add_f32 v88, v88, v160
    v_add_f32 v89, v89, v161
    v_mfma_f32_32x32x16_bf16 v[64:79], v[116:119], a[172:175], v[64:79]
    v_cvt_pk_bf16_f32 v184, v88, v89
    v_lshlrev_b32 v88, 16, v184
    v_and_b32 v89, 0xffff0000, v184
    v_pk_lshlrev_b16 v185, s50, v184
    ds_read_b128 v[116:119], v8 offset:13312
    s_waitcnt lgkmcnt(6)
    v_mfma_f32_32x32x16_bf16 v[48:63], v[120:123], a[32:35], v[48:63]
    s_add_u32 m0, s27, 45056
    s_add_u32 s41, s37, 321536
    buffer_load_dwordx4 v7, s[8:11], s41 offen offset:0 lds
    v_pk_max_u16 v185, v185, s52
    v_pk_min_u16 v185, v185, s53
    v_mfma_f32_32x32x16_bf16 v[64:79], v[120:123], a[176:179], v[64:79]
    v_pk_lshrrev_b16 v184, s51, v184
    v_pk_mad_u16 v185, v184, s54, v185
    v_and_b32 v186, 0xffff, v185
    v_lshrrev_b32 v187, 16, v185
    ds_read_b128 v[120:123], v8 offset:14336
    v_mfma_f32_32x32x16_bf16 v[48:63], v[124:127], a[36:39], v[48:63]
    buffer_load_dwordx4 v[136:139], v11, s[32:35], 0 offen offset:512
    ds_read_u16_d16_hi v176, v186 offset:44288
    ds_read_u16_d16_hi v177, v187 offset:44288
    v_mfma_f32_32x32x16_bf16 v[64:79], v[124:127], a[180:183], v[64:79]
    v_mul_f32 v80, v80, v168
    v_mul_f32 v81, v81, v169
    v_cvt_pk_bf16_f32 v80, v80, v81
    v_cvt_pk_bf16_f32 v90, 0, v90
    ds_read_b128 v[124:127], v8 offset:15360
    s_waitcnt lgkmcnt(8)
    v_mfma_f32_32x32x16_bf16 v[48:63], v[128:131], a[40:43], v[48:63]
    buffer_load_dwordx4 v[140:143], v11, s[32:35], 0 offen offset:544
    v_cvt_pk_bf16_f32 v91, 0, v91
    v_add_f32 v90, v90, v162
    v_mfma_f32_32x32x16_bf16 v[64:79], v[128:131], a[184:187], v[64:79]
    v_add_f32 v91, v91, v163
    v_cvt_pk_bf16_f32 v188, v90, v91
    v_lshlrev_b32 v90, 16, v188
    v_and_b32 v91, 0xffff0000, v188
    ds_read_b128 v[128:131], v8 offset:16384
    v_mfma_f32_32x32x16_bf16 v[48:63], v[132:135], a[44:47], v[48:63]
    buffer_load_dwordx4 v[144:147], v11, s[32:35], 0 offen offset:576
    v_pk_lshlrev_b16 v189, s50, v188
    v_pk_max_u16 v189, v189, s52
    v_mfma_f32_32x32x16_bf16 v[64:79], v[132:135], a[188:191], v[64:79]
    v_pk_min_u16 v189, v189, s53
    v_pk_lshrrev_b16 v188, s51, v188
    v_pk_mad_u16 v189, v188, s54, v189
    v_and_b32 v190, 0xffff, v189
    ds_read_b128 v[132:135], v8 offset:17408
    s_waitcnt lgkmcnt(6)
    v_mfma_f32_32x32x16_bf16 v[48:63], v[112:115], a[48:51], v[48:63]
    buffer_load_dwordx4 v[148:151], v11, s[32:35], 0 offen offset:608
    v_lshrrev_b32 v191, 16, v189
    ds_read_u16_d16_hi v178, v190 offset:44288
    v_mfma_f32_32x32x16_bf16 v[64:79], v[112:115], a[192:195], v[64:79]
    ds_read_u16_d16_hi v179, v191 offset:44288
    v_mul_f32 v82, v82, v170
    v_mul_f32 v83, v83, v171
    v_cvt_pk_bf16_f32 v81, v82, v83
    v_mfma_f32_32x32x16_bf16 v[48:63], v[116:119], a[52:55], v[48:63]
    v_cvt_pk_bf16_f32 v92, 0, v92
    v_cvt_pk_bf16_f32 v93, 0, v93
    v_add_f32 v92, v92, v164
    v_add_f32 v93, v93, v165
    v_mfma_f32_32x32x16_bf16 v[64:79], v[116:119], a[196:199], v[64:79]
    v_cvt_pk_bf16_f32 v184, v92, v93
    v_lshlrev_b32 v92, 16, v184
    v_and_b32 v93, 0xffff0000, v184
    v_pk_lshlrev_b16 v185, s50, v184
    s_waitcnt lgkmcnt(4)
    v_mfma_f32_32x32x16_bf16 v[48:63], v[120:123], a[56:59], v[48:63]
    v_pk_max_u16 v185, v185, s52
    v_pk_min_u16 v185, v185, s53
    v_pk_lshrrev_b16 v184, s51, v184
    v_pk_mad_u16 v185, v184, s54, v185
    v_mfma_f32_32x32x16_bf16 v[64:79], v[120:123], a[200:203], v[64:79]
    v_and_b32 v186, 0xffff, v185
    v_lshrrev_b32 v187, 16, v185
    ds_read_u16_d16_hi v180, v186 offset:44288
    ds_read_u16_d16_hi v181, v187 offset:44288
    v_mfma_f32_32x32x16_bf16 v[48:63], v[124:127], a[60:63], v[48:63]
    v_mul_f32 v84, v84, v172
    v_mul_f32 v85, v85, v173
    v_cvt_pk_bf16_f32 v82, v84, v85
    v_cvt_pk_bf16_f32 v94, 0, v94
    v_mfma_f32_32x32x16_bf16 v[64:79], v[124:127], a[204:207], v[64:79]
    v_cvt_pk_bf16_f32 v95, 0, v95
    v_add_f32 v94, v94, v166
    v_add_f32 v95, v95, v167
    v_cvt_pk_bf16_f32 v188, v94, v95
    s_waitcnt lgkmcnt(4)
    v_mfma_f32_32x32x16_bf16 v[48:63], v[128:131], a[64:67], v[48:63]
    v_lshlrev_b32 v94, 16, v188
    v_and_b32 v95, 0xffff0000, v188
    v_pk_lshlrev_b16 v189, s50, v188
    v_pk_max_u16 v189, v189, s52
    v_mfma_f32_32x32x16_bf16 v[64:79], v[128:131], a[208:211], v[64:79]
    v_pk_min_u16 v189, v189, s53
    v_pk_lshrrev_b16 v188, s51, v188
    v_pk_mad_u16 v189, v188, s54, v189
    v_and_b32 v190, 0xffff, v189
    v_mfma_f32_32x32x16_bf16 v[48:63], v[132:135], a[68:71], v[48:63]
    v_lshrrev_b32 v191, 16, v189
    ds_read_u16_d16_hi v182, v190 offset:44288
    ds_read_u16_d16_hi v183, v191 offset:44288
    v_mul_f32 v86, v86, v174
    v_mfma_f32_32x32x16_bf16 v[64:79], v[132:135], a[212:215], v[64:79]
    v_mul_f32 v87, v87, v175
    v_cvt_pk_bf16_f32 v83, v86, v87
    ds_write_b128 v9, v[80:83] offset:4096
    v_cvt_pk_bf16_f32 v96, 0, v96
    s_waitcnt vmcnt(4)
    s_barrier
    ds_read_b128 v[112:115], v8 offset:36864
    ds_read_b128 v[116:119], v8 offset:37888
    ds_read_b128 v[120:123], v8 offset:38912
    ds_read_b128 v[124:127], v8 offset:39936
    ds_read_b128 v[128:131], v8 offset:40960
    ds_read_b128 v[132:135], v8 offset:41984
    s_waitcnt lgkmcnt(4)
    v_mfma_f32_32x32x16_bf16 v[48:63], v[112:115], a[72:75], v[48:63]
    s_add_u32 m0, s27, 0
    s_add_u32 s41, s37, 442368
    buffer_load_dwordx4 v7, s[8:11], s41 offen offset:0 lds
    v_cvt_pk_bf16_f32 v97, 0, v97
    v_add_f32 v96, v96, v152
    v_mfma_f32_32x32x16_bf16 v[64:79], v[112:115], a[216:219], v[64:79]
    v_add_f32 v97, v97, v153
    v_cvt_pk_bf16_f32 v184, v96, v97
    v_lshlrev_b32 v96, 16, v184
    v_and_b32 v97, 0xffff0000, v184
    ds_read_b128 v[112:115], v8 offset:43008
    v_mfma_f32_32x32x16_bf16 v[48:63], v[116:119], a[76:79], v[48:63]
    buffer_load_dwordx4 v7, s[8:11], s41 offen offset:1024 lds
    v_pk_lshlrev_b16 v185, s50, v184
    v_pk_max_u16 v185, v185, s52
    v_mfma_f32_32x32x16_bf16 v[64:79], v[116:119], a[220:223], v[64:79]
    v_pk_min_u16 v185, v185, s53
    v_pk_lshrrev_b16 v184, s51, v184
    v_pk_mad_u16 v185, v184, s54, v185
    v_and_b32 v186, 0xffff, v185
    ds_read_b128 v[116:119], v8 offset:44032
    s_waitcnt lgkmcnt(4)
    v_mfma_f32_32x32x16_bf16 v[48:63], v[120:123], a[80:83], v[48:63]
    buffer_load_dwordx4 v7, s[8:11], s41 offen offset:2048 lds
    v_lshrrev_b32 v187, 16, v185
    ds_read_u16_d16_hi v168, v186 offset:44288
    v_mfma_f32_32x32x16_bf16 v[64:79], v[120:123], a[224:227], v[64:79]
    ds_read_u16_d16_hi v169, v187 offset:44288
    v_mul_f32 v88, v88, v176
    v_mul_f32 v89, v89, v177
    v_cvt_pk_bf16_f32 v88, v88, v89
    ds_read_b128 v[120:123], v8 offset:45056
    v_mfma_f32_32x32x16_bf16 v[48:63], v[124:127], a[84:87], v[48:63]
    buffer_load_dwordx4 v7, s[8:11], s41 offen offset:3072 lds
    v_cvt_pk_bf16_f32 v98, 0, v98
    v_cvt_pk_bf16_f32 v99, 0, v99
    v_mfma_f32_32x32x16_bf16 v[64:79], v[124:127], a[228:231], v[64:79]
    v_add_f32 v98, v98, v154
    v_add_f32 v99, v99, v155
    v_cvt_pk_bf16_f32 v188, v98, v99
    v_lshlrev_b32 v98, 16, v188
    ds_read_b128 v[124:127], v8 offset:46080
    s_waitcnt lgkmcnt(6)
    v_mfma_f32_32x32x16_bf16 v[48:63], v[128:131], a[88:91], v[48:63]
    s_add_u32 m0, s27, 4096
    s_add_u32 s41, s37, 446464
    buffer_load_dwordx4 v7, s[8:11], s41 offen offset:0 lds
    v_and_b32 v99, 0xffff0000, v188
    v_pk_lshlrev_b16 v189, s50, v188
    v_mfma_f32_32x32x16_bf16 v[64:79], v[128:131], a[232:235], v[64:79]
    v_pk_max_u16 v189, v189, s52
    v_pk_min_u16 v189, v189, s53
    v_pk_lshrrev_b16 v188, s51, v188
    v_pk_mad_u16 v189, v188, s54, v189
    ds_read_b128 v[128:131], v8 offset:47104
    v_mfma_f32_32x32x16_bf16 v[48:63], v[132:135], a[92:95], v[48:63]
    buffer_load_dwordx4 v7, s[8:11], s41 offen offset:1024 lds
    v_and_b32 v190, 0xffff, v189
    v_lshrrev_b32 v191, 16, v189
    v_mfma_f32_32x32x16_bf16 v[64:79], v[132:135], a[236:239], v[64:79]
    ds_read_u16_d16_hi v170, v190 offset:44288
    ds_read_u16_d16_hi v171, v191 offset:44288
    v_mul_f32 v90, v90, v178
    v_mul_f32 v91, v91, v179
    ds_read_b128 v[132:135], v8 offset:48128
    s_waitcnt lgkmcnt(8)
    v_mfma_f32_32x32x16_bf16 v[48:63], v[112:115], a[96:99], v[48:63]
    buffer_load_dwordx4 v7, s[8:11], s41 offen offset:2048 lds
    v_cvt_pk_bf16_f32 v89, v90, v91
    v_cvt_pk_bf16_f32 v100, 0, v100
    v_mfma_f32_32x32x16_bf16 v[64:79], v[112:115], a[240:243], v[64:79]
    v_cvt_pk_bf16_f32 v101, 0, v101
    v_add_f32 v100, v100, v156
    v_add_f32 v101, v101, v157
    v_cvt_pk_bf16_f32 v184, v100, v101
    ds_read_b128 v[112:115], v8 offset:49152
    v_mfma_f32_32x32x16_bf16 v[48:63], v[116:119], a[100:103], v[48:63]
    buffer_load_dwordx4 v7, s[8:11], s41 offen offset:3072 lds
    v_lshlrev_b32 v100, 16, v184
    v_and_b32 v101, 0xffff0000, v184
    v_mfma_f32_32x32x16_bf16 v[64:79], v[116:119], a[244:247], v[64:79]
    v_pk_lshlrev_b16 v185, s50, v184
    v_pk_max_u16 v185, v185, s52
    v_pk_min_u16 v185, v185, s53
    v_pk_lshrrev_b16 v184, s51, v184
    ds_read_b128 v[116:119], v8 offset:50176
    s_waitcnt lgkmcnt(6)
    v_mfma_f32_32x32x16_bf16 v[48:63], v[120:123], a[104:107], v[48:63]
    s_add_u32 m0, s27, 8192
    s_add_u32 s41, s37, 450560
    buffer_load_dwordx4 v7, s[8:11], s41 offen offset:0 lds
    v_pk_mad_u16 v185, v184, s54, v185
    v_and_b32 v186, 0xffff, v185
    v_mfma_f32_32x32x16_bf16 v[64:79], v[120:123], a[248:251], v[64:79]
    v_lshrrev_b32 v187, 16, v185
    ds_read_u16_d16_hi v172, v186 offset:44288
    ds_read_u16_d16_hi v173, v187 offset:44288
    v_mul_f32 v92, v92, v180
    ds_read_b128 v[120:123], v8 offset:51200
    v_mfma_f32_32x32x16_bf16 v[48:63], v[124:127], a[108:111], v[48:63]
    v_mul_f32 v93, v93, v181
    v_cvt_pk_bf16_f32 v90, v92, v93
    v_cvt_pk_bf16_f32 v102, 0, v102
    v_cvt_pk_bf16_f32 v103, 0, v103
    v_mfma_f32_32x32x16_bf16 v[64:79], v[124:127], a[252:255], v[64:79]
    v_add_f32 v102, v102, v158
    v_add_f32 v103, v103, v159
    v_cvt_pk_bf16_f32 v188, v102, v103
    v_lshlrev_b32 v102, 16, v188
    ds_read_b128 v[124:127], v8 offset:52224
    s_waitcnt lgkmcnt(6)
    v_mfma_f32_32x32x16_bf16 v[48:63], v[128:131], a[112:115], v[48:63]
    v_and_b32 v103, 0xffff0000, v188
    v_pk_lshlrev_b16 v189, s50, v188
    v_pk_max_u16 v189, v189, s52
    v_pk_min_u16 v189, v189, s53
    v_mfma_f32_32x32x16_bf16 v[64:79], v[128:131], v[16:19], v[64:79]
    v_pk_lshrrev_b16 v188, s51, v188
    v_pk_mad_u16 v189, v188, s54, v189
    v_and_b32 v190, 0xffff, v189
    v_lshrrev_b32 v191, 16, v189
    ds_read_b128 v[128:131], v8 offset:53248
    v_mfma_f32_32x32x16_bf16 v[48:63], v[132:135], a[116:119], v[48:63]
    ds_read_u16_d16_hi v174, v190 offset:44288
    ds_read_u16_d16_hi v175, v191 offset:44288
    v_mul_f32 v94, v94, v182
    v_mul_f32 v95, v95, v183
    v_mfma_f32_32x32x16_bf16 v[64:79], v[132:135], v[20:23], v[64:79]
    v_cvt_pk_bf16_f32 v91, v94, v95
    ds_write_b128 v9, v[88:91] offset:5120
    v_cvt_pk_bf16_f32 v104, 0, v104
    v_cvt_pk_bf16_f32 v105, 0, v105
    ds_read_b128 v[132:135], v8 offset:54272
    s_waitcnt lgkmcnt(9)
    v_mfma_f32_32x32x16_bf16 v[48:63], v[112:115], a[120:123], v[48:63]
    v_add_f32 v104, v104, v160
    v_add_f32 v105, v105, v161
    v_cvt_pk_bf16_f32 v184, v104, v105
    v_lshlrev_b32 v104, 16, v184
    v_mfma_f32_32x32x16_bf16 v[64:79], v[112:115], v[24:27], v[64:79]
    v_and_b32 v105, 0xffff0000, v184
    v_pk_lshlrev_b16 v185, s50, v184
    v_pk_max_u16 v185, v185, s52
    v_pk_min_u16 v185, v185, s53
    v_mfma_f32_32x32x16_bf16 v[48:63], v[116:119], a[124:127], v[48:63]
    v_pk_lshrrev_b16 v184, s51, v184
    v_pk_mad_u16 v185, v184, s54, v185
    v_and_b32 v186, 0xffff, v185
    v_lshrrev_b32 v187, 16, v185
    v_mfma_f32_32x32x16_bf16 v[64:79], v[116:119], v[28:31], v[64:79]
    ds_read_u16_d16_hi v176, v186 offset:44288
    ds_read_u16_d16_hi v177, v187 offset:44288
    v_mul_f32 v96, v96, v168
    v_mul_f32 v97, v97, v169
    s_waitcnt lgkmcnt(7)
    v_mfma_f32_32x32x16_bf16 v[48:63], v[120:123], a[128:131], v[48:63]
    v_cvt_pk_bf16_f32 v96, v96, v97
    v_cvt_pk_bf16_f32 v106, 0, v106
    v_cvt_pk_bf16_f32 v107, 0, v107
    v_add_f32 v106, v106, v162
    v_mfma_f32_32x32x16_bf16 v[64:79], v[120:123], v[32:35], v[64:79]
    v_add_f32 v107, v107, v163
    v_cvt_pk_bf16_f32 v188, v106, v107
    v_lshlrev_b32 v106, 16, v188
    v_and_b32 v107, 0xffff0000, v188
    v_mfma_f32_32x32x16_bf16 v[48:63], v[124:127], a[132:135], v[48:63]
    v_pk_lshlrev_b16 v189, s50, v188
    v_pk_max_u16 v189, v189, s52
    v_pk_min_u16 v189, v189, s53
    v_pk_lshrrev_b16 v188, s51, v188
    v_mfma_f32_32x32x16_bf16 v[64:79], v[124:127], v[36:39], v[64:79]
    v_pk_mad_u16 v189, v188, s54, v189
    v_and_b32 v190, 0xffff, v189
    v_lshrrev_b32 v191, 16, v189
    ds_read_u16_d16_hi v178, v190 offset:44288
    s_waitcnt lgkmcnt(3)
    v_mfma_f32_32x32x16_bf16 v[48:63], v[128:131], a[136:139], v[48:63]
    ds_read_u16_d16_hi v179, v191 offset:44288
    v_mul_f32 v98, v98, v170
    v_mul_f32 v99, v99, v171
    v_cvt_pk_bf16_f32 v97, v98, v99
    v_mfma_f32_32x32x16_bf16 v[64:79], v[128:131], v[40:43], v[64:79]
    v_cvt_pk_bf16_f32 v108, 0, v108
    v_cvt_pk_bf16_f32 v109, 0, v109
    v_add_f32 v108, v108, v164
    v_add_f32 v109, v109, v165
    v_mfma_f32_32x32x16_bf16 v[48:63], v[132:135], a[140:143], v[48:63]
    v_cvt_pk_bf16_f32 v184, v108, v109
    v_lshlrev_b32 v108, 16, v184
    v_and_b32 v109, 0xffff0000, v184
    v_pk_lshlrev_b16 v185, s50, v184
    v_mfma_f32_32x32x16_bf16 v[64:79], v[132:135], v[44:47], v[64:79]
    v_pk_max_u16 v185, v185, s52
    v_pk_min_u16 v185, v185, s53
    v_pk_lshrrev_b16 v184, s51, v184
    v_pk_mad_u16 v185, v184, s54, v185
    v_and_b32 v186, 0xffff, v185
    v_lshrrev_b32 v187, 16, v185
    ds_read_u16_d16_hi v180, v186 offset:44288
    ds_read_u16_d16_hi v181, v187 offset:44288
    v_mul_f32 v100, v100, v172
    v_mul_f32 v101, v101, v173
    v_cvt_pk_bf16_f32 v98, v100, v101
    v_cvt_pk_bf16_f32 v110, 0, v110
    v_cvt_pk_bf16_f32 v111, 0, v111
    v_add_f32 v110, v110, v166
    v_add_f32 v111, v111, v167
    v_cvt_pk_bf16_f32 v188, v110, v111
    v_lshlrev_b32 v110, 16, v188
    v_and_b32 v111, 0xffff0000, v188
    v_pk_lshlrev_b16 v189, s50, v188
    v_pk_max_u16 v189, v189, s52
    v_pk_min_u16 v189, v189, s53
    v_pk_lshrrev_b16 v188, s51, v188
    v_pk_mad_u16 v189, v188, s54, v189
    v_and_b32 v190, 0xffff, v189
    v_lshrrev_b32 v191, 16, v189
    ds_read_u16_d16_hi v182, v190 offset:44288
    ds_read_u16_d16_hi v183, v191 offset:44288
    v_mul_f32 v102, v102, v174
    v_mul_f32 v103, v103, v175
    v_cvt_pk_bf16_f32 v99, v102, v103
    ds_write_b128 v9, v[96:99] offset:22528
    s_waitcnt lgkmcnt(7)
    v_mul_f32 v104, v104, v176
    v_mul_f32 v105, v105, v177
    v_cvt_pk_bf16_f32 v104, v104, v105
    s_waitcnt lgkmcnt(5)
    v_mul_f32 v106, v106, v178
    v_mul_f32 v107, v107, v179
    v_cvt_pk_bf16_f32 v105, v106, v107
    s_waitcnt lgkmcnt(3)
    v_mul_f32 v108, v108, v180
    v_mul_f32 v109, v109, v181
    v_cvt_pk_bf16_f32 v106, v108, v109
    s_waitcnt lgkmcnt(1)
    v_mul_f32 v110, v110, v182
    v_mul_f32 v111, v111, v183
    v_cvt_pk_bf16_f32 v107, v110, v111
    ds_write_b128 v9, v[104:107] offset:23552
    s_waitcnt vmcnt(0)
    s_barrier
    ds_read_b128 v[112:115], v8 offset:0
    ds_read_b128 v[116:119], v8 offset:1024
    ds_read_b128 v[120:123], v8 offset:2048
    ds_read_b128 v[124:127], v8 offset:3072
    ds_read_b128 v[128:131], v8 offset:4096
    v_cvt_pk_bf16_f32 v48, 0, v48
    v_cvt_pk_bf16_f32 v49, 0, v49
    v_add_f32 v48, v48, v136
    v_add_f32 v49, v49, v137
    v_cvt_pk_bf16_f32 v184, v48, v49
    v_lshlrev_b32 v48, 16, v184
    v_and_b32 v49, 0xffff0000, v184
    v_pk_lshlrev_b16 v185, s50, v184
    v_pk_max_u16 v185, v185, s52
    v_pk_min_u16 v185, v185, s53
    v_pk_lshrrev_b16 v184, s51, v184
    v_pk_mad_u16 v185, v184, s54, v185
    v_and_b32 v186, 0xffff, v185
    v_lshrrev_b32 v187, 16, v185
    ds_read_u16_d16_hi v168, v186 offset:44288
    ds_read_u16_d16_hi v169, v187 offset:44288
    v_cvt_pk_bf16_f32 v50, 0, v50
    v_cvt_pk_bf16_f32 v51, 0, v51
    v_add_f32 v50, v50, v138
    v_add_f32 v51, v51, v139
    v_cvt_pk_bf16_f32 v188, v50, v51
    v_lshlrev_b32 v50, 16, v188
    v_and_b32 v51, 0xffff0000, v188
    v_pk_lshlrev_b16 v189, s50, v188
    ds_read_b128 v[132:135], v8 offset:5120
    s_waitcnt lgkmcnt(6)
    v_mfma_f32_32x32x16_bf16 v[80:95], v[112:115], a[0:3], 0
    s_add_u32 m0, s27, 36864
    s_add_u32 s41, s37, 460800
    buffer_load_dwordx4 v7, s[8:11], s41 offen offset:0 lds
    v_pk_max_u16 v189, v189, s52
    v_pk_min_u16 v189, v189, s53
    v_mfma_f32_32x32x16_bf16 v[96:111], v[112:115], a[144:147], 0
    v_pk_lshrrev_b16 v188, s51, v188
    v_pk_mad_u16 v189, v188, s54, v189
    v_and_b32 v190, 0xffff, v189
    v_lshrrev_b32 v191, 16, v189
    ds_read_b128 v[112:115], v8 offset:6144
    v_mfma_f32_32x32x16_bf16 v[80:95], v[116:119], a[4:7], v[80:95]
    buffer_load_dwordx4 v7, s[8:11], s41 offen offset:1024 lds
    ds_read_u16_d16_hi v170, v190 offset:44288
    ds_read_u16_d16_hi v171, v191 offset:44288
    v_mfma_f32_32x32x16_bf16 v[96:111], v[116:119], a[148:151], v[96:111]
    v_cvt_pk_bf16_f32 v52, 0, v52
    v_cvt_pk_bf16_f32 v53, 0, v53
    v_add_f32 v52, v52, v140
    v_add_f32 v53, v53, v141
    ds_read_b128 v[116:119], v8 offset:7168
    s_waitcnt lgkmcnt(8)
    v_mfma_f32_32x32x16_bf16 v[80:95], v[120:123], a[8:11], v[80:95]
    buffer_load_dwordx4 v7, s[8:11], s41 offen offset:2048 lds
    v_cvt_pk_bf16_f32 v184, v52, v53
    v_lshlrev_b32 v52, 16, v184
    v_mfma_f32_32x32x16_bf16 v[96:111], v[120:123], a[152:155], v[96:111]
    v_and_b32 v53, 0xffff0000, v184
    v_pk_lshlrev_b16 v185, s50, v184
    v_pk_max_u16 v185, v185, s52
    v_pk_min_u16 v185, v185, s53
    ds_read_b128 v[120:123], v8 offset:8192
    v_mfma_f32_32x32x16_bf16 v[80:95], v[124:127], a[12:15], v[80:95]
    buffer_load_dwordx4 v7, s[8:11], s41 offen offset:3072 lds
    v_pk_lshrrev_b16 v184, s51, v184
    v_pk_mad_u16 v185, v184, s54, v185
    v_mfma_f32_32x32x16_bf16 v[96:111], v[124:127], a[156:159], v[96:111]
    v_and_b32 v186, 0xffff, v185
    v_lshrrev_b32 v187, 16, v185
    ds_read_u16_d16_hi v172, v186 offset:44288
    ds_read_u16_d16_hi v173, v187 offset:44288
    ds_read_b128 v[124:127], v8 offset:9216
    s_waitcnt lgkmcnt(8)
    v_mfma_f32_32x32x16_bf16 v[80:95], v[128:131], a[16:19], v[80:95]
    s_add_u32 m0, s27, 40960
    s_add_u32 s41, s37, 464896
    buffer_load_dwordx4 v7, s[8:11], s41 offen offset:0 lds
    v_cvt_pk_bf16_f32 v54, 0, v54
    v_cvt_pk_bf16_f32 v55, 0, v55
    v_mfma_f32_32x32x16_bf16 v[96:111], v[128:131], a[160:163], v[96:111]
    v_add_f32 v54, v54, v142
    v_add_f32 v55, v55, v143
    v_cvt_pk_bf16_f32 v188, v54, v55
    v_lshlrev_b32 v54, 16, v188
    ds_read_b128 v[128:131], v8 offset:10240
    v_mfma_f32_32x32x16_bf16 v[80:95], v[132:135], a[20:23], v[80:95]
    buffer_load_dwordx4 v7, s[8:11], s41 offen offset:1024 lds
    v_and_b32 v55, 0xffff0000, v188
    v_pk_lshlrev_b16 v189, s50, v188
    v_mfma_f32_32x32x16_bf16 v[96:111], v[132:135], a[164:167], v[96:111]
    v_pk_max_u16 v189, v189, s52
    v_pk_min_u16 v189, v189, s53
    v_pk_lshrrev_b16 v188, s51, v188
    v_pk_mad_u16 v189, v188, s54, v189
    ds_read_b128 v[132:135], v8 offset:11264
    s_waitcnt lgkmcnt(6)
    v_mfma_f32_32x32x16_bf16 v[80:95], v[112:115], a[24:27], v[80:95]
    buffer_load_dwordx4 v7, s[8:11], s41 offen offset:2048 lds
    v_and_b32 v190, 0xffff, v189
    v_lshrrev_b32 v191, 16, v189
    v_mfma_f32_32x32x16_bf16 v[96:111], v[112:115], a[168:171], v[96:111]
    ds_read_u16_d16_hi v174, v190 offset:44288
    ds_read_u16_d16_hi v175, v191 offset:44288
    v_cvt_pk_bf16_f32 v56, 0, v56
    v_cvt_pk_bf16_f32 v57, 0, v57
    ds_read_b128 v[112:115], v8 offset:12288
    v_mfma_f32_32x32x16_bf16 v[80:95], v[116:119], a[28:31], v[80:95]
    buffer_load_dwordx4 v7, s[8:11], s41 offen offset:3072 lds
    v_add_f32 v56, v56, v144
    v_add_f32 v57, v57, v145
    v_mfma_f32_32x32x16_bf16 v[96:111], v[116:119], a[172:175], v[96:111]
    v_cvt_pk_bf16_f32 v184, v56, v57
    v_lshlrev_b32 v56, 16, v184
    v_and_b32 v57, 0xffff0000, v184
    v_pk_lshlrev_b16 v185, s50, v184
    ds_read_b128 v[116:119], v8 offset:13312
    s_waitcnt lgkmcnt(6)
    v_mfma_f32_32x32x16_bf16 v[80:95], v[120:123], a[32:35], v[80:95]
    s_add_u32 m0, s27, 45056
    s_add_u32 s41, s37, 468992
    buffer_load_dwordx4 v7, s[8:11], s41 offen offset:0 lds
    v_pk_max_u16 v185, v185, s52
    v_pk_min_u16 v185, v185, s53
    v_mfma_f32_32x32x16_bf16 v[96:111], v[120:123], a[176:179], v[96:111]
    v_pk_lshrrev_b16 v184, s51, v184
    v_pk_mad_u16 v185, v184, s54, v185
    v_and_b32 v186, 0xffff, v185
    v_lshrrev_b32 v187, 16, v185
    ds_read_b128 v[120:123], v8 offset:14336
    v_mfma_f32_32x32x16_bf16 v[80:95], v[124:127], a[36:39], v[80:95]
    buffer_load_dwordx4 v[152:155], v11, s[32:35], 0 offen offset:768
    ds_read_u16_d16_hi v176, v186 offset:44288
    ds_read_u16_d16_hi v177, v187 offset:44288
    v_mfma_f32_32x32x16_bf16 v[96:111], v[124:127], a[180:183], v[96:111]
    v_mul_f32 v48, v48, v168
    v_mul_f32 v49, v49, v169
    v_cvt_pk_bf16_f32 v48, v48, v49
    v_cvt_pk_bf16_f32 v58, 0, v58
    ds_read_b128 v[124:127], v8 offset:15360
    s_waitcnt lgkmcnt(8)
    v_mfma_f32_32x32x16_bf16 v[80:95], v[128:131], a[40:43], v[80:95]
    buffer_load_dwordx4 v[156:159], v11, s[32:35], 0 offen offset:800
    v_cvt_pk_bf16_f32 v59, 0, v59
    v_add_f32 v58, v58, v146
    v_mfma_f32_32x32x16_bf16 v[96:111], v[128:131], a[184:187], v[96:111]
    v_add_f32 v59, v59, v147
    v_cvt_pk_bf16_f32 v188, v58, v59
    v_lshlrev_b32 v58, 16, v188
    v_and_b32 v59, 0xffff0000, v188
    ds_read_b128 v[128:131], v8 offset:16384
    v_mfma_f32_32x32x16_bf16 v[80:95], v[132:135], a[44:47], v[80:95]
    buffer_load_dwordx4 v[160:163], v11, s[32:35], 0 offen offset:832
    v_pk_lshlrev_b16 v189, s50, v188
    v_pk_max_u16 v189, v189, s52
    v_mfma_f32_32x32x16_bf16 v[96:111], v[132:135], a[188:191], v[96:111]
    v_pk_min_u16 v189, v189, s53
    v_pk_lshrrev_b16 v188, s51, v188
    v_pk_mad_u16 v189, v188, s54, v189
    v_and_b32 v190, 0xffff, v189
    ds_read_b128 v[132:135], v8 offset:17408
    s_waitcnt lgkmcnt(6)
    v_mfma_f32_32x32x16_bf16 v[80:95], v[112:115], a[48:51], v[80:95]
    buffer_load_dwordx4 v[164:167], v11, s[32:35], 0 offen offset:864
    v_lshrrev_b32 v191, 16, v189
    ds_read_u16_d16_hi v178, v190 offset:44288
    v_mfma_f32_32x32x16_bf16 v[96:111], v[112:115], a[192:195], v[96:111]
    ds_read_u16_d16_hi v179, v191 offset:44288
    v_mul_f32 v50, v50, v170
    v_mul_f32 v51, v51, v171
    v_cvt_pk_bf16_f32 v49, v50, v51
    v_mfma_f32_32x32x16_bf16 v[80:95], v[116:119], a[52:55], v[80:95]
    v_cvt_pk_bf16_f32 v60, 0, v60
    v_cvt_pk_bf16_f32 v61, 0, v61
    v_add_f32 v60, v60, v148
    v_add_f32 v61, v61, v149
    v_mfma_f32_32x32x16_bf16 v[96:111], v[116:119], a[196:199], v[96:111]
    v_cvt_pk_bf16_f32 v184, v60, v61
    v_lshlrev_b32 v60, 16, v184
    v_and_b32 v61, 0xffff0000, v184
    v_pk_lshlrev_b16 v185, s50, v184
    s_waitcnt lgkmcnt(4)
    v_mfma_f32_32x32x16_bf16 v[80:95], v[120:123], a[56:59], v[80:95]
    v_pk_max_u16 v185, v185, s52
    v_pk_min_u16 v185, v185, s53
    v_pk_lshrrev_b16 v184, s51, v184
    v_pk_mad_u16 v185, v184, s54, v185
    v_mfma_f32_32x32x16_bf16 v[96:111], v[120:123], a[200:203], v[96:111]
    v_and_b32 v186, 0xffff, v185
    v_lshrrev_b32 v187, 16, v185
    ds_read_u16_d16_hi v180, v186 offset:44288
    ds_read_u16_d16_hi v181, v187 offset:44288
    v_mfma_f32_32x32x16_bf16 v[80:95], v[124:127], a[60:63], v[80:95]
    v_mul_f32 v52, v52, v172
    v_mul_f32 v53, v53, v173
    v_cvt_pk_bf16_f32 v50, v52, v53
    v_cvt_pk_bf16_f32 v62, 0, v62
    v_mfma_f32_32x32x16_bf16 v[96:111], v[124:127], a[204:207], v[96:111]
    v_cvt_pk_bf16_f32 v63, 0, v63
    v_add_f32 v62, v62, v150
    v_add_f32 v63, v63, v151
    v_cvt_pk_bf16_f32 v188, v62, v63
    s_waitcnt lgkmcnt(4)
    v_mfma_f32_32x32x16_bf16 v[80:95], v[128:131], a[64:67], v[80:95]
    v_lshlrev_b32 v62, 16, v188
    v_and_b32 v63, 0xffff0000, v188
    v_pk_lshlrev_b16 v189, s50, v188
    v_pk_max_u16 v189, v189, s52
    v_mfma_f32_32x32x16_bf16 v[96:111], v[128:131], a[208:211], v[96:111]
    v_pk_min_u16 v189, v189, s53
    v_pk_lshrrev_b16 v188, s51, v188
    v_pk_mad_u16 v189, v188, s54, v189
    v_and_b32 v190, 0xffff, v189
    v_mfma_f32_32x32x16_bf16 v[80:95], v[132:135], a[68:71], v[80:95]
    v_lshrrev_b32 v191, 16, v189
    ds_read_u16_d16_hi v182, v190 offset:44288
    ds_read_u16_d16_hi v183, v191 offset:44288
    v_mul_f32 v54, v54, v174
    v_mfma_f32_32x32x16_bf16 v[96:111], v[132:135], a[212:215], v[96:111]
    v_mul_f32 v55, v55, v175
    v_cvt_pk_bf16_f32 v51, v54, v55
    ds_write_b128 v9, v[48:51] offset:8192
    v_cvt_pk_bf16_f32 v64, 0, v64
    s_waitcnt vmcnt(4)
    s_barrier
    ds_read_b128 v[112:115], v8 offset:36864
    ds_read_b128 v[116:119], v8 offset:37888
    ds_read_b128 v[120:123], v8 offset:38912
    ds_read_b128 v[124:127], v8 offset:39936
    ds_read_b128 v[128:131], v8 offset:40960
    ds_read_b128 v[132:135], v8 offset:41984
    s_waitcnt lgkmcnt(4)
    v_mfma_f32_32x32x16_bf16 v[80:95], v[112:115], a[72:75], v[80:95]
    s_add_u32 m0, s27, 0
    s_add_u32 s41, s38, 0
    buffer_load_dwordx4 v7, s[8:11], s41 offen offset:0 lds
    v_cvt_pk_bf16_f32 v65, 0, v65
    v_add_f32 v64, v64, v136
    v_mfma_f32_32x32x16_bf16 v[96:111], v[112:115], a[216:219], v[96:111]
    v_add_f32 v65, v65, v137
    v_cvt_pk_bf16_f32 v184, v64, v65
    v_lshlrev_b32 v64, 16, v184
    v_and_b32 v65, 0xffff0000, v184
    ds_read_b128 v[112:115], v8 offset:43008
    v_mfma_f32_32x32x16_bf16 v[80:95], v[116:119], a[76:79], v[80:95]
    buffer_load_dwordx4 v7, s[8:11], s41 offen offset:1024 lds
    v_pk_lshlrev_b16 v185, s50, v184
    v_pk_max_u16 v185, v185, s52
    v_mfma_f32_32x32x16_bf16 v[96:111], v[116:119], a[220:223], v[96:111]
    v_pk_min_u16 v185, v185, s53
    v_pk_lshrrev_b16 v184, s51, v184
    v_pk_mad_u16 v185, v184, s54, v185
    v_and_b32 v186, 0xffff, v185
    ds_read_b128 v[116:119], v8 offset:44032
    s_waitcnt lgkmcnt(4)
    v_mfma_f32_32x32x16_bf16 v[80:95], v[120:123], a[80:83], v[80:95]
    buffer_load_dwordx4 v7, s[8:11], s41 offen offset:2048 lds
    v_lshrrev_b32 v187, 16, v185
    ds_read_u16_d16_hi v168, v186 offset:44288
    v_mfma_f32_32x32x16_bf16 v[96:111], v[120:123], a[224:227], v[96:111]
    ds_read_u16_d16_hi v169, v187 offset:44288
    v_mul_f32 v56, v56, v176
    v_mul_f32 v57, v57, v177
    v_cvt_pk_bf16_f32 v56, v56, v57
    ds_read_b128 v[120:123], v8 offset:45056
    v_mfma_f32_32x32x16_bf16 v[80:95], v[124:127], a[84:87], v[80:95]
    buffer_load_dwordx4 v7, s[8:11], s41 offen offset:3072 lds
    v_cvt_pk_bf16_f32 v66, 0, v66
    v_cvt_pk_bf16_f32 v67, 0, v67
    v_mfma_f32_32x32x16_bf16 v[96:111], v[124:127], a[228:231], v[96:111]
    v_add_f32 v66, v66, v138
    v_add_f32 v67, v67, v139
    v_cvt_pk_bf16_f32 v188, v66, v67
    v_lshlrev_b32 v66, 16, v188
    ds_read_b128 v[124:127], v8 offset:46080
    s_waitcnt lgkmcnt(6)
    v_mfma_f32_32x32x16_bf16 v[80:95], v[128:131], a[88:91], v[80:95]
    s_add_u32 m0, s27, 4096
    s_add_u32 s41, s38, 4096
    buffer_load_dwordx4 v7, s[8:11], s41 offen offset:0 lds
    v_and_b32 v67, 0xffff0000, v188
    v_pk_lshlrev_b16 v189, s50, v188
    v_mfma_f32_32x32x16_bf16 v[96:111], v[128:131], a[232:235], v[96:111]
    v_pk_max_u16 v189, v189, s52
    v_pk_min_u16 v189, v189, s53
    v_pk_lshrrev_b16 v188, s51, v188
    v_pk_mad_u16 v189, v188, s54, v189
    ds_read_b128 v[128:131], v8 offset:47104
    v_mfma_f32_32x32x16_bf16 v[80:95], v[132:135], a[92:95], v[80:95]
    buffer_load_dwordx4 v7, s[8:11], s41 offen offset:1024 lds
    v_and_b32 v190, 0xffff, v189
    v_lshrrev_b32 v191, 16, v189
    v_mfma_f32_32x32x16_bf16 v[96:111], v[132:135], a[236:239], v[96:111]
    ds_read_u16_d16_hi v170, v190 offset:44288
    ds_read_u16_d16_hi v171, v191 offset:44288
    v_mul_f32 v58, v58, v178
    v_mul_f32 v59, v59, v179
    ds_read_b128 v[132:135], v8 offset:48128
    s_waitcnt lgkmcnt(8)
    v_mfma_f32_32x32x16_bf16 v[80:95], v[112:115], a[96:99], v[80:95]
    buffer_load_dwordx4 v7, s[8:11], s41 offen offset:2048 lds
    v_cvt_pk_bf16_f32 v57, v58, v59
    v_cvt_pk_bf16_f32 v68, 0, v68
    v_mfma_f32_32x32x16_bf16 v[96:111], v[112:115], a[240:243], v[96:111]
    v_cvt_pk_bf16_f32 v69, 0, v69
    v_add_f32 v68, v68, v140
    v_add_f32 v69, v69, v141
    v_cvt_pk_bf16_f32 v184, v68, v69
    ds_read_b128 v[112:115], v8 offset:49152
    v_mfma_f32_32x32x16_bf16 v[80:95], v[116:119], a[100:103], v[80:95]
    buffer_load_dwordx4 v7, s[8:11], s41 offen offset:3072 lds
    v_lshlrev_b32 v68, 16, v184
    v_and_b32 v69, 0xffff0000, v184
    v_mfma_f32_32x32x16_bf16 v[96:111], v[116:119], a[244:247], v[96:111]
    v_pk_lshlrev_b16 v185, s50, v184
    v_pk_max_u16 v185, v185, s52
    v_pk_min_u16 v185, v185, s53
    v_pk_lshrrev_b16 v184, s51, v184
    ds_read_b128 v[116:119], v8 offset:50176
    s_waitcnt lgkmcnt(6)
    v_mfma_f32_32x32x16_bf16 v[80:95], v[120:123], a[104:107], v[80:95]
    s_add_u32 m0, s27, 8192
    s_add_u32 s41, s38, 8192
    buffer_load_dwordx4 v7, s[8:11], s41 offen offset:0 lds
    v_pk_mad_u16 v185, v184, s54, v185
    v_and_b32 v186, 0xffff, v185
    v_mfma_f32_32x32x16_bf16 v[96:111], v[120:123], a[248:251], v[96:111]
    v_lshrrev_b32 v187, 16, v185
    ds_read_u16_d16_hi v172, v186 offset:44288
    ds_read_u16_d16_hi v173, v187 offset:44288
    v_mul_f32 v60, v60, v180
    ds_read_b128 v[120:123], v8 offset:51200
    v_mfma_f32_32x32x16_bf16 v[80:95], v[124:127], a[108:111], v[80:95]
    v_mul_f32 v61, v61, v181
    v_cvt_pk_bf16_f32 v58, v60, v61
    v_cvt_pk_bf16_f32 v70, 0, v70
    v_cvt_pk_bf16_f32 v71, 0, v71
    v_mfma_f32_32x32x16_bf16 v[96:111], v[124:127], a[252:255], v[96:111]
    v_add_f32 v70, v70, v142
    v_add_f32 v71, v71, v143
    v_cvt_pk_bf16_f32 v188, v70, v71
    v_lshlrev_b32 v70, 16, v188
    ds_read_b128 v[124:127], v8 offset:52224
    s_waitcnt lgkmcnt(6)
    v_mfma_f32_32x32x16_bf16 v[80:95], v[128:131], a[112:115], v[80:95]
    v_and_b32 v71, 0xffff0000, v188
    v_pk_lshlrev_b16 v189, s50, v188
    v_pk_max_u16 v189, v189, s52
    v_pk_min_u16 v189, v189, s53
    v_mfma_f32_32x32x16_bf16 v[96:111], v[128:131], v[16:19], v[96:111]
    v_pk_lshrrev_b16 v188, s51, v188
    v_pk_mad_u16 v189, v188, s54, v189
    v_and_b32 v190, 0xffff, v189
    v_lshrrev_b32 v191, 16, v189
    ds_read_b128 v[128:131], v8 offset:53248
    v_mfma_f32_32x32x16_bf16 v[80:95], v[132:135], a[116:119], v[80:95]
    ds_read_u16_d16_hi v174, v190 offset:44288
    ds_read_u16_d16_hi v175, v191 offset:44288
    v_mul_f32 v62, v62, v182
    v_mul_f32 v63, v63, v183
    v_mfma_f32_32x32x16_bf16 v[96:111], v[132:135], v[20:23], v[96:111]
    v_cvt_pk_bf16_f32 v59, v62, v63
    ds_write_b128 v9, v[56:59] offset:9216
    v_cvt_pk_bf16_f32 v72, 0, v72
    v_cvt_pk_bf16_f32 v73, 0, v73
    ds_read_b128 v[132:135], v8 offset:54272
    s_waitcnt lgkmcnt(9)
    v_mfma_f32_32x32x16_bf16 v[80:95], v[112:115], a[120:123], v[80:95]
    v_add_f32 v72, v72, v144
    v_add_f32 v73, v73, v145
    v_cvt_pk_bf16_f32 v184, v72, v73
    v_lshlrev_b32 v72, 16, v184
    v_mfma_f32_32x32x16_bf16 v[96:111], v[112:115], v[24:27], v[96:111]
    v_and_b32 v73, 0xffff0000, v184
    v_pk_lshlrev_b16 v185, s50, v184
    v_pk_max_u16 v185, v185, s52
    v_pk_min_u16 v185, v185, s53
    v_mfma_f32_32x32x16_bf16 v[80:95], v[116:119], a[124:127], v[80:95]
    v_pk_lshrrev_b16 v184, s51, v184
    v_pk_mad_u16 v185, v184, s54, v185
    v_and_b32 v186, 0xffff, v185
    v_lshrrev_b32 v187, 16, v185
    v_mfma_f32_32x32x16_bf16 v[96:111], v[116:119], v[28:31], v[96:111]
    ds_read_u16_d16_hi v176, v186 offset:44288
    ds_read_u16_d16_hi v177, v187 offset:44288
    v_mul_f32 v64, v64, v168
    v_mul_f32 v65, v65, v169
    s_waitcnt lgkmcnt(7)
    v_mfma_f32_32x32x16_bf16 v[80:95], v[120:123], a[128:131], v[80:95]
    v_cvt_pk_bf16_f32 v64, v64, v65
    v_cvt_pk_bf16_f32 v74, 0, v74
    v_cvt_pk_bf16_f32 v75, 0, v75
    v_add_f32 v74, v74, v146
    v_mfma_f32_32x32x16_bf16 v[96:111], v[120:123], v[32:35], v[96:111]
    v_add_f32 v75, v75, v147
    v_cvt_pk_bf16_f32 v188, v74, v75
    v_lshlrev_b32 v74, 16, v188
    v_and_b32 v75, 0xffff0000, v188
    v_mfma_f32_32x32x16_bf16 v[80:95], v[124:127], a[132:135], v[80:95]
    v_pk_lshlrev_b16 v189, s50, v188
    v_pk_max_u16 v189, v189, s52
    v_pk_min_u16 v189, v189, s53
    v_pk_lshrrev_b16 v188, s51, v188
    v_mfma_f32_32x32x16_bf16 v[96:111], v[124:127], v[36:39], v[96:111]
    v_pk_mad_u16 v189, v188, s54, v189
    v_and_b32 v190, 0xffff, v189
    v_lshrrev_b32 v191, 16, v189
    ds_read_u16_d16_hi v178, v190 offset:44288
    s_waitcnt lgkmcnt(3)
    v_mfma_f32_32x32x16_bf16 v[80:95], v[128:131], a[136:139], v[80:95]
    ds_read_u16_d16_hi v179, v191 offset:44288
    v_mul_f32 v66, v66, v170
    v_mul_f32 v67, v67, v171
    v_cvt_pk_bf16_f32 v65, v66, v67
    v_mfma_f32_32x32x16_bf16 v[96:111], v[128:131], v[40:43], v[96:111]
    v_cvt_pk_bf16_f32 v76, 0, v76
    v_cvt_pk_bf16_f32 v77, 0, v77
    v_add_f32 v76, v76, v148
    v_add_f32 v77, v77, v149
    v_mfma_f32_32x32x16_bf16 v[80:95], v[132:135], a[140:143], v[80:95]
    v_cvt_pk_bf16_f32 v184, v76, v77
    v_lshlrev_b32 v76, 16, v184
    v_and_b32 v77, 0xffff0000, v184
    v_pk_lshlrev_b16 v185, s50, v184
    v_mfma_f32_32x32x16_bf16 v[96:111], v[132:135], v[44:47], v[96:111]
    v_pk_max_u16 v185, v185, s52
    v_pk_min_u16 v185, v185, s53
    v_pk_lshrrev_b16 v184, s51, v184
    v_pk_mad_u16 v185, v184, s54, v185
    v_and_b32 v186, 0xffff, v185
    v_lshrrev_b32 v187, 16, v185
    ds_read_u16_d16_hi v180, v186 offset:44288
    ds_read_u16_d16_hi v181, v187 offset:44288
    v_mul_f32 v68, v68, v172
    v_mul_f32 v69, v69, v173
    v_cvt_pk_bf16_f32 v66, v68, v69
    v_cvt_pk_bf16_f32 v78, 0, v78
    v_cvt_pk_bf16_f32 v79, 0, v79
    v_add_f32 v78, v78, v150
    v_add_f32 v79, v79, v151
    v_cvt_pk_bf16_f32 v188, v78, v79
    v_lshlrev_b32 v78, 16, v188
    v_and_b32 v79, 0xffff0000, v188
    v_pk_lshlrev_b16 v189, s50, v188
    v_pk_max_u16 v189, v189, s52
    v_pk_min_u16 v189, v189, s53
    v_pk_lshrrev_b16 v188, s51, v188
    v_pk_mad_u16 v189, v188, s54, v189
    v_and_b32 v190, 0xffff, v189
    v_lshrrev_b32 v191, 16, v189
    ds_read_u16_d16_hi v182, v190 offset:44288
    ds_read_u16_d16_hi v183, v191 offset:44288
    v_mul_f32 v70, v70, v174
    v_mul_f32 v71, v71, v175
    v_cvt_pk_bf16_f32 v67, v70, v71
    ds_write_b128 v9, v[64:67] offset:26624
    s_waitcnt lgkmcnt(7)
    v_mul_f32 v72, v72, v176
    v_mul_f32 v73, v73, v177
    v_cvt_pk_bf16_f32 v72, v72, v73
    s_waitcnt lgkmcnt(5)
    v_mul_f32 v74, v74, v178
    v_mul_f32 v75, v75, v179
    v_cvt_pk_bf16_f32 v73, v74, v75
    s_waitcnt lgkmcnt(3)
    v_mul_f32 v76, v76, v180
    v_mul_f32 v77, v77, v181
    v_cvt_pk_bf16_f32 v74, v76, v77
    s_waitcnt lgkmcnt(1)
    v_mul_f32 v78, v78, v182
    v_mul_f32 v79, v79, v183
    v_cvt_pk_bf16_f32 v75, v78, v79
    ds_write_b128 v9, v[72:75] offset:27648
    s_waitcnt vmcnt(0)
    s_barrier
    buffer_load_dwordx4 v[136:139], v10, s[32:35], 0 offen offset:0
    buffer_load_dwordx4 v[140:143], v10, s[32:35], 0 offen offset:32
    buffer_load_dwordx4 v[144:147], v10, s[32:35], 0 offen offset:64
    buffer_load_dwordx4 v[148:151], v10, s[32:35], 0 offen offset:96
    s_lshl_b32 s57, s24, 11
    s_add_u32 s57, s57, s55
    s_lshr_b32 s58, s24, 1
    s_add_u32 s58, s58, 16
    s_lshl_b32 s58, s58, 11
    s_add_u32 s58, s58, s55
    s_lshl_b32 s44, s20, 10
    s_mul_i32 s59, s21, 2359296
    s_add_u32 s44, s44, s59
    s_lshl_b32 s59, s24, 17
    s_add_u32 s59, s59, s44
    v_add_u32 v12, s59, v7
    s_lshr_b32 s59, s24, 1
    s_add_u32 s59, s59, 16
    s_lshl_b32 s59, s59, 17
    s_and_b32 s66, s24, 1
    s_lshl_b32 s66, s66, 16
    s_add_u32 s59, s59, s66
    s_add_u32 s59, s59, s44
    v_add_u32 v13, s59, v7
    s_cmp_eq_u32 s23, 1
    s_cbranch_scc1 KF_J1
    ds_read_b128 v[112:115], v7 offset:0
    ds_read_b128 v[116:119], v7 offset:1024
    ds_read_b128 v[120:123], v7 offset:2048
    ds_read_b128 v[124:127], v7 offset:3072
    ds_read_b128 v[128:131], v7 offset:4096
    v_cvt_pk_bf16_f32 v80, 0, v80
    v_cvt_pk_bf16_f32 v81, 0, v81
    v_add_f32 v80, v80, v152
    v_add_f32 v81, v81, v153
    v_cvt_pk_bf16_f32 v184, v80, v81
    v_lshlrev_b32 v80, 16, v184
    v_and_b32 v81, 0xffff0000, v184
    v_pk_lshlrev_b16 v185, s50, v184
    v_pk_max_u16 v185, v185, s52
    v_pk_min_u16 v185, v185, s53
    v_pk_lshrrev_b16 v184, s51, v184
    v_pk_mad_u16 v185, v184, s54, v185
    v_and_b32 v186, 0xffff, v185
    v_lshrrev_b32 v187, 16, v185
    ds_read_u16_d16_hi v168, v186 offset:44288
    ds_read_u16_d16_hi v169, v187 offset:44288
    v_cvt_pk_bf16_f32 v82, 0, v82
    v_cvt_pk_bf16_f32 v83, 0, v83
    v_add_f32 v82, v82, v154
    v_add_f32 v83, v83, v155
    v_cvt_pk_bf16_f32 v188, v82, v83
    v_lshlrev_b32 v82, 16, v188
    v_and_b32 v83, 0xffff0000, v188
    v_pk_lshlrev_b16 v189, s50, v188
    ds_read_b128 v[132:135], v7 offset:5120
    s_waitcnt lgkmcnt(6)
    v_mfma_f32_32x32x16_bf16 v[48:63], v[112:115], a[0:3], 0
    s_add_u32 s67, s57, 0
    buffer_load_dwordx4 v[192:195], v7, s[8:11], s67 offen
    v_pk_max_u16 v189, v189, s52
    v_pk_min_u16 v189, v189, s53
    v_pk_lshrrev_b16 v188, s51, v188
    v_pk_mad_u16 v189, v188, s54, v189
    ds_read_b128 v[112:115], v7 offset:6144
    v_mfma_f32_32x32x16_bf16 v[48:63], v[116:119], a[4:7], v[48:63]
    v_and_b32 v190, 0xffff, v189
    v_lshrrev_b32 v191, 16, v189
    ds_read_u16_d16_hi v170, v190 offset:44288
    ds_read_u16_d16_hi v171, v191 offset:44288
    v_cvt_pk_bf16_f32 v84, 0, v84
    v_cvt_pk_bf16_f32 v85, 0, v85
    ds_read_b128 v[116:119], v7 offset:7168
    s_waitcnt lgkmcnt(8)
    v_mfma_f32_32x32x16_bf16 v[48:63], v[120:123], a[8:11], v[48:63]
    s_add_u32 s67, s57, 1024
    buffer_load_dwordx4 v[196:199], v7, s[8:11], s67 offen
    v_add_f32 v84, v84, v156
    v_add_f32 v85, v85, v157
    v_cvt_pk_bf16_f32 v184, v84, v85
    v_lshlrev_b32 v84, 16, v184
    ds_read_b128 v[120:123], v7 offset:8192
    v_mfma_f32_32x32x16_bf16 v[48:63], v[124:127], a[12:15], v[48:63]
    v_and_b32 v85, 0xffff0000, v184
    v_pk_lshlrev_b16 v185, s50, v184
    v_pk_max_u16 v185, v185, s52
    v_pk_min_u16 v185, v185, s53
    v_pk_lshrrev_b16 v184, s51, v184
    v_pk_mad_u16 v185, v184, s54, v185
    ds_read_b128 v[124:127], v7 offset:9216
    s_waitcnt lgkmcnt(6)
    v_mfma_f32_32x32x16_bf16 v[48:63], v[128:131], a[16:19], v[48:63]
    s_add_u32 s67, s57, 73728
    buffer_load_dwordx4 v[200:203], v7, s[8:11], s67 offen
    v_and_b32 v186, 0xffff, v185
    v_lshrrev_b32 v187, 16, v185
    ds_read_u16_d16_hi v172, v186 offset:44288
    ds_read_u16_d16_hi v173, v187 offset:44288
    ds_read_b128 v[128:131], v7 offset:10240
    v_mfma_f32_32x32x16_bf16 v[48:63], v[132:135], a[20:23], v[48:63]
    v_cvt_pk_bf16_f32 v86, 0, v86
    v_cvt_pk_bf16_f32 v87, 0, v87
    v_add_f32 v86, v86, v158
    v_add_f32 v87, v87, v159
    v_cvt_pk_bf16_f32 v188, v86, v87
    v_lshlrev_b32 v86, 16, v188
    ds_read_b128 v[132:135], v7 offset:11264
    s_waitcnt lgkmcnt(6)
    v_mfma_f32_32x32x16_bf16 v[48:63], v[112:115], a[24:27], v[48:63]
    s_add_u32 s67, s57, 74752
    buffer_load_dwordx4 v[204:207], v7, s[8:11], s67 offen
    v_and_b32 v87, 0xffff0000, v188
    v_pk_lshlrev_b16 v189, s50, v188
    v_pk_max_u16 v189, v189, s52
    v_pk_min_u16 v189, v189, s53
    ds_read_b128 v[112:115], v7 offset:12288
    v_mfma_f32_32x32x16_bf16 v[48:63], v[116:119], a[28:31], v[48:63]
    v_pk_lshrrev_b16 v188, s51, v188
    v_pk_mad_u16 v189, v188, s54, v189
    v_and_b32 v190, 0xffff, v189
    v_lshrrev_b32 v191, 16, v189
    ds_read_u16_d16_hi v174, v190 offset:44288
    ds_read_u16_d16_hi v175, v191 offset:44288
    ds_read_b128 v[116:119], v7 offset:13312
    s_waitcnt lgkmcnt(8)
    v_mfma_f32_32x32x16_bf16 v[48:63], v[120:123], a[32:35], v[48:63]
    s_add_u32 s67, s57, 147456
    buffer_load_dwordx4 v[208:211], v7, s[8:11], s67 offen
    v_cvt_pk_bf16_f32 v88, 0, v88
    v_cvt_pk_bf16_f32 v89, 0, v89
    v_add_f32 v88, v88, v160
    v_add_f32 v89, v89, v161
    ds_read_b128 v[120:123], v7 offset:14336
    v_mfma_f32_32x32x16_bf16 v[48:63], v[124:127], a[36:39], v[48:63]
    v_cvt_pk_bf16_f32 v184, v88, v89
    v_lshlrev_b32 v88, 16, v184
    v_and_b32 v89, 0xffff0000, v184
    v_pk_lshlrev_b16 v185, s50, v184
    v_pk_max_u16 v185, v185, s52
    v_pk_min_u16 v185, v185, s53
    ds_read_b128 v[124:127], v7 offset:15360
    s_waitcnt lgkmcnt(6)
    v_mfma_f32_32x32x16_bf16 v[48:63], v[128:131], a[40:43], v[48:63]
    s_add_u32 s67, s57, 148480
    buffer_load_dwordx4 v[212:215], v7, s[8:11], s67 offen
    v_pk_lshrrev_b16 v184, s51, v184
    v_pk_mad_u16 v185, v184, s54, v185
    v_and_b32 v186, 0xffff, v185
    v_lshrrev_b32 v187, 16, v185
    ds_read_b128 v[128:131], v7 offset:16384
    v_mfma_f32_32x32x16_bf16 v[48:63], v[132:135], a[44:47], v[48:63]
    ds_read_u16_d16_hi v176, v186 offset:44288
    ds_read_u16_d16_hi v177, v187 offset:44288
    v_mul_f32 v80, v80, v168
    v_mul_f32 v81, v81, v169
    v_cvt_pk_bf16_f32 v80, v80, v81
    v_cvt_pk_bf16_f32 v90, 0, v90
    ds_read_b128 v[132:135], v7 offset:17408
    s_waitcnt lgkmcnt(6)
    v_mfma_f32_32x32x16_bf16 v[48:63], v[112:115], a[48:51], v[48:63]
    s_add_u32 s67, s57, 221184
    buffer_load_dwordx4 v[216:219], v7, s[8:11], s67 offen
    v_cvt_pk_bf16_f32 v91, 0, v91
    v_add_f32 v90, v90, v162
    v_add_f32 v91, v91, v163
    v_cvt_pk_bf16_f32 v188, v90, v91
    ds_read_b128 v[112:115], v7 offset:18432
    v_mfma_f32_32x32x16_bf16 v[48:63], v[116:119], a[52:55], v[48:63]
    v_lshlrev_b32 v90, 16, v188
    v_and_b32 v91, 0xffff0000, v188
    v_pk_lshlrev_b16 v189, s50, v188
    v_pk_max_u16 v189, v189, s52
    v_pk_min_u16 v189, v189, s53
    v_pk_lshrrev_b16 v188, s51, v188
    ds_read_b128 v[116:119], v7 offset:19456
    s_waitcnt lgkmcnt(6)
    v_mfma_f32_32x32x16_bf16 v[48:63], v[120:123], a[56:59], v[48:63]
    s_add_u32 s67, s57, 222208
    buffer_load_dwordx4 v[220:223], v7, s[8:11], s67 offen
    v_pk_mad_u16 v189, v188, s54, v189
    v_and_b32 v190, 0xffff, v189
    v_lshrrev_b32 v191, 16, v189
    ds_read_u16_d16_hi v178, v190 offset:44288
    ds_read_b128 v[120:123], v7 offset:20480
    v_mfma_f32_32x32x16_bf16 v[48:63], v[124:127], a[60:63], v[48:63]
    ds_read_u16_d16_hi v179, v191 offset:44288
    v_mul_f32 v82, v82, v170
    v_mul_f32 v83, v83, v171
    v_cvt_pk_bf16_f32 v81, v82, v83
    v_cvt_pk_bf16_f32 v92, 0, v92
    v_cvt_pk_bf16_f32 v93, 0, v93
    ds_read_b128 v[124:127], v7 offset:21504
    s_waitcnt lgkmcnt(6)
    v_mfma_f32_32x32x16_bf16 v[48:63], v[128:131], a[64:67], v[48:63]
    s_add_u32 s67, s57, 294912
    buffer_load_dwordx4 v[224:227], v7, s[8:11], s67 offen
    v_add_f32 v92, v92, v164
    v_add_f32 v93, v93, v165
    v_cvt_pk_bf16_f32 v184, v92, v93
    v_lshlrev_b32 v92, 16, v184
    ds_read_b128 v[128:131], v7 offset:22528
    v_mfma_f32_32x32x16_bf16 v[48:63], v[132:135], a[68:71], v[48:63]
    v_and_b32 v93, 0xffff0000, v184
    v_pk_lshlrev_b16 v185, s50, v184
    v_pk_max_u16 v185, v185, s52
    v_pk_min_u16 v185, v185, s53
    v_pk_lshrrev_b16 v184, s51, v184
    v_pk_mad_u16 v185, v184, s54, v185
    ds_read_b128 v[132:135], v7 offset:23552
    s_waitcnt lgkmcnt(6)
    v_mfma_f32_32x32x16_bf16 v[48:63], v[112:115], a[72:75], v[48:63]
    s_add_u32 s67, s57, 295936
    buffer_load_dwordx4 v[228:231], v7, s[8:11], s67 offen
    v_and_b32 v186, 0xffff, v185
    v_lshrrev_b32 v187, 16, v185
    ds_read_u16_d16_hi v180, v186 offset:44288
    ds_read_u16_d16_hi v181, v187 offset:44288
    ds_read_b128 v[112:115], v7 offset:24576
    v_mfma_f32_32x32x16_bf16 v[48:63], v[116:119], a[76:79], v[48:63]
    v_mul_f32 v84, v84, v172
    v_mul_f32 v85, v85, v173
    v_cvt_pk_bf16_f32 v82, v84, v85
    v_cvt_pk_bf16_f32 v94, 0, v94
    v_cvt_pk_bf16_f32 v95, 0, v95
    v_add_f32 v94, v94, v166
    ds_read_b128 v[116:119], v7 offset:25600
    s_waitcnt lgkmcnt(6)
    v_mfma_f32_32x32x16_bf16 v[48:63], v[120:123], a[80:83], v[48:63]
    s_add_u32 s67, s57, 368640
    buffer_load_dwordx4 v[232:235], v7, s[8:11], s67 offen
    v_add_f32 v95, v95, v167
    v_cvt_pk_bf16_f32 v188, v94, v95
    v_lshlrev_b32 v94, 16, v188
    v_and_b32 v95, 0xffff0000, v188
    ds_read_b128 v[120:123], v7 offset:26624
    v_mfma_f32_32x32x16_bf16 v[48:63], v[124:127], a[84:87], v[48:63]
    v_pk_lshlrev_b16 v189, s50, v188
    v_pk_max_u16 v189, v189, s52
    v_pk_min_u16 v189, v189, s53
    v_pk_lshrrev_b16 v188, s51, v188
    v_pk_mad_u16 v189, v188, s54, v189
    v_and_b32 v190, 0xffff, v189
    ds_read_b128 v[124:127], v7 offset:27648
    s_waitcnt lgkmcnt(6)
    v_mfma_f32_32x32x16_bf16 v[48:63], v[128:131], a[88:91], v[48:63]
    s_add_u32 s67, s57, 369664
    buffer_load_dwordx4 v[236:239], v7, s[8:11], s67 offen
    v_lshrrev_b32 v191, 16, v189
    ds_read_u16_d16_hi v182, v190 offset:44288
    ds_read_u16_d16_hi v183, v191 offset:44288
    v_mul_f32 v86, v86, v174
    ds_read_b128 v[128:131], v7 offset:28672
    v_mfma_f32_32x32x16_bf16 v[48:63], v[132:135], a[92:95], v[48:63]
    v_mul_f32 v87, v87, v175
    v_cvt_pk_bf16_f32 v83, v86, v87
    ds_write_b128 v9, v[80:83] offset:12288
    v_cvt_pk_bf16_f32 v96, 0, v96
    v_cvt_pk_bf16_f32 v97, 0, v97
    v_add_f32 v96, v96, v152
    ds_read_b128 v[132:135], v7 offset:29696
    s_waitcnt lgkmcnt(7)
    v_mfma_f32_32x32x16_bf16 v[48:63], v[112:115], a[96:99], v[48:63]
    s_add_u32 s67, s57, 442368
    buffer_load_dwordx4 v[240:243], v7, s[8:11], s67 offen
    v_add_f32 v97, v97, v153
    v_cvt_pk_bf16_f32 v184, v96, v97
    v_lshlrev_b32 v96, 16, v184
    v_and_b32 v97, 0xffff0000, v184
    ds_read_b128 v[112:115], v7 offset:30720
    v_mfma_f32_32x32x16_bf16 v[48:63], v[116:119], a[100:103], v[48:63]
    v_pk_lshlrev_b16 v185, s50, v184
    v_pk_max_u16 v185, v185, s52
    v_pk_min_u16 v185, v185, s53
    v_pk_lshrrev_b16 v184, s51, v184
    v_pk_mad_u16 v185, v184, s54, v185
    v_and_b32 v186, 0xffff, v185
    ds_read_b128 v[116:119], v7 offset:31744
    s_waitcnt lgkmcnt(7)
    v_mfma_f32_32x32x16_bf16 v[48:63], v[120:123], a[104:107], v[48:63]
    s_add_u32 s67, s57, 443392
    buffer_load_dwordx4 v[244:247], v7, s[8:11], s67 offen
    v_lshrrev_b32 v187, 16, v185
    ds_read_u16_d16_hi v168, v186 offset:44288
    ds_read_u16_d16_hi v169, v187 offset:44288
    v_mul_f32 v88, v88, v176
    ds_read_b128 v[120:123], v7 offset:32768
    v_mfma_f32_32x32x16_bf16 v[48:63], v[124:127], a[108:111], v[48:63]
    v_mul_f32 v89, v89, v177
    v_cvt_pk_bf16_f32 v88, v88, v89
    v_cvt_pk_bf16_f32 v98, 0, v98
    v_cvt_pk_bf16_f32 v99, 0, v99
    v_add_f32 v98, v98, v154
    v_add_f32 v99, v99, v155
    ds_read_b128 v[124:127], v7 offset:33792
    s_waitcnt lgkmcnt(6)
    v_mfma_f32_32x32x16_bf16 v[48:63], v[128:131], a[112:115], v[48:63]
    s_add_u32 s67, s57, 516096
    buffer_load_dwordx4 v[248:251], v7, s[8:11], s67 offen
    v_cvt_pk_bf16_f32 v188, v98, v99
    v_lshlrev_b32 v98, 16, v188
    v_and_b32 v99, 0xffff0000, v188
    v_pk_lshlrev_b16 v189, s50, v188
    ds_read_b128 v[128:131], v7 offset:34816
    v_mfma_f32_32x32x16_bf16 v[48:63], v[132:135], a[116:119], v[48:63]
    v_pk_max_u16 v189, v189, s52
    v_pk_min_u16 v189, v189, s53
    v_pk_lshrrev_b16 v188, s51, v188
    v_pk_mad_u16 v189, v188, s54, v189
    v_and_b32 v190, 0xffff, v189
    v_lshrrev_b32 v191, 16, v189
    ds_read_b128 v[132:135], v7 offset:35840
    s_waitcnt lgkmcnt(6)
    v_mfma_f32_32x32x16_bf16 v[48:63], v[112:115], a[120:123], v[48:63]
    s_add_u32 s67, s57, 517120
    buffer_load_dwordx4 v[252:255], v7, s[8:11], s67 offen
    ds_read_u16_d16_hi v170, v190 offset:44288
    ds_read_u16_d16_hi v171, v191 offset:44288
    v_mul_f32 v90, v90, v178
    v_mul_f32 v91, v91, v179
    v_mfma_f32_32x32x16_bf16 v[48:63], v[116:119], a[124:127], v[48:63]
    v_cvt_pk_bf16_f32 v89, v90, v91
    v_cvt_pk_bf16_f32 v100, 0, v100
    v_cvt_pk_bf16_f32 v101, 0, v101
    v_add_f32 v100, v100, v156
    v_add_f32 v101, v101, v157
    v_cvt_pk_bf16_f32 v184, v100, v101
    s_waitcnt lgkmcnt(4)
    v_mfma_f32_32x32x16_bf16 v[48:63], v[120:123], a[128:131], v[48:63]
    v_lshlrev_b32 v100, 16, v184
    v_and_b32 v101, 0xffff0000, v184
    v_pk_lshlrev_b16 v185, s50, v184
    v_pk_max_u16 v185, v185, s52
    v_pk_min_u16 v185, v185, s53
    v_pk_lshrrev_b16 v184, s51, v184
    v_mfma_f32_32x32x16_bf16 v[48:63], v[124:127], a[132:135], v[48:63]
    v_pk_mad_u16 v185, v184, s54, v185
    v_and_b32 v186, 0xffff, v185
    v_lshrrev_b32 v187, 16, v185
    ds_read_u16_d16_hi v172, v186 offset:44288
    ds_read_u16_d16_hi v173, v187 offset:44288
    v_mul_f32 v92, v92, v180
    s_waitcnt lgkmcnt(4)
    v_mfma_f32_32x32x16_bf16 v[48:63], v[128:131], a[136:139], v[48:63]
    v_mul_f32 v93, v93, v181
    v_cvt_pk_bf16_f32 v90, v92, v93
    v_cvt_pk_bf16_f32 v102, 0, v102
    v_cvt_pk_bf16_f32 v103, 0, v103
    v_add_f32 v102, v102, v158
    v_add_f32 v103, v103, v159
    v_mfma_f32_32x32x16_bf16 v[48:63], v[132:135], a[140:143], v[48:63]
    v_cvt_pk_bf16_f32 v188, v102, v103
    v_lshlrev_b32 v102, 16, v188
    v_and_b32 v103, 0xffff0000, v188
    v_pk_lshlrev_b16 v189, s50, v188
    v_pk_max_u16 v189, v189, s52
    v_pk_min_u16 v189, v189, s53
    s_branch KF_J2
KF_J1:
    ds_read_b128 v[112:115], v7 offset:0
    ds_read_b128 v[116:119], v7 offset:1024
    ds_read_b128 v[120:123], v7 offset:2048
    ds_read_b128 v[124:127], v7 offset:3072
    ds_read_b128 v[128:131], v7 offset:4096
    v_cvt_pk_bf16_f32 v80, 0, v80
    v_cvt_pk_bf16_f32 v81, 0, v81
    v_add_f32 v80, v80, v152
    v_add_f32 v81, v81, v153
    v_cvt_pk_bf16_f32 v184, v80, v81
    v_lshlrev_b32 v80, 16, v184
    v_and_b32 v81, 0xffff0000, v184
    v_pk_lshlrev_b16 v185, s50, v184
    v_pk_max_u16 v185, v185, s52
    v_pk_min_u16 v185, v185, s53
    v_pk_lshrrev_b16 v184, s51, v184
    v_pk_mad_u16 v185, v184, s54, v185
    v_and_b32 v186, 0xffff, v185
    v_lshrrev_b32 v187, 16, v185
    ds_read_u16_d16_hi v168, v186 offset:44288
    ds_read_u16_d16_hi v169, v187 offset:44288
    v_cvt_pk_bf16_f32 v82, 0, v82
    v_cvt_pk_bf16_f32 v83, 0, v83
    v_add_f32 v82, v82, v154
    v_add_f32 v83, v83, v155
    v_cvt_pk_bf16_f32 v188, v82, v83
    v_lshlrev_b32 v82, 16, v188
    v_and_b32 v83, 0xffff0000, v188
    v_pk_lshlrev_b16 v189, s50, v188
    ds_read_b128 v[132:135], v7 offset:5120
    s_waitcnt lgkmcnt(6)
    v_mfma_f32_32x32x16_bf16 v[48:63], v[112:115], a[144:147], 0
    s_add_u32 s67, s57, 0
    buffer_load_dwordx4 v[192:195], v7, s[8:11], s67 offen
    v_pk_max_u16 v189, v189, s52
    v_pk_min_u16 v189, v189, s53
    v_pk_lshrrev_b16 v188, s51, v188
    v_pk_mad_u16 v189, v188, s54, v189
    ds_read_b128 v[112:115], v7 offset:6144
    v_mfma_f32_32x32x16_bf16 v[48:63], v[116:119], a[148:151], v[48:63]
    v_and_b32 v190, 0xffff, v189
    v_lshrrev_b32 v191, 16, v189
    ds_read_u16_d16_hi v170, v190 offset:44288
    ds_read_u16_d16_hi v171, v191 offset:44288
    v_cvt_pk_bf16_f32 v84, 0, v84
    v_cvt_pk_bf16_f32 v85, 0, v85
    ds_read_b128 v[116:119], v7 offset:7168
    s_waitcnt lgkmcnt(8)
    v_mfma_f32_32x32x16_bf16 v[48:63], v[120:123], a[152:155], v[48:63]
    s_add_u32 s67, s57, 1024
    buffer_load_dwordx4 v[196:199], v7, s[8:11], s67 offen
    v_add_f32 v84, v84, v156
    v_add_f32 v85, v85, v157
    v_cvt_pk_bf16_f32 v184, v84, v85
    v_lshlrev_b32 v84, 16, v184
    ds_read_b128 v[120:123], v7 offset:8192
    v_mfma_f32_32x32x16_bf16 v[48:63], v[124:127], a[156:159], v[48:63]
    v_and_b32 v85, 0xffff0000, v184
    v_pk_lshlrev_b16 v185, s50, v184
    v_pk_max_u16 v185, v185, s52
    v_pk_min_u16 v185, v185, s53
    v_pk_lshrrev_b16 v184, s51, v184
    v_pk_mad_u16 v185, v184, s54, v185
    ds_read_b128 v[124:127], v7 offset:9216
    s_waitcnt lgkmcnt(6)
    v_mfma_f32_32x32x16_bf16 v[48:63], v[128:131], a[160:163], v[48:63]
    s_add_u32 s67, s57, 73728
    buffer_load_dwordx4 v[200:203], v7, s[8:11], s67 offen
    v_and_b32 v186, 0xffff, v185
    v_lshrrev_b32 v187, 16, v185
    ds_read_u16_d16_hi v172, v186 offset:44288
    ds_read_u16_d16_hi v173, v187 offset:44288
    ds_read_b128 v[128:131], v7 offset:10240
    v_mfma_f32_32x32x16_bf16 v[48:63], v[132:135], a[164:167], v[48:63]
    v_cvt_pk_bf16_f32 v86, 0, v86
    v_cvt_pk_bf16_f32 v87, 0, v87
    v_add_f32 v86, v86, v158
    v_add_f32 v87, v87, v159
    v_cvt_pk_bf16_f32 v188, v86, v87
    v_lshlrev_b32 v86, 16, v188
    ds_read_b128 v[132:135], v7 offset:11264
    s_waitcnt lgkmcnt(6)
    v_mfma_f32_32x32x16_bf16 v[48:63], v[112:115], a[168:171], v[48:63]
    s_add_u32 s67, s57, 74752
    buffer_load_dwordx4 v[204:207], v7, s[8:11], s67 offen
    v_and_b32 v87, 0xffff0000, v188
    v_pk_lshlrev_b16 v189, s50, v188
    v_pk_max_u16 v189, v189, s52
    v_pk_min_u16 v189, v189, s53
    ds_read_b128 v[112:115], v7 offset:12288
    v_mfma_f32_32x32x16_bf16 v[48:63], v[116:119], a[172:175], v[48:63]
    v_pk_lshrrev_b16 v188, s51, v188
    v_pk_mad_u16 v189, v188, s54, v189
    v_and_b32 v190, 0xffff, v189
    v_lshrrev_b32 v191, 16, v189
    ds_read_u16_d16_hi v174, v190 offset:44288
    ds_read_u16_d16_hi v175, v191 offset:44288
    ds_read_b128 v[116:119], v7 offset:13312
    s_waitcnt lgkmcnt(8)
    v_mfma_f32_32x32x16_bf16 v[48:63], v[120:123], a[176:179], v[48:63]
    s_add_u32 s67, s57, 147456
    buffer_load_dwordx4 v[208:211], v7, s[8:11], s67 offen
    v_cvt_pk_bf16_f32 v88, 0, v88
    v_cvt_pk_bf16_f32 v89, 0, v89
    v_add_f32 v88, v88, v160
    v_add_f32 v89, v89, v161
    ds_read_b128 v[120:123], v7 offset:14336
    v_mfma_f32_32x32x16_bf16 v[48:63], v[124:127], a[180:183], v[48:63]
    v_cvt_pk_bf16_f32 v184, v88, v89
    v_lshlrev_b32 v88, 16, v184
    v_and_b32 v89, 0xffff0000, v184
    v_pk_lshlrev_b16 v185, s50, v184
    v_pk_max_u16 v185, v185, s52
    v_pk_min_u16 v185, v185, s53
    ds_read_b128 v[124:127], v7 offset:15360
    s_waitcnt lgkmcnt(6)
    v_mfma_f32_32x32x16_bf16 v[48:63], v[128:131], a[184:187], v[48:63]
    s_add_u32 s67, s57, 148480
    buffer_load_dwordx4 v[212:215], v7, s[8:11], s67 offen
    v_pk_lshrrev_b16 v184, s51, v184
    v_pk_mad_u16 v185, v184, s54, v185
    v_and_b32 v186, 0xffff, v185
    v_lshrrev_b32 v187, 16, v185
    ds_read_b128 v[128:131], v7 offset:16384
    v_mfma_f32_32x32x16_bf16 v[48:63], v[132:135], a[188:191], v[48:63]
    ds_read_u16_d16_hi v176, v186 offset:44288
    ds_read_u16_d16_hi v177, v187 offset:44288
    v_mul_f32 v80, v80, v168
    v_mul_f32 v81, v81, v169
    v_cvt_pk_bf16_f32 v80, v80, v81
    v_cvt_pk_bf16_f32 v90, 0, v90
    ds_read_b128 v[132:135], v7 offset:17408
    s_waitcnt lgkmcnt(6)
    v_mfma_f32_32x32x16_bf16 v[48:63], v[112:115], a[192:195], v[48:63]
    s_add_u32 s67, s57, 221184
    buffer_load_dwordx4 v[216:219], v7, s[8:11], s67 offen
    v_cvt_pk_bf16_f32 v91, 0, v91
    v_add_f32 v90, v90, v162
    v_add_f32 v91, v91, v163
    v_cvt_pk_bf16_f32 v188, v90, v91
    ds_read_b128 v[112:115], v7 offset:18432
    v_mfma_f32_32x32x16_bf16 v[48:63], v[116:119], a[196:199], v[48:63]
    v_lshlrev_b32 v90, 16, v188
    v_and_b32 v91, 0xffff0000, v188
    v_pk_lshlrev_b16 v189, s50, v188
    v_pk_max_u16 v189, v189, s52
    v_pk_min_u16 v189, v189, s53
    v_pk_lshrrev_b16 v188, s51, v188
    ds_read_b128 v[116:119], v7 offset:19456
    s_waitcnt lgkmcnt(6)
    v_mfma_f32_32x32x16_bf16 v[48:63], v[120:123], a[200:203], v[48:63]
    s_add_u32 s67, s57, 222208
    buffer_load_dwordx4 v[220:223], v7, s[8:11], s67 offen
    v_pk_mad_u16 v189, v188, s54, v189
    v_and_b32 v190, 0xffff, v189
    v_lshrrev_b32 v191, 16, v189
    ds_read_u16_d16_hi v178, v190 offset:44288
    ds_read_b128 v[120:123], v7 offset:20480
    v_mfma_f32_32x32x16_bf16 v[48:63], v[124:127], a[204:207], v[48:63]
    ds_read_u16_d16_hi v179, v191 offset:44288
    v_mul_f32 v82, v82, v170
    v_mul_f32 v83, v83, v171
    v_cvt_pk_bf16_f32 v81, v82, v83
    v_cvt_pk_bf16_f32 v92, 0, v92
    v_cvt_pk_bf16_f32 v93, 0, v93
    ds_read_b128 v[124:127], v7 offset:21504
    s_waitcnt lgkmcnt(6)
    v_mfma_f32_32x32x16_bf16 v[48:63], v[128:131], a[208:211], v[48:63]
    s_add_u32 s67, s57, 294912
    buffer_load_dwordx4 v[224:227], v7, s[8:11], s67 offen
    v_add_f32 v92, v92, v164
    v_add_f32 v93, v93, v165
    v_cvt_pk_bf16_f32 v184, v92, v93
    v_lshlrev_b32 v92, 16, v184
    ds_read_b128 v[128:131], v7 offset:22528
    v_mfma_f32_32x32x16_bf16 v[48:63], v[132:135], a[212:215], v[48:63]
    v_and_b32 v93, 0xffff0000, v184
    v_pk_lshlrev_b16 v185, s50, v184
    v_pk_max_u16 v185, v185, s52
    v_pk_min_u16 v185, v185, s53
    v_pk_lshrrev_b16 v184, s51, v184
    v_pk_mad_u16 v185, v184, s54, v185
    ds_read_b128 v[132:135], v7 offset:23552
    s_waitcnt lgkmcnt(6)
    v_mfma_f32_32x32x16_bf16 v[48:63], v[112:115], a[216:219], v[48:63]
    s_add_u32 s67, s57, 295936
    buffer_load_dwordx4 v[228:231], v7, s[8:11], s67 offen
    v_and_b32 v186, 0xffff, v185
    v_lshrrev_b32 v187, 16, v185
    ds_read_u16_d16_hi v180, v186 offset:44288
    ds_read_u16_d16_hi v181, v187 offset:44288
    ds_read_b128 v[112:115], v7 offset:24576
    v_mfma_f32_32x32x16_bf16 v[48:63], v[116:119], a[220:223], v[48:63]
    v_mul_f32 v84, v84, v172
    v_mul_f32 v85, v85, v173
    v_cvt_pk_bf16_f32 v82, v84, v85
    v_cvt_pk_bf16_f32 v94, 0, v94
    v_cvt_pk_bf16_f32 v95, 0, v95
    v_add_f32 v94, v94, v166
    ds_read_b128 v[116:119], v7 offset:25600
    s_waitcnt lgkmcnt(6)
    v_mfma_f32_32x32x16_bf16 v[48:63], v[120:123], a[224:227], v[48:63]
    s_add_u32 s67, s57, 368640
    buffer_load_dwordx4 v[232:235], v7, s[8:11], s67 offen
    v_add_f32 v95, v95, v167
    v_cvt_pk_bf16_f32 v188, v94, v95
    v_lshlrev_b32 v94, 16, v188
    v_and_b32 v95, 0xffff0000, v188
    ds_read_b128 v[120:123], v7 offset:26624
    v_mfma_f32_32x32x16_bf16 v[48:63], v[124:127], a[228:231], v[48:63]
    v_pk_lshlrev_b16 v189, s50, v188
    v_pk_max_u16 v189, v189, s52
    v_pk_min_u16 v189, v189, s53
    v_pk_lshrrev_b16 v188, s51, v188
    v_pk_mad_u16 v189, v188, s54, v189
    v_and_b32 v190, 0xffff, v189
    ds_read_b128 v[124:127], v7 offset:27648
    s_waitcnt lgkmcnt(6)
    v_mfma_f32_32x32x16_bf16 v[48:63], v[128:131], a[232:235], v[48:63]
    s_add_u32 s67, s57, 369664
    buffer_load_dwordx4 v[236:239], v7, s[8:11], s67 offen
    v_lshrrev_b32 v191, 16, v189
    ds_read_u16_d16_hi v182, v190 offset:44288
    ds_read_u16_d16_hi v183, v191 offset:44288
    v_mul_f32 v86, v86, v174
    ds_read_b128 v[128:131], v7 offset:28672
    v_mfma_f32_32x32x16_bf16 v[48:63], v[132:135], a[236:239], v[48:63]
    v_mul_f32 v87, v87, v175
    v_cvt_pk_bf16_f32 v83, v86, v87
    ds_write_b128 v9, v[80:83] offset:12288
    v_cvt_pk_bf16_f32 v96, 0, v96
    v_cvt_pk_bf16_f32 v97, 0, v97
    v_add_f32 v96, v96, v152
    ds_read_b128 v[132:135], v7 offset:29696
    s_waitcnt lgkmcnt(7)
    v_mfma_f32_32x32x16_bf16 v[48:63], v[112:115], a[240:243], v[48:63]
    s_add_u32 s67, s57, 442368
    buffer_load_dwordx4 v[240:243], v7, s[8:11], s67 offen
    v_add_f32 v97, v97, v153
    v_cvt_pk_bf16_f32 v184, v96, v97
    v_lshlrev_b32 v96, 16, v184
    v_and_b32 v97, 0xffff0000, v184
    ds_read_b128 v[112:115], v7 offset:30720
    v_mfma_f32_32x32x16_bf16 v[48:63], v[116:119], a[244:247], v[48:63]
    v_pk_lshlrev_b16 v185, s50, v184
    v_pk_max_u16 v185, v185, s52
    v_pk_min_u16 v185, v185, s53
    v_pk_lshrrev_b16 v184, s51, v184
    v_pk_mad_u16 v185, v184, s54, v185
    v_and_b32 v186, 0xffff, v185
    ds_read_b128 v[116:119], v7 offset:31744
    s_waitcnt lgkmcnt(7)
    v_mfma_f32_32x32x16_bf16 v[48:63], v[120:123], a[248:251], v[48:63]
    s_add_u32 s67, s57, 443392
    buffer_load_dwordx4 v[244:247], v7, s[8:11], s67 offen
    v_lshrrev_b32 v187, 16, v185
    ds_read_u16_d16_hi v168, v186 offset:44288
    ds_read_u16_d16_hi v169, v187 offset:44288
    v_mul_f32 v88, v88, v176
    ds_read_b128 v[120:123], v7 offset:32768
    v_mfma_f32_32x32x16_bf16 v[48:63], v[124:127], a[252:255], v[48:63]
    v_mul_f32 v89, v89, v177
    v_cvt_pk_bf16_f32 v88, v88, v89
    v_cvt_pk_bf16_f32 v98, 0, v98
    v_cvt_pk_bf16_f32 v99, 0, v99
    v_add_f32 v98, v98, v154
    v_add_f32 v99, v99, v155
    ds_read_b128 v[124:127], v7 offset:33792
    s_waitcnt lgkmcnt(6)
    v_mfma_f32_32x32x16_bf16 v[48:63], v[128:131], v[16:19], v[48:63]
    s_add_u32 s67, s57, 516096
    buffer_load_dwordx4 v[248:251], v7, s[8:11], s67 offen
    v_cvt_pk_bf16_f32 v188, v98, v99
    v_lshlrev_b32 v98, 16, v188
    v_and_b32 v99, 0xffff0000, v188
    v_pk_lshlrev_b16 v189, s50, v188
    ds_read_b128 v[128:131], v7 offset:34816
    v_mfma_f32_32x32x16_bf16 v[48:63], v[132:135], v[20:23], v[48:63]
    v_pk_max_u16 v189, v189, s52
    v_pk_min_u16 v189, v189, s53
    v_pk_lshrrev_b16 v188, s51, v188
    v_pk_mad_u16 v189, v188, s54, v189
    v_and_b32 v190, 0xffff, v189
    v_lshrrev_b32 v191, 16, v189
    ds_read_b128 v[132:135], v7 offset:35840
    s_waitcnt lgkmcnt(6)
    v_mfma_f32_32x32x16_bf16 v[48:63], v[112:115], v[24:27], v[48:63]
    s_add_u32 s67, s57, 517120
    buffer_load_dwordx4 v[252:255], v7, s[8:11], s67 offen
    ds_read_u16_d16_hi v170, v190 offset:44288
    ds_read_u16_d16_hi v171, v191 offset:44288
    v_mul_f32 v90, v90, v178
    v_mul_f32 v91, v91, v179
    v_mfma_f32_32x32x16_bf16 v[48:63], v[116:119], v[28:31], v[48:63]
    v_cvt_pk_bf16_f32 v89, v90, v91
    v_cvt_pk_bf16_f32 v100, 0, v100
    v_cvt_pk_bf16_f32 v101, 0, v101
    v_add_f32 v100, v100, v156
    v_add_f32 v101, v101, v157
    v_cvt_pk_bf16_f32 v184, v100, v101
    s_waitcnt lgkmcnt(4)
    v_mfma_f32_32x32x16_bf16 v[48:63], v[120:123], v[32:35], v[48:63]
    v_lshlrev_b32 v100, 16, v184
    v_and_b32 v101, 0xffff0000, v184
    v_pk_lshlrev_b16 v185, s50, v184
    v_pk_max_u16 v185, v185, s52
    v_pk_min_u16 v185, v185, s53
    v_pk_lshrrev_b16 v184, s51, v184
    v_mfma_f32_32x32x16_bf16 v[48:63], v[124:127], v[36:39], v[48:63]
    v_pk_mad_u16 v185, v184, s54, v185
    v_and_b32 v186, 0xffff, v185
    v_lshrrev_b32 v187, 16, v185
    ds_read_u16_d16_hi v172, v186 offset:44288
    ds_read_u16_d16_hi v173, v187 offset:44288
    v_mul_f32 v92, v92, v180
    s_waitcnt lgkmcnt(4)
    v_mfma_f32_32x32x16_bf16 v[48:63], v[128:131], v[40:43], v[48:63]
    v_mul_f32 v93, v93, v181
    v_cvt_pk_bf16_f32 v90, v92, v93
    v_cvt_pk_bf16_f32 v102, 0, v102
    v_cvt_pk_bf16_f32 v103, 0, v103
    v_add_f32 v102, v102, v158
    v_add_f32 v103, v103, v159
    v_mfma_f32_32x32x16_bf16 v[48:63], v[132:135], v[44:47], v[48:63]
    v_cvt_pk_bf16_f32 v188, v102, v103
    v_lshlrev_b32 v102, 16, v188
    v_and_b32 v103, 0xffff0000, v188
    v_pk_lshlrev_b16 v189, s50, v188
    v_pk_max_u16 v189, v189, s52
    v_pk_min_u16 v189, v189, s53
KF_J2:
    s_barrier
    s_mov_b32 s64, s60
    v_add_u32 v6, 83456, v7
    v_add_u32 v15, 36864, v6
    ds_read_b128 a[0:3], v6 offset:0
    ds_read_b128 a[64:67], v6 offset:18432
    ds_read_b128 a[128:131], v15 offset:0
    ds_read_b128 a[192:195], v15 offset:18432
    ds_read_b128 a[4:7], v6 offset:1024
    ds_read_b128 a[68:71], v6 offset:19456
    ds_read_b128 a[132:135], v15 offset:1024
    ds_read_b128 a[196:199], v15 offset:19456
    ds_read_b128 a[8:11], v6 offset:2048
    ds_read_b128 a[72:75], v6 offset:20480
    ds_read_b128 a[136:139], v15 offset:2048
    ds_read_b128 a[200:203], v15 offset:20480
    s_waitcnt vmcnt(15)
    s_waitcnt lgkmcnt(11)
    v_mfma_f32_32x32x16_bf16 v[16:31], v[192:195], a[0:3], 0
    v_pk_lshrrev_b16 v188, s51, v188
    v_pk_mad_u16 v189, v188, s54, v189
    v_and_b32 v190, 0xffff, v189
    v_lshrrev_b32 v191, 16, v189
    ds_read_u16_d16_hi v174, v190 offset:44288
    s_waitcnt lgkmcnt(11)
    v_mfma_f32_32x32x16_bf16 v[32:47], v[192:195], a[64:67], 0
    ds_read_u16_d16_hi v175, v191 offset:44288
    v_mul_f32 v94, v94, v182
    v_mul_f32 v95, v95, v183
    v_cvt_pk_bf16_f32 v91, v94, v95
    ds_write_b128 v9, v[88:91] offset:13312
    s_waitcnt lgkmcnt(12)
    v_mfma_f32_32x32x16_bf16 v[64:79], v[192:195], a[128:131], 0
    v_cvt_pk_bf16_f32 v104, 0, v104
    v_cvt_pk_bf16_f32 v105, 0, v105
    v_add_f32 v104, v104, v160
    v_add_f32 v105, v105, v161
    v_cvt_pk_bf16_f32 v184, v104, v105
    s_waitcnt lgkmcnt(11)
    v_mfma_f32_32x32x16_bf16 v[112:127], v[192:195], a[192:195], 0
    v_lshlrev_b32 v104, 16, v184
    v_and_b32 v105, 0xffff0000, v184
    v_pk_lshlrev_b16 v185, s50, v184
    v_pk_max_u16 v185, v185, s52
    v_pk_min_u16 v185, v185, s53
    s_add_u32 s67, s57, 589824
    buffer_load_dwordx4 v[192:195], v7, s[8:11], s67 offen
    ds_read_b128 a[12:15], v6 offset:3072
    ds_read_b128 a[76:79], v6 offset:21504
    ds_read_b128 a[140:143], v15 offset:3072
    ds_read_b128 a[204:207], v15 offset:21504
    s_waitcnt vmcnt(15)
    s_waitcnt lgkmcnt(14)
    v_mfma_f32_32x32x16_bf16 v[16:31], v[196:199], a[4:7], v[16:31]
    v_pk_lshrrev_b16 v184, s51, v184
    v_pk_mad_u16 v185, v184, s54, v185
    v_and_b32 v186, 0xffff, v185
    v_lshrrev_b32 v187, 16, v185
    ds_read_u16_d16_hi v176, v186 offset:44288
    s_waitcnt lgkmcnt(14)
    v_mfma_f32_32x32x16_bf16 v[32:47], v[196:199], a[68:71], v[32:47]
    ds_read_u16_d16_hi v177, v187 offset:44288
    v_mul_f32 v96, v96, v168
    v_mul_f32 v97, v97, v169
    v_cvt_pk_bf16_f32 v96, v96, v97
    v_cvt_pk_bf16_f32 v106, 0, v106
    s_waitcnt lgkmcnt(14)
    v_mfma_f32_32x32x16_bf16 v[64:79], v[196:199], a[132:135], v[64:79]
    v_cvt_pk_bf16_f32 v107, 0, v107
    v_add_f32 v106, v106, v162
    v_add_f32 v107, v107, v163
    v_cvt_pk_bf16_f32 v188, v106, v107
    v_lshlrev_b32 v106, 16, v188
    s_waitcnt lgkmcnt(13)
    v_mfma_f32_32x32x16_bf16 v[112:127], v[196:199], a[196:199], v[112:127]
    v_and_b32 v107, 0xffff0000, v188
    v_pk_lshlrev_b16 v189, s50, v188
    v_pk_max_u16 v189, v189, s52
    v_pk_min_u16 v189, v189, s53
    v_pk_lshrrev_b16 v188, s51, v188
    s_add_u32 s67, s57, 590848
    buffer_load_dwordx4 v[196:199], v7, s[8:11], s67 offen
    ds_read_b128 a[16:19], v6 offset:4096
    ds_read_b128 a[80:83], v6 offset:22528
    ds_read_b128 a[144:147], v15 offset:4096
    ds_read_b128 a[208:211], v15 offset:22528
    s_waitcnt vmcnt(15)
    s_waitcnt lgkmcnt(15)
    v_mfma_f32_32x32x16_bf16 v[16:31], v[200:203], a[8:11], v[16:31]
    v_pk_mad_u16 v189, v188, s54, v189
    v_and_b32 v190, 0xffff, v189
    v_lshrrev_b32 v191, 16, v189
    ds_read_u16_d16_hi v178, v190 offset:44288
    ds_read_u16_d16_hi v179, v191 offset:44288
    v_mfma_f32_32x32x16_bf16 v[32:47], v[200:203], a[72:75], v[32:47]
    v_mul_f32 v98, v98, v170
    v_mul_f32 v99, v99, v171
    v_cvt_pk_bf16_f32 v97, v98, v99
    v_cvt_pk_bf16_f32 v108, 0, v108
    v_cvt_pk_bf16_f32 v109, 0, v109
    s_waitcnt lgkmcnt(15)
    v_mfma_f32_32x32x16_bf16 v[64:79], v[200:203], a[136:139], v[64:79]
    v_add_f32 v108, v108, v164
    v_add_f32 v109, v109, v165
    v_cvt_pk_bf16_f32 v184, v108, v109
    v_lshlrev_b32 v108, 16, v184
    v_and_b32 v109, 0xffff0000, v184
    v_mfma_f32_32x32x16_bf16 v[112:127], v[200:203], a[200:203], v[112:127]
    v_pk_lshlrev_b16 v185, s50, v184
    v_pk_max_u16 v185, v185, s52
    v_pk_min_u16 v185, v185, s53
    v_pk_lshrrev_b16 v184, s51, v184
    v_pk_mad_u16 v185, v184, s54, v185
    s_add_u32 s67, s57, 8192
    buffer_load_dwordx4 v[200:203], v7, s[8:11], s67 offen
    ds_read_b128 a[20:23], v6 offset:5120
    ds_read_b128 a[84:87], v6 offset:23552
    ds_read_b128 a[148:151], v15 offset:5120
    ds_read_b128 a[212:215], v15 offset:23552
    s_waitcnt vmcnt(15)
    s_waitcnt lgkmcnt(15)
    v_mfma_f32_32x32x16_bf16 v[16:31], v[204:207], a[12:15], v[16:31]
    v_and_b32 v186, 0xffff, v185
    v_lshrrev_b32 v187, 16, v185
    ds_read_u16_d16_hi v180, v186 offset:44288
    ds_read_u16_d16_hi v181, v187 offset:44288
    v_mul_f32 v100, v100, v172
    s_waitcnt lgkmcnt(15)
    v_mfma_f32_32x32x16_bf16 v[32:47], v[204:207], a[76:79], v[32:47]
    v_mul_f32 v101, v101, v173
    v_cvt_pk_bf16_f32 v98, v100, v101
    v_cvt_pk_bf16_f32 v110, 0, v110
    v_cvt_pk_bf16_f32 v111, 0, v111
    v_add_f32 v110, v110, v166
    v_mfma_f32_32x32x16_bf16 v[64:79], v[204:207], a[140:143], v[64:79]
    v_add_f32 v111, v111, v167
    v_cvt_pk_bf16_f32 v188, v110, v111
    v_lshlrev_b32 v110, 16, v188
    v_and_b32 v111, 0xffff0000, v188
    v_pk_lshlrev_b16 v189, s50, v188
    s_waitcnt lgkmcnt(14)
    v_mfma_f32_32x32x16_bf16 v[112:127], v[204:207], a[204:207], v[112:127]
    v_pk_max_u16 v189, v189, s52
    v_pk_min_u16 v189, v189, s53
    v_pk_lshrrev_b16 v188, s51, v188
    v_pk_mad_u16 v189, v188, s54, v189
    v_and_b32 v190, 0xffff, v189
    s_add_u32 s67, s57, 9216
    buffer_load_dwordx4 v[204:207], v7, s[8:11], s67 offen
    ds_read_b128 a[24:27], v6 offset:6144
    ds_read_b128 a[88:91], v6 offset:24576
    ds_read_b128 a[152:155], v15 offset:6144
    ds_read_b128 a[216:219], v15 offset:24576
    s_waitcnt vmcnt(15)
    s_waitcnt lgkmcnt(15)
    v_mfma_f32_32x32x16_bf16 v[16:31], v[208:211], a[16:19], v[16:31]
    v_lshrrev_b32 v191, 16, v189
    ds_read_u16_d16_hi v182, v190 offset:44288
    ds_read_u16_d16_hi v183, v191 offset:44288
    v_mul_f32 v102, v102, v174
    v_mul_f32 v103, v103, v175
    s_waitcnt lgkmcnt(15)
    v_mfma_f32_32x32x16_bf16 v[32:47], v[208:211], a[80:83], v[32:47]
    v_cvt_pk_bf16_f32 v99, v102, v103
    ds_write_b128 v9, v[96:99] offset:30720
    v_mul_f32 v104, v104, v176
    v_mul_f32 v105, v105, v177
    v_cvt_pk_bf16_f32 v104, v104, v105
    v_mfma_f32_32x32x16_bf16 v[64:79], v[208:211], a[144:147], v[64:79]
    s_waitcnt lgkmcnt(13)
    v_mul_f32 v106, v106, v178
    v_mul_f32 v107, v107, v179
    v_cvt_pk_bf16_f32 v105, v106, v107
    s_waitcnt lgkmcnt(7)
    v_mul_f32 v108, v108, v180
    v_mul_f32 v109, v109, v181
    v_mfma_f32_32x32x16_bf16 v[112:127], v[208:211], a[208:211], v[112:127]
    v_cvt_pk_bf16_f32 v106, v108, v109
    s_waitcnt lgkmcnt(1)
    v_mul_f32 v110, v110, v182
    v_mul_f32 v111, v111, v183
    v_cvt_pk_bf16_f32 v107, v110, v111
    ds_write_b128 v9, v[104:107] offset:31744
    s_add_u32 s67, s57, 81920
    buffer_load_dwordx4 v[208:211], v7, s[8:11], s67 offen
    ds_read_b128 a[28:31], v6 offset:7168
    ds_read_b128 a[92:95], v6 offset:25600
    ds_read_b128 a[156:159], v15 offset:7168
    ds_read_b128 a[220:223], v15 offset:25600
    s_waitcnt vmcnt(15)
    v_mfma_f32_32x32x16_bf16 v[16:31], v[212:215], a[20:23], v[16:31]
    v_cvt_pk_bf16_f32 v48, 0, v48
    v_cvt_pk_bf16_f32 v49, 0, v49
    v_add_f32 v48, v48, v136
    v_add_f32 v49, v49, v137
    v_cvt_pk_bf16_f32 v184, v48, v49
    v_mfma_f32_32x32x16_bf16 v[32:47], v[212:215], a[84:87], v[32:47]
    v_lshlrev_b32 v48, 16, v184
    v_and_b32 v49, 0xffff0000, v184
    v_pk_lshlrev_b16 v185, s50, v184
    v_pk_max_u16 v185, v185, s52
    v_pk_min_u16 v185, v185, s53
    v_mfma_f32_32x32x16_bf16 v[64:79], v[212:215], a[148:151], v[64:79]
    v_pk_lshrrev_b16 v184, s51, v184
    v_pk_mad_u16 v185, v184, s54, v185
    v_and_b32 v186, 0xffff, v185
    v_lshrrev_b32 v187, 16, v185
    ds_read_u16_d16_hi v168, v186 offset:44288
    v_mfma_f32_32x32x16_bf16 v[112:127], v[212:215], a[212:215], v[112:127]
    ds_read_u16_d16_hi v169, v187 offset:44288
    v_cvt_pk_bf16_f32 v50, 0, v50
    v_cvt_pk_bf16_f32 v51, 0, v51
    v_add_f32 v50, v50, v138
    v_add_f32 v51, v51, v139
    s_add_u32 s67, s57, 82944
    buffer_load_dwordx4 v[212:215], v7, s[8:11], s67 offen
    ds_read_b128 a[32:35], v6 offset:8192
    ds_read_b128 a[96:99], v6 offset:26624
    ds_read_b128 a[160:163], v15 offset:8192
    ds_read_b128 a[224:227], v15 offset:26624
    s_waitcnt vmcnt(15)
    v_mfma_f32_32x32x16_bf16 v[16:31], v[216:219], a[24:27], v[16:31]
    v_cvt_pk_bf16_f32 v188, v50, v51
    v_lshlrev_b32 v50, 16, v188
    v_and_b32 v51, 0xffff0000, v188
    v_pk_lshlrev_b16 v189, s50, v188
    v_pk_max_u16 v189, v189, s52
    v_mfma_f32_32x32x16_bf16 v[32:47], v[216:219], a[88:91], v[32:47]
    v_pk_min_u16 v189, v189, s53
    v_pk_lshrrev_b16 v188, s51, v188
    v_pk_mad_u16 v189, v188, s54, v189
    v_and_b32 v190, 0xffff, v189
    v_lshrrev_b32 v191, 16, v189
    v_mfma_f32_32x32x16_bf16 v[64:79], v[216:219], a[152:155], v[64:79]
    ds_read_u16_d16_hi v170, v190 offset:44288
    ds_read_u16_d16_hi v171, v191 offset:44288
    v_cvt_pk_bf16_f32 v52, 0, v52
    v_cvt_pk_bf16_f32 v53, 0, v53
    v_add_f32 v52, v52, v140
    v_mfma_f32_32x32x16_bf16 v[112:127], v[216:219], a[216:219], v[112:127]
    v_add_f32 v53, v53, v141
    v_cvt_pk_bf16_f32 v184, v52, v53
    v_lshlrev_b32 v52, 16, v184
    v_and_b32 v53, 0xffff0000, v184
    v_pk_lshlrev_b16 v185, s50, v184
    s_add_u32 s67, s57, 155648
    buffer_load_dwordx4 v[216:219], v7, s[8:11], s67 offen
    ds_read_b128 a[36:39], v6 offset:9216
    ds_read_b128 a[100:103], v6 offset:27648
    ds_read_b128 a[164:167], v15 offset:9216
    ds_read_b128 a[228:231], v15 offset:27648
    s_waitcnt vmcnt(15)
    s_waitcnt lgkmcnt(15)
    v_mfma_f32_32x32x16_bf16 v[16:31], v[220:223], a[28:31], v[16:31]
    v_pk_max_u16 v185, v185, s52
    v_pk_min_u16 v185, v185, s53
    v_pk_lshrrev_b16 v184, s51, v184
    v_pk_mad_u16 v185, v184, s54, v185
    v_and_b32 v186, 0xffff, v185
    s_waitcnt lgkmcnt(14)
    v_mfma_f32_32x32x16_bf16 v[32:47], v[220:223], a[92:95], v[32:47]
    v_lshrrev_b32 v187, 16, v185
    ds_read_u16_d16_hi v172, v186 offset:44288
    ds_read_u16_d16_hi v173, v187 offset:44288
    v_cvt_pk_bf16_f32 v54, 0, v54
    v_cvt_pk_bf16_f32 v55, 0, v55
    s_waitcnt lgkmcnt(15)
    v_mfma_f32_32x32x16_bf16 v[64:79], v[220:223], a[156:159], v[64:79]
    v_add_f32 v54, v54, v142
    v_add_f32 v55, v55, v143
    v_cvt_pk_bf16_f32 v188, v54, v55
    v_lshlrev_b32 v54, 16, v188
    v_and_b32 v55, 0xffff0000, v188
    s_waitcnt lgkmcnt(14)
    v_mfma_f32_32x32x16_bf16 v[112:127], v[220:223], a[220:223], v[112:127]
    v_pk_lshlrev_b16 v189, s50, v188
    v_pk_max_u16 v189, v189, s52
    v_pk_min_u16 v189, v189, s53
    v_pk_lshrrev_b16 v188, s51, v188
    v_pk_mad_u16 v189, v188, s54, v189
    s_add_u32 s67, s57, 156672
    buffer_load_dwordx4 v[220:223], v7, s[8:11], s67 offen
    ds_read_b128 a[40:43], v6 offset:10240
    ds_read_b128 a[104:107], v6 offset:28672
    ds_read_b128 a[168:171], v15 offset:10240
    ds_read_b128 a[232:235], v15 offset:28672
    s_waitcnt vmcnt(15)
    s_waitcnt lgkmcnt(15)
    v_mfma_f32_32x32x16_bf16 v[16:31], v[224:227], a[32:35], v[16:31]
    v_and_b32 v190, 0xffff, v189
    v_lshrrev_b32 v191, 16, v189
    ds_read_u16_d16_hi v174, v190 offset:44288
    ds_read_u16_d16_hi v175, v191 offset:44288
    v_cvt_pk_bf16_f32 v56, 0, v56
    s_waitcnt lgkmcnt(15)
    v_mfma_f32_32x32x16_bf16 v[32:47], v[224:227], a[96:99], v[32:47]
    v_cvt_pk_bf16_f32 v57, 0, v57
    v_add_f32 v56, v56, v144
    v_add_f32 v57, v57, v145
    v_cvt_pk_bf16_f32 v184, v56, v57
    v_lshlrev_b32 v56, 16, v184
    v_mfma_f32_32x32x16_bf16 v[64:79], v[224:227], a[160:163], v[64:79]
    v_and_b32 v57, 0xffff0000, v184
    v_pk_lshlrev_b16 v185, s50, v184
    v_pk_max_u16 v185, v185, s52
    v_pk_min_u16 v185, v185, s53
    v_pk_lshrrev_b16 v184, s51, v184
    s_waitcnt lgkmcnt(14)
    v_mfma_f32_32x32x16_bf16 v[112:127], v[224:227], a[224:227], v[112:127]
    v_pk_mad_u16 v185, v184, s54, v185
    v_and_b32 v186, 0xffff, v185
    v_lshrrev_b32 v187, 16, v185
    ds_read_u16_d16_hi v176, v186 offset:44288
    ds_read_u16_d16_hi v177, v187 offset:44288
    s_add_u32 s67, s57, 229376
    buffer_load_dwordx4 v[224:227], v7, s[8:11], s67 offen
    ds_read_b128 a[44:47], v6 offset:11264
    ds_read_b128 a[108:111], v6 offset:29696
    ds_read_b128 a[172:175], v15 offset:11264
    ds_read_b128 a[236:239], v15 offset:29696
    s_waitcnt vmcnt(15)
    s_waitcnt lgkmcnt(15)
    v_mfma_f32_32x32x16_bf16 v[16:31], v[228:231], a[36:39], v[16:31]
    v_mul_f32 v48, v48, v168
    v_mul_f32 v49, v49, v169
    v_cvt_pk_bf16_f32 v48, v48, v49
    v_cvt_pk_bf16_f32 v58, 0, v58
    v_cvt_pk_bf16_f32 v59, 0, v59
    v_mfma_f32_32x32x16_bf16 v[32:47], v[228:231], a[100:103], v[32:47]
    v_add_f32 v58, v58, v146
    v_add_f32 v59, v59, v147
    v_cvt_pk_bf16_f32 v188, v58, v59
    v_lshlrev_b32 v58, 16, v188
    v_and_b32 v59, 0xffff0000, v188
    v_mfma_f32_32x32x16_bf16 v[64:79], v[228:231], a[164:167], v[64:79]
    v_pk_lshlrev_b16 v189, s50, v188
    v_pk_max_u16 v189, v189, s52
    v_pk_min_u16 v189, v189, s53
    v_pk_lshrrev_b16 v188, s51, v188
    v_pk_mad_u16 v189, v188, s54, v189
    s_waitcnt lgkmcnt(14)
    v_mfma_f32_32x32x16_bf16 v[112:127], v[228:231], a[228:231], v[112:127]
    v_and_b32 v190, 0xffff, v189
    v_lshrrev_b32 v191, 16, v189
    ds_read_u16_d16_hi v178, v190 offset:44288
    ds_read_u16_d16_hi v179, v191 offset:44288
    v_mul_f32 v50, v50, v170
    s_add_u32 s67, s57, 230400
    buffer_load_dwordx4 v[228:231], v7, s[8:11], s67 offen
    s_barrier
    ds_read_b128 a[48:51], v6 offset:12288
    ds_read_b128 a[112:115], v6 offset:30720
    ds_read_b128 a[176:179], v15 offset:12288
    ds_read_b128 a[240:243], v15 offset:30720
    s_waitcnt vmcnt(15)
    s_waitcnt lgkmcnt(15)
    v_mfma_f32_32x32x16_bf16 v[16:31], v[232:235], a[40:43], v[16:31]
    v_mul_f32 v51, v51, v171
    v_cvt_pk_bf16_f32 v49, v50, v51
    v_cvt_pk_bf16_f32 v60, 0, v60
    v_cvt_pk_bf16_f32 v61, 0, v61
    v_add_f32 v60, v60, v148
    v_mfma_f32_32x32x16_bf16 v[32:47], v[232:235], a[104:107], v[32:47]
    v_add_f32 v61, v61, v149
    v_cvt_pk_bf16_f32 v184, v60, v61
    v_lshlrev_b32 v60, 16, v184
    v_and_b32 v61, 0xffff0000, v184
    v_pk_lshlrev_b16 v185, s50, v184
    v_mfma_f32_32x32x16_bf16 v[64:79], v[232:235], a[168:171], v[64:79]
    v_pk_max_u16 v185, v185, s52
    v_pk_min_u16 v185, v185, s53
    v_pk_lshrrev_b16 v184, s51, v184
    v_pk_mad_u16 v185, v184, s54, v185
    v_and_b32 v186, 0xffff, v185
    s_waitcnt lgkmcnt(14)
    v_mfma_f32_32x32x16_bf16 v[112:127], v[232:235], a[232:235], v[112:127]
    v_lshrrev_b32 v187, 16, v185
    ds_read_u16_d16_hi v180, v186 offset:44288
    ds_read_u16_d16_hi v181, v187 offset:44288
    v_mul_f32 v52, v52, v172
    v_mul_f32 v53, v53, v173
    s_add_u32 s67, s57, 303104
    buffer_load_dwordx4 v[232:235], v7, s[8:11], s67 offen
    ds_read_b128 a[52:55], v6 offset:13312
    ds_read_b128 a[116:119], v6 offset:31744
    ds_read_b128 a[180:183], v15 offset:13312
    ds_read_b128 a[244:247], v15 offset:31744
    s_waitcnt vmcnt(15)
    s_waitcnt lgkmcnt(15)
    v_mfma_f32_32x32x16_bf16 v[16:31], v[236:239], a[44:47], v[16:31]
    v_cvt_pk_bf16_f32 v50, v52, v53
    v_cvt_pk_bf16_f32 v62, 0, v62
    v_cvt_pk_bf16_f32 v63, 0, v63
    v_add_f32 v62, v62, v150
    v_add_f32 v63, v63, v151
    s_waitcnt lgkmcnt(14)
    v_mfma_f32_32x32x16_bf16 v[32:47], v[236:239], a[108:111], v[32:47]
    v_cvt_pk_bf16_f32 v188, v62, v63
    v_lshlrev_b32 v62, 16, v188
    v_and_b32 v63, 0xffff0000, v188
    v_pk_lshlrev_b16 v189, s50, v188
    v_pk_max_u16 v189, v189, s52
    s_waitcnt lgkmcnt(13)
    v_mfma_f32_32x32x16_bf16 v[64:79], v[236:239], a[172:175], v[64:79]
    v_pk_min_u16 v189, v189, s53
    v_pk_lshrrev_b16 v188, s51, v188
    v_pk_mad_u16 v189, v188, s54, v189
    v_and_b32 v190, 0xffff, v189
    v_lshrrev_b32 v191, 16, v189
    s_waitcnt lgkmcnt(12)
    v_mfma_f32_32x32x16_bf16 v[112:127], v[236:239], a[236:239], v[112:127]
    ds_read_u16_d16_hi v182, v190 offset:44288
    ds_read_u16_d16_hi v183, v191 offset:44288
    v_mul_f32 v54, v54, v174
    v_mul_f32 v55, v55, v175
    v_cvt_pk_bf16_f32 v51, v54, v55
    s_add_u32 s67, s57, 304128
    buffer_load_dwordx4 v[236:239], v7, s[8:11], s67 offen
    ds_read_b128 a[56:59], v6 offset:14336
    ds_read_b128 a[120:123], v6 offset:32768
    ds_read_b128 a[184:187], v15 offset:14336
    ds_read_b128 a[248:251], v15 offset:32768
    s_waitcnt vmcnt(15)
    s_waitcnt lgkmcnt(15)
    v_mfma_f32_32x32x16_bf16 v[16:31], v[240:243], a[48:51], v[16:31]
    ds_write_b128 v14, v[48:51] offset:0
    v_mul_f32 v56, v56, v176
    v_mul_f32 v57, v57, v177
    v_cvt_pk_bf16_f32 v56, v56, v57
    v_mul_f32 v58, v58, v178
    s_waitcnt lgkmcnt(15)
    v_mfma_f32_32x32x16_bf16 v[32:47], v[240:243], a[112:115], v[32:47]
    v_mul_f32 v59, v59, v179
    v_cvt_pk_bf16_f32 v57, v58, v59
    s_waitcnt lgkmcnt(11)
    v_mul_f32 v60, v60, v180
    v_mul_f32 v61, v61, v181
    v_cvt_pk_bf16_f32 v58, v60, v61
    v_mfma_f32_32x32x16_bf16 v[64:79], v[240:243], a[176:179], v[64:79]
    s_waitcnt lgkmcnt(5)
    v_mul_f32 v62, v62, v182
    v_mul_f32 v63, v63, v183
    v_cvt_pk_bf16_f32 v59, v62, v63
    ds_write_b128 v14, v[56:59] offset:1024
    v_mfma_f32_32x32x16_bf16 v[112:127], v[240:243], a[240:243], v[112:127]
    s_add_u32 s67, s57, 376832
    buffer_load_dwordx4 v[240:243], v7, s[8:11], s67 offen
    ds_read_b128 a[60:63], v6 offset:15360
    ds_read_b128 a[124:127], v6 offset:33792
    ds_read_b128 a[188:191], v15 offset:15360
    ds_read_b128 a[252:255], v15 offset:33792
    s_waitcnt vmcnt(15)
    v_mfma_f32_32x32x16_bf16 v[16:31], v[244:247], a[52:55], v[16:31]
    v_mfma_f32_32x32x16_bf16 v[32:47], v[244:247], a[116:119], v[32:47]
    v_mfma_f32_32x32x16_bf16 v[64:79], v[244:247], a[180:183], v[64:79]
    v_mfma_f32_32x32x16_bf16 v[112:127], v[244:247], a[244:247], v[112:127]
    s_add_u32 s67, s57, 377856
    buffer_load_dwordx4 v[244:247], v7, s[8:11], s67 offen
    s_waitcnt lgkmcnt(0)
    s_barrier
    ds_read_b128 v[160:163], v6 offset:16384
    ds_read_b128 v[168:171], v6 offset:34816
    ds_read_b128 v[176:179], v15 offset:16384
    ds_read_b128 v[184:187], v15 offset:34816
    s_waitcnt vmcnt(15)
    v_mfma_f32_32x32x16_bf16 v[16:31], v[248:251], a[56:59], v[16:31]
    v_mfma_f32_32x32x16_bf16 v[32:47], v[248:251], a[120:123], v[32:47]
    v_mfma_f32_32x32x16_bf16 v[64:79], v[248:251], a[184:187], v[64:79]
    v_mfma_f32_32x32x16_bf16 v[112:127], v[248:251], a[248:251], v[112:127]
    s_add_u32 s67, s57, 450560
    buffer_load_dwordx4 v[248:251], v7, s[8:11], s67 offen
    ds_read_b128 v[164:167], v6 offset:17408
    ds_read_b128 v[172:175], v6 offset:35840
    ds_read_b128 v[180:183], v15 offset:17408
    ds_read_b128 v[188:191], v15 offset:35840
    s_waitcnt vmcnt(15)
    v_mfma_f32_32x32x16_bf16 v[16:31], v[252:255], a[60:63], v[16:31]
    v_mfma_f32_32x32x16_bf16 v[32:47], v[252:255], a[124:127], v[32:47]
    v_mfma_f32_32x32x16_bf16 v[64:79], v[252:255], a[188:191], v[64:79]
    v_mfma_f32_32x32x16_bf16 v[112:127], v[252:255], a[252:255], v[112:127]
    s_add_u32 s67, s57, 451584
    buffer_load_dwordx4 v[252:255], v7, s[8:11], s67 offen
    s_waitcnt vmcnt(15)
    s_waitcnt lgkmcnt(7)
    v_mfma_f32_32x32x16_bf16 v[16:31], v[192:195], v[160:163], v[16:31]
    s_waitcnt lgkmcnt(6)
    v_mfma_f32_32x32x16_bf16 v[32:47], v[192:195], v[168:171], v[32:47]
    s_waitcnt lgkmcnt(5)
    v_mfma_f32_32x32x16_bf16 v[64:79], v[192:195], v[176:179], v[64:79]
    s_waitcnt lgkmcnt(4)
    v_mfma_f32_32x32x16_bf16 v[112:127], v[192:195], v[184:187], v[112:127]
    s_add_u32 s67, s57, 524288
    buffer_load_dwordx4 v[192:195], v7, s[8:11], s67 offen
    s_waitcnt vmcnt(15)
    s_waitcnt lgkmcnt(3)
    v_mfma_f32_32x32x16_bf16 v[16:31], v[196:199], v[164:167], v[16:31]
    s_waitcnt lgkmcnt(2)
    v_mfma_f32_32x32x16_bf16 v[32:47], v[196:199], v[172:175], v[32:47]
    s_waitcnt lgkmcnt(1)
    v_mfma_f32_32x32x16_bf16 v[64:79], v[196:199], v[180:183], v[64:79]
    s_waitcnt lgkmcnt(0)
    v_mfma_f32_32x32x16_bf16 v[112:127], v[196:199], v[188:191], v[112:127]
    s_add_u32 s67, s57, 525312
    buffer_load_dwordx4 v[196:199], v7, s[8:11], s67 offen
    s_waitcnt vmcnt(15)
    v_mfma_f32_32x32x16_bf16 v[48:63], v[200:203], a[0:3], 0
    v_mfma_f32_32x32x16_bf16 v[80:95], v[200:203], a[64:67], 0
    v_mfma_f32_32x32x16_bf16 v[96:111], v[200:203], a[128:131], 0
    v_mfma_f32_32x32x16_bf16 v[128:143], v[200:203], a[192:195], 0
    s_add_u32 s67, s57, 598016
    buffer_load_dwordx4 v[200:203], v7, s[8:11], s67 offen
    s_waitcnt vmcnt(15)
    v_mfma_f32_32x32x16_bf16 v[48:63], v[204:207], a[4:7], v[48:63]
    v_cvt_pk_f16_f32 v16, v16, v17
    v_cvt_pk_f16_f32 v17, v18, v19
    v_mfma_f32_32x32x16_bf16 v[80:95], v[204:207], a[68:71], v[80:95]
    v_cvt_pk_f16_f32 v18, v20, v21
    v_cvt_pk_f16_f32 v19, v22, v23
    v_mfma_f32_32x32x16_bf16 v[96:111], v[204:207], a[132:135], v[96:111]
    s_mov_b32 s70, 0
    buffer_store_dwordx4 v[16:19], v12, s[28:31], s70 offen sc1
    v_mfma_f32_32x32x16_bf16 v[128:143], v[204:207], a[196:199], v[128:143]
    s_add_u32 s67, s57, 599040
    buffer_load_dwordx4 v[204:207], v7, s[8:11], s67 offen
    s_waitcnt vmcnt(16)
    v_mfma_f32_32x32x16_bf16 v[48:63], v[208:211], a[8:11], v[48:63]
    v_cvt_pk_f16_f32 v20, v24, v25
    v_cvt_pk_f16_f32 v21, v26, v27
    v_mfma_f32_32x32x16_bf16 v[80:95], v[208:211], a[72:75], v[80:95]
    v_cvt_pk_f16_f32 v22, v28, v29
    v_cvt_pk_f16_f32 v23, v30, v31
    v_mfma_f32_32x32x16_bf16 v[96:111], v[208:211], a[136:139], v[96:111]
    s_mov_b32 s70, 16384
    buffer_store_dwordx4 v[20:23], v12, s[28:31], s70 offen sc1
    v_mfma_f32_32x32x16_bf16 v[128:143], v[208:211], a[200:203], v[128:143]
    s_add_u32 s67, s57, 16384
    buffer_load_dwordx4 v[208:211], v7, s[8:11], s67 offen
    s_waitcnt vmcnt(17)
    v_mfma_f32_32x32x16_bf16 v[48:63], v[212:215], a[12:15], v[48:63]
    v_cvt_pk_f16_f32 v32, v32, v33
    v_cvt_pk_f16_f32 v33, v34, v35
    v_mfma_f32_32x32x16_bf16 v[80:95], v[212:215], a[76:79], v[80:95]
    v_cvt_pk_f16_f32 v34, v36, v37
    v_cvt_pk_f16_f32 v35, v38, v39
    v_mfma_f32_32x32x16_bf16 v[96:111], v[212:215], a[140:143], v[96:111]
    s_mov_b32 s70, 32768
    buffer_store_dwordx4 v[32:35], v12, s[28:31], s70 offen sc1
    v_mfma_f32_32x32x16_bf16 v[128:143], v[212:215], a[204:207], v[128:143]
    s_add_u32 s67, s57, 17408
    buffer_load_dwordx4 v[212:215], v7, s[8:11], s67 offen
    s_waitcnt vmcnt(18)
    v_mfma_f32_32x32x16_bf16 v[48:63], v[216:219], a[16:19], v[48:63]
    v_cvt_pk_f16_f32 v36, v40, v41
    v_cvt_pk_f16_f32 v37, v42, v43
    v_mfma_f32_32x32x16_bf16 v[80:95], v[216:219], a[80:83], v[80:95]
    v_cvt_pk_f16_f32 v38, v44, v45
    v_cvt_pk_f16_f32 v39, v46, v47
    v_mfma_f32_32x32x16_bf16 v[96:111], v[216:219], a[144:147], v[96:111]
    s_mov_b32 s70, 49152
    buffer_store_dwordx4 v[36:39], v12, s[28:31], s70 offen sc1
    v_mfma_f32_32x32x16_bf16 v[128:143], v[216:219], a[208:211], v[128:143]
    s_add_u32 s67, s57, 90112
    buffer_load_dwordx4 v[216:219], v7, s[8:11], s67 offen
    s_waitcnt vmcnt(19)
    v_mfma_f32_32x32x16_bf16 v[48:63], v[220:223], a[20:23], v[48:63]
    v_cvt_pk_f16_f32 v64, v64, v65
    v_cvt_pk_f16_f32 v65, v66, v67
    v_mfma_f32_32x32x16_bf16 v[80:95], v[220:223], a[84:87], v[80:95]
    v_cvt_pk_f16_f32 v66, v68, v69
    v_cvt_pk_f16_f32 v67, v70, v71
    v_mfma_f32_32x32x16_bf16 v[96:111], v[220:223], a[148:151], v[96:111]
    s_mov_b32 s70, 65536
    buffer_store_dwordx4 v[64:67], v12, s[28:31], s70 offen sc1
    v_mfma_f32_32x32x16_bf16 v[128:143], v[220:223], a[212:215], v[128:143]
    s_add_u32 s67, s57, 91136
    buffer_load_dwordx4 v[220:223], v7, s[8:11], s67 offen
    s_waitcnt vmcnt(20)
    v_mfma_f32_32x32x16_bf16 v[48:63], v[224:227], a[24:27], v[48:63]
    v_cvt_pk_f16_f32 v68, v72, v73
    v_cvt_pk_f16_f32 v69, v74, v75
    v_mfma_f32_32x32x16_bf16 v[80:95], v[224:227], a[88:91], v[80:95]
    v_cvt_pk_f16_f32 v70, v76, v77
    v_cvt_pk_f16_f32 v71, v78, v79
    v_mfma_f32_32x32x16_bf16 v[96:111], v[224:227], a[152:155], v[96:111]
    s_mov_b32 s70, 81920
    buffer_store_dwordx4 v[68:71], v12, s[28:31], s70 offen sc1
    v_mfma_f32_32x32x16_bf16 v[128:143], v[224:227], a[216:219], v[128:143]
    s_add_u32 s67, s57, 163840
    buffer_load_dwordx4 v[224:227], v7, s[8:11], s67 offen
    s_waitcnt vmcnt(21)
    v_mfma_f32_32x32x16_bf16 v[48:63], v[228:231], a[28:31], v[48:63]
    v_cvt_pk_f16_f32 v112, v112, v113
    v_cvt_pk_f16_f32 v113, v114, v115
    v_mfma_f32_32x32x16_bf16 v[80:95], v[228:231], a[92:95], v[80:95]
    v_cvt_pk_f16_f32 v114, v116, v117
    v_cvt_pk_f16_f32 v115, v118, v119
    v_mfma_f32_32x32x16_bf16 v[96:111], v[228:231], a[156:159], v[96:111]
    s_mov_b32 s70, 98304
    buffer_store_dwordx4 v[112:115], v12, s[28:31], s70 offen sc1
    v_mfma_f32_32x32x16_bf16 v[128:143], v[228:231], a[220:223], v[128:143]
    s_add_u32 s67, s57, 164864
    buffer_load_dwordx4 v[228:231], v7, s[8:11], s67 offen
    s_waitcnt vmcnt(22)
    v_mfma_f32_32x32x16_bf16 v[48:63], v[232:235], a[32:35], v[48:63]
    v_cvt_pk_f16_f32 v116, v120, v121
    v_cvt_pk_f16_f32 v117, v122, v123
    v_mfma_f32_32x32x16_bf16 v[80:95], v[232:235], a[96:99], v[80:95]
    v_cvt_pk_f16_f32 v118, v124, v125
    v_cvt_pk_f16_f32 v119, v126, v127
    v_mfma_f32_32x32x16_bf16 v[96:111], v[232:235], a[160:163], v[96:111]
    s_mov_b32 s70, 114688
    buffer_store_dwordx4 v[116:119], v12, s[28:31], s70 offen sc1
    v_mfma_f32_32x32x16_bf16 v[128:143], v[232:235], a[224:227], v[128:143]
    s_add_u32 s67, s57, 237568
    buffer_load_dwordx4 v[232:235], v7, s[8:11], s67 offen
    s_waitcnt vmcnt(23)
    v_mfma_f32_32x32x16_bf16 v[48:63], v[236:239], a[36:39], v[48:63]
    v_mfma_f32_32x32x16_bf16 v[80:95], v[236:239], a[100:103], v[80:95]
    v_mfma_f32_32x32x16_bf16 v[96:111], v[236:239], a[164:167], v[96:111]
    v_mfma_f32_32x32x16_bf16 v[128:143], v[236:239], a[228:231], v[128:143]
    s_add_u32 s67, s57, 238592
    buffer_load_dwordx4 v[236:239], v7, s[8:11], s67 offen
    s_waitcnt vmcnt(23)
    v_mfma_f32_32x32x16_bf16 v[48:63], v[240:243], a[40:43], v[48:63]
    v_mfma_f32_32x32x16_bf16 v[80:95], v[240:243], a[104:107], v[80:95]
    v_mfma_f32_32x32x16_bf16 v[96:111], v[240:243], a[168:171], v[96:111]
    v_mfma_f32_32x32x16_bf16 v[128:143], v[240:243], a[232:235], v[128:143]
    s_add_u32 s67, s57, 311296
    buffer_load_dwordx4 v[240:243], v7, s[8:11], s67 offen
    s_waitcnt vmcnt(23)
    v_mfma_f32_32x32x16_bf16 v[48:63], v[244:247], a[44:47], v[48:63]
    v_mfma_f32_32x32x16_bf16 v[80:95], v[244:247], a[108:111], v[80:95]
    v_mfma_f32_32x32x16_bf16 v[96:111], v[244:247], a[172:175], v[96:111]
    v_mfma_f32_32x32x16_bf16 v[128:143], v[244:247], a[236:239], v[128:143]
    s_add_u32 s67, s57, 312320
    buffer_load_dwordx4 v[244:247], v7, s[8:11], s67 offen
    s_waitcnt vmcnt(23)
    v_mfma_f32_32x32x16_bf16 v[48:63], v[248:251], a[48:51], v[48:63]
    v_mfma_f32_32x32x16_bf16 v[80:95], v[248:251], a[112:115], v[80:95]
    v_mfma_f32_32x32x16_bf16 v[96:111], v[248:251], a[176:179], v[96:111]
    v_mfma_f32_32x32x16_bf16 v[128:143], v[248:251], a[240:243], v[128:143]
    s_add_u32 s67, s57, 385024
    buffer_load_dwordx4 v[248:251], v7, s[8:11], s67 offen
    s_waitcnt vmcnt(23)
    v_mfma_f32_32x32x16_bf16 v[48:63], v[252:255], a[52:55], v[48:63]
    v_mfma_f32_32x32x16_bf16 v[80:95], v[252:255], a[116:119], v[80:95]
    v_mfma_f32_32x32x16_bf16 v[96:111], v[252:255], a[180:183], v[96:111]
    v_mfma_f32_32x32x16_bf16 v[128:143], v[252:255], a[244:247], v[128:143]
    s_add_u32 s67, s57, 386048
    buffer_load_dwordx4 v[252:255], v7, s[8:11], s67 offen
    s_waitcnt vmcnt(23)
    v_mfma_f32_32x32x16_bf16 v[48:63], v[192:195], a[56:59], v[48:63]
    v_mfma_f32_32x32x16_bf16 v[80:95], v[192:195], a[120:123], v[80:95]
    v_mfma_f32_32x32x16_bf16 v[96:111], v[192:195], a[184:187], v[96:111]
    v_mfma_f32_32x32x16_bf16 v[128:143], v[192:195], a[248:251], v[128:143]
    s_add_u32 s67, s57, 458752
    buffer_load_dwordx4 v[192:195], v7, s[8:11], s67 offen
    s_waitcnt vmcnt(23)
    v_mfma_f32_32x32x16_bf16 v[48:63], v[196:199], a[60:63], v[48:63]
    v_mfma_f32_32x32x16_bf16 v[80:95], v[196:199], a[124:127], v[80:95]
    v_mfma_f32_32x32x16_bf16 v[96:111], v[196:199], a[188:191], v[96:111]
    v_mfma_f32_32x32x16_bf16 v[128:143], v[196:199], a[252:255], v[128:143]
    s_add_u32 s67, s57, 459776
    buffer_load_dwordx4 v[196:199], v7, s[8:11], s67 offen
    s_waitcnt vmcnt(23)
    v_mfma_f32_32x32x16_bf16 v[48:63], v[200:203], v[160:163], v[48:63]
    v_mfma_f32_32x32x16_bf16 v[80:95], v[200:203], v[168:171], v[80:95]
    v_mfma_f32_32x32x16_bf16 v[96:111], v[200:203], v[176:179], v[96:111]
    v_mfma_f32_32x32x16_bf16 v[128:143], v[200:203], v[184:187], v[128:143]
    s_add_u32 s67, s57, 532480
    buffer_load_dwordx4 v[200:203], v7, s[8:11], s67 offen
    s_waitcnt vmcnt(22)
    v_mfma_f32_32x32x16_bf16 v[48:63], v[204:207], v[164:167], v[48:63]
    v_mfma_f32_32x32x16_bf16 v[80:95], v[204:207], v[172:175], v[80:95]
    v_mfma_f32_32x32x16_bf16 v[96:111], v[204:207], v[180:183], v[96:111]
    v_mfma_f32_32x32x16_bf16 v[128:143], v[204:207], v[188:191], v[128:143]
    s_add_u32 s67, s57, 533504
    buffer_load_dwordx4 v[204:207], v7, s[8:11], s67 offen
    s_waitcnt vmcnt(21)
    v_mfma_f32_32x32x16_bf16 v[16:31], v[208:211], a[0:3], 0
    v_mfma_f32_32x32x16_bf16 v[32:47], v[208:211], a[64:67], 0
    v_mfma_f32_32x32x16_bf16 v[64:79], v[208:211], a[128:131], 0
    v_mfma_f32_32x32x16_bf16 v[112:127], v[208:211], a[192:195], 0
    s_add_u32 s67, s57, 606208
    buffer_load_dwordx4 v[208:211], v7, s[8:11], s67 offen
    s_waitcnt vmcnt(20)
    v_mfma_f32_32x32x16_bf16 v[16:31], v[212:215], a[4:7], v[16:31]
    v_cvt_pk_f16_f32 v48, v48, v49
    v_cvt_pk_f16_f32 v49, v50, v51
    v_mfma_f32_32x32x16_bf16 v[32:47], v[212:215], a[68:71], v[32:47]
    v_cvt_pk_f16_f32 v50, v52, v53
    v_cvt_pk_f16_f32 v51, v54, v55
    v_mfma_f32_32x32x16_bf16 v[64:79], v[212:215], a[132:135], v[64:79]
    s_mov_b32 s70, 524288
    buffer_store_dwordx4 v[48:51], v12, s[28:31], s70 offen sc1
    v_mfma_f32_32x32x16_bf16 v[112:127], v[212:215], a[196:199], v[112:127]
    s_add_u32 s67, s57, 607232
    buffer_load_dwordx4 v[212:215], v7, s[8:11], s67 offen
    s_waitcnt vmcnt(20)
    v_mfma_f32_32x32x16_bf16 v[16:31], v[216:219], a[8:11], v[16:31]
    v_cvt_pk_f16_f32 v52, v56, v57
    v_cvt_pk_f16_f32 v53, v58, v59
    v_mfma_f32_32x32x16_bf16 v[32:47], v[216:219], a[72:75], v[32:47]
    v_cvt_pk_f16_f32 v54, v60, v61
    v_cvt_pk_f16_f32 v55, v62, v63
    v_mfma_f32_32x32x16_bf16 v[64:79], v[216:219], a[136:139], v[64:79]
    s_mov_b32 s70, 540672
    buffer_store_dwordx4 v[52:55], v12, s[28:31], s70 offen sc1
    v_mfma_f32_32x32x16_bf16 v[112:127], v[216:219], a[200:203], v[112:127]
    s_add_u32 s67, s57, 24576
    buffer_load_dwordx4 v[216:219], v7, s[8:11], s67 offen
    s_waitcnt vmcnt(20)
    v_mfma_f32_32x32x16_bf16 v[16:31], v[220:223], a[12:15], v[16:31]
    v_cvt_pk_f16_f32 v80, v80, v81
    v_cvt_pk_f16_f32 v81, v82, v83
    v_mfma_f32_32x32x16_bf16 v[32:47], v[220:223], a[76:79], v[32:47]
    v_cvt_pk_f16_f32 v82, v84, v85
    v_cvt_pk_f16_f32 v83, v86, v87
    v_mfma_f32_32x32x16_bf16 v[64:79], v[220:223], a[140:143], v[64:79]
    s_mov_b32 s70, 557056
    buffer_store_dwordx4 v[80:83], v12, s[28:31], s70 offen sc1
    v_mfma_f32_32x32x16_bf16 v[112:127], v[220:223], a[204:207], v[112:127]
    s_add_u32 s67, s57, 25600
    buffer_load_dwordx4 v[220:223], v7, s[8:11], s67 offen
    s_waitcnt vmcnt(20)
    v_mfma_f32_32x32x16_bf16 v[16:31], v[224:227], a[16:19], v[16:31]
    v_cvt_pk_f16_f32 v84, v88, v89
    v_cvt_pk_f16_f32 v85, v90, v91
    v_mfma_f32_32x32x16_bf16 v[32:47], v[224:227], a[80:83], v[32:47]
    v_cvt_pk_f16_f32 v86, v92, v93
    v_cvt_pk_f16_f32 v87, v94, v95
    v_mfma_f32_32x32x16_bf16 v[64:79], v[224:227], a[144:147], v[64:79]
    s_mov_b32 s70, 573440
    buffer_store_dwordx4 v[84:87], v12, s[28:31], s70 offen sc1
    v_mfma_f32_32x32x16_bf16 v[112:127], v[224:227], a[208:211], v[112:127]
    s_add_u32 s67, s57, 98304
    buffer_load_dwordx4 v[224:227], v7, s[8:11], s67 offen
    s_waitcnt vmcnt(20)
    v_mfma_f32_32x32x16_bf16 v[16:31], v[228:231], a[20:23], v[16:31]
    v_cvt_pk_f16_f32 v96, v96, v97
    v_cvt_pk_f16_f32 v97, v98, v99
    v_mfma_f32_32x32x16_bf16 v[32:47], v[228:231], a[84:87], v[32:47]
    v_cvt_pk_f16_f32 v98, v100, v101
    v_cvt_pk_f16_f32 v99, v102, v103
    v_mfma_f32_32x32x16_bf16 v[64:79], v[228:231], a[148:151], v[64:79]
    s_mov_b32 s70, 589824
    buffer_store_dwordx4 v[96:99], v12, s[28:31], s70 offen sc1
    v_mfma_f32_32x32x16_bf16 v[112:127], v[228:231], a[212:215], v[112:127]
    s_add_u32 s67, s57, 99328
    buffer_load_dwordx4 v[228:231], v7, s[8:11], s67 offen
    s_waitcnt vmcnt(20)
    v_mfma_f32_32x32x16_bf16 v[16:31], v[232:235], a[24:27], v[16:31]
    v_cvt_pk_f16_f32 v100, v104, v105
    v_cvt_pk_f16_f32 v101, v106, v107
    v_mfma_f32_32x32x16_bf16 v[32:47], v[232:235], a[88:91], v[32:47]
    v_cvt_pk_f16_f32 v102, v108, v109
    v_cvt_pk_f16_f32 v103, v110, v111
    v_mfma_f32_32x32x16_bf16 v[64:79], v[232:235], a[152:155], v[64:79]
    s_mov_b32 s70, 606208
    buffer_store_dwordx4 v[100:103], v12, s[28:31], s70 offen sc1
    v_mfma_f32_32x32x16_bf16 v[112:127], v[232:235], a[216:219], v[112:127]
    s_add_u32 s67, s57, 172032
    buffer_load_dwordx4 v[232:235], v7, s[8:11], s67 offen
    s_waitcnt vmcnt(21)
    v_mfma_f32_32x32x16_bf16 v[16:31], v[236:239], a[28:31], v[16:31]
    v_cvt_pk_f16_f32 v128, v128, v129
    v_cvt_pk_f16_f32 v129, v130, v131
    v_mfma_f32_32x32x16_bf16 v[32:47], v[236:239], a[92:95], v[32:47]
    v_cvt_pk_f16_f32 v130, v132, v133
    v_cvt_pk_f16_f32 v131, v134, v135
    v_mfma_f32_32x32x16_bf16 v[64:79], v[236:239], a[156:159], v[64:79]
    s_mov_b32 s70, 622592
    buffer_store_dwordx4 v[128:131], v12, s[28:31], s70 offen sc1
    v_mfma_f32_32x32x16_bf16 v[112:127], v[236:239], a[220:223], v[112:127]
    s_add_u32 s67, s57, 173056
    buffer_load_dwordx4 v[236:239], v7, s[8:11], s67 offen
    s_waitcnt vmcnt(22)
    v_mfma_f32_32x32x16_bf16 v[16:31], v[240:243], a[32:35], v[16:31]
    v_cvt_pk_f16_f32 v132, v136, v137
    v_cvt_pk_f16_f32 v133, v138, v139
    v_mfma_f32_32x32x16_bf16 v[32:47], v[240:243], a[96:99], v[32:47]
    v_cvt_pk_f16_f32 v134, v140, v141
    v_cvt_pk_f16_f32 v135, v142, v143
    v_mfma_f32_32x32x16_bf16 v[64:79], v[240:243], a[160:163], v[64:79]
    s_mov_b32 s70, 638976
    buffer_store_dwordx4 v[132:135], v12, s[28:31], s70 offen sc1
    v_mfma_f32_32x32x16_bf16 v[112:127], v[240:243], a[224:227], v[112:127]
    s_add_u32 s67, s57, 245760
    buffer_load_dwordx4 v[240:243], v7, s[8:11], s67 offen
    s_waitcnt vmcnt(23)
    v_mfma_f32_32x32x16_bf16 v[16:31], v[244:247], a[36:39], v[16:31]
    v_mfma_f32_32x32x16_bf16 v[32:47], v[244:247], a[100:103], v[32:47]
    v_mfma_f32_32x32x16_bf16 v[64:79], v[244:247], a[164:167], v[64:79]
    v_mfma_f32_32x32x16_bf16 v[112:127], v[244:247], a[228:231], v[112:127]
    s_add_u32 s67, s57, 246784
    buffer_load_dwordx4 v[244:247], v7, s[8:11], s67 offen
    s_waitcnt vmcnt(23)
    v_mfma_f32_32x32x16_bf16 v[16:31], v[248:251], a[40:43], v[16:31]
    v_mfma_f32_32x32x16_bf16 v[32:47], v[248:251], a[104:107], v[32:47]
    v_mfma_f32_32x32x16_bf16 v[64:79], v[248:251], a[168:171], v[64:79]
    v_mfma_f32_32x32x16_bf16 v[112:127], v[248:251], a[232:235], v[112:127]
    s_add_u32 s67, s57, 319488
    buffer_load_dwordx4 v[248:251], v7, s[8:11], s67 offen
    s_waitcnt vmcnt(23)
    v_mfma_f32_32x32x16_bf16 v[16:31], v[252:255], a[44:47], v[16:31]
    v_mfma_f32_32x32x16_bf16 v[32:47], v[252:255], a[108:111], v[32:47]
    v_mfma_f32_32x32x16_bf16 v[64:79], v[252:255], a[172:175], v[64:79]
    v_mfma_f32_32x32x16_bf16 v[112:127], v[252:255], a[236:239], v[112:127]
    s_add_u32 s67, s57, 320512
    buffer_load_dwordx4 v[252:255], v7, s[8:11], s67 offen
    s_waitcnt vmcnt(23)
    v_mfma_f32_32x32x16_bf16 v[16:31], v[192:195], a[48:51], v[16:31]
    v_mfma_f32_32x32x16_bf16 v[32:47], v[192:195], a[112:115], v[32:47]
    v_mfma_f32_32x32x16_bf16 v[64:79], v[192:195], a[176:179], v[64:79]
    v_mfma_f32_32x32x16_bf16 v[112:127], v[192:195], a[240:243], v[112:127]
    s_add_u32 s67, s57, 393216
    buffer_load_dwordx4 v[192:195], v7, s[8:11], s67 offen
    s_waitcnt vmcnt(23)
    v_mfma_f32_32x32x16_bf16 v[16:31], v[196:199], a[52:55], v[16:31]
    v_mfma_f32_32x32x16_bf16 v[32:47], v[196:199], a[116:119], v[32:47]
    v_mfma_f32_32x32x16_bf16 v[64:79], v[196:199], a[180:183], v[64:79]
    v_mfma_f32_32x32x16_bf16 v[112:127], v[196:199], a[244:247], v[112:127]
    s_add_u32 s67, s57, 394240
    buffer_load_dwordx4 v[196:199], v7, s[8:11], s67 offen
    s_waitcnt vmcnt(23)
    v_mfma_f32_32x32x16_bf16 v[16:31], v[200:203], a[56:59], v[16:31]
    v_mfma_f32_32x32x16_bf16 v[32:47], v[200:203], a[120:123], v[32:47]
    v_mfma_f32_32x32x16_bf16 v[64:79], v[200:203], a[184:187], v[64:79]
    v_mfma_f32_32x32x16_bf16 v[112:127], v[200:203], a[248:251], v[112:127]
    s_add_u32 s67, s57, 466944
    buffer_load_dwordx4 v[200:203], v7, s[8:11], s67 offen
    s_waitcnt vmcnt(23)
    v_mfma_f32_32x32x16_bf16 v[16:31], v[204:207], a[60:63], v[16:31]
    v_mfma_f32_32x32x16_bf16 v[32:47], v[204:207], a[124:127], v[32:47]
    v_mfma_f32_32x32x16_bf16 v[64:79], v[204:207], a[188:191], v[64:79]
    v_mfma_f32_32x32x16_bf16 v[112:127], v[204:207], a[252:255], v[112:127]
    s_add_u32 s67, s57, 467968
    buffer_load_dwordx4 v[204:207], v7, s[8:11], s67 offen
    s_waitcnt vmcnt(23)
    v_mfma_f32_32x32x16_bf16 v[16:31], v[208:211], v[160:163], v[16:31]
    v_mfma_f32_32x32x16_bf16 v[32:47], v[208:211], v[168:171], v[32:47]
    v_mfma_f32_32x32x16_bf16 v[64:79], v[208:211], v[176:179], v[64:79]
    v_mfma_f32_32x32x16_bf16 v[112:127], v[208:211], v[184:187], v[112:127]
    s_add_u32 s67, s57, 540672
    buffer_load_dwordx4 v[208:211], v7, s[8:11], s67 offen
    s_waitcnt vmcnt(22)
    v_mfma_f32_32x32x16_bf16 v[16:31], v[212:215], v[164:167], v[16:31]
    v_mfma_f32_32x32x16_bf16 v[32:47], v[212:215], v[172:175], v[32:47]
    v_mfma_f32_32x32x16_bf16 v[64:79], v[212:215], v[180:183], v[64:79]
    v_mfma_f32_32x32x16_bf16 v[112:127], v[212:215], v[188:191], v[112:127]
    s_add_u32 s67, s57, 541696
    buffer_load_dwordx4 v[212:215], v7, s[8:11], s67 offen
    s_waitcnt vmcnt(21)
    v_mfma_f32_32x32x16_bf16 v[48:63], v[216:219], a[0:3], 0
    v_mfma_f32_32x32x16_bf16 v[80:95], v[216:219], a[64:67], 0
    v_mfma_f32_32x32x16_bf16 v[96:111], v[216:219], a[128:131], 0
    v_mfma_f32_32x32x16_bf16 v[128:143], v[216:219], a[192:195], 0
    s_add_u32 s67, s57, 614400
    buffer_load_dwordx4 v[216:219], v7, s[8:11], s67 offen
    s_waitcnt vmcnt(20)
    v_mfma_f32_32x32x16_bf16 v[48:63], v[220:223], a[4:7], v[48:63]
    v_cvt_pk_f16_f32 v16, v16, v17
    v_cvt_pk_f16_f32 v17, v18, v19
    v_mfma_f32_32x32x16_bf16 v[80:95], v[220:223], a[68:71], v[80:95]
    v_cvt_pk_f16_f32 v18, v20, v21
    v_cvt_pk_f16_f32 v19, v22, v23
    v_mfma_f32_32x32x16_bf16 v[96:111], v[220:223], a[132:135], v[96:111]
    s_mov_b32 s70, 1048576
    buffer_store_dwordx4 v[16:19], v12, s[28:31], s70 offen sc1
    v_mfma_f32_32x32x16_bf16 v[128:143], v[220:223], a[196:199], v[128:143]
    s_add_u32 s67, s57, 615424
    buffer_load_dwordx4 v[220:223], v7, s[8:11], s67 offen
    s_waitcnt vmcnt(20)
    v_mfma_f32_32x32x16_bf16 v[48:63], v[224:227], a[8:11], v[48:63]
    v_cvt_pk_f16_f32 v20, v24, v25
    v_cvt_pk_f16_f32 v21, v26, v27
    v_mfma_f32_32x32x16_bf16 v[80:95], v[224:227], a[72:75], v[80:95]
    v_cvt_pk_f16_f32 v22, v28, v29
    v_cvt_pk_f16_f32 v23, v30, v31
    v_mfma_f32_32x32x16_bf16 v[96:111], v[224:227], a[136:139], v[96:111]
    s_mov_b32 s70, 1064960
    buffer_store_dwordx4 v[20:23], v12, s[28:31], s70 offen sc1
    v_mfma_f32_32x32x16_bf16 v[128:143], v[224:227], a[200:203], v[128:143]
    s_add_u32 s67, s58, 0
    buffer_load_dwordx4 v[224:227], v7, s[8:11], s67 offen
    s_waitcnt vmcnt(20)
    v_mfma_f32_32x32x16_bf16 v[48:63], v[228:231], a[12:15], v[48:63]
    v_cvt_pk_f16_f32 v32, v32, v33
    v_cvt_pk_f16_f32 v33, v34, v35
    v_mfma_f32_32x32x16_bf16 v[80:95], v[228:231], a[76:79], v[80:95]
    v_cvt_pk_f16_f32 v34, v36, v37
    v_cvt_pk_f16_f32 v35, v38, v39
    v_mfma_f32_32x32x16_bf16 v[96:111], v[228:231], a[140:143], v[96:111]
    s_mov_b32 s70, 1081344
    buffer_store_dwordx4 v[32:35], v12, s[28:31], s70 offen sc1
    v_mfma_f32_32x32x16_bf16 v[128:143], v[228:231], a[204:207], v[128:143]
    s_add_u32 s67, s58, 1024
    buffer_load_dwordx4 v[228:231], v7, s[8:11], s67 offen
    s_waitcnt vmcnt(20)
    v_mfma_f32_32x32x16_bf16 v[48:63], v[232:235], a[16:19], v[48:63]
    v_cvt_pk_f16_f32 v36, v40, v41
    v_cvt_pk_f16_f32 v37, v42, v43
    v_mfma_f32_32x32x16_bf16 v[80:95], v[232:235], a[80:83], v[80:95]
    v_cvt_pk_f16_f32 v38, v44, v45
    v_cvt_pk_f16_f32 v39, v46, v47
    v_mfma_f32_32x32x16_bf16 v[96:111], v[232:235], a[144:147], v[96:111]
    s_mov_b32 s70, 1097728
    buffer_store_dwordx4 v[36:39], v12, s[28:31], s70 offen sc1
    v_mfma_f32_32x32x16_bf16 v[128:143], v[232:235], a[208:211], v[128:143]
    s_add_u32 s67, s58, 73728
    buffer_load_dwordx4 v[232:235], v7, s[8:11], s67 offen
    s_waitcnt vmcnt(20)
    v_mfma_f32_32x32x16_bf16 v[48:63], v[236:239], a[20:23], v[48:63]
    v_cvt_pk_f16_f32 v64, v64, v65
    v_cvt_pk_f16_f32 v65, v66, v67
    v_mfma_f32_32x32x16_bf16 v[80:95], v[236:239], a[84:87], v[80:95]
    v_cvt_pk_f16_f32 v66, v68, v69
    v_cvt_pk_f16_f32 v67, v70, v71
    v_mfma_f32_32x32x16_bf16 v[96:111], v[236:239], a[148:151], v[96:111]
    s_mov_b32 s70, 1114112
    buffer_store_dwordx4 v[64:67], v12, s[28:31], s70 offen sc1
    v_mfma_f32_32x32x16_bf16 v[128:143], v[236:239], a[212:215], v[128:143]
    s_add_u32 s67, s58, 74752
    buffer_load_dwordx4 v[236:239], v7, s[8:11], s67 offen
    s_waitcnt vmcnt(20)
    v_mfma_f32_32x32x16_bf16 v[48:63], v[240:243], a[24:27], v[48:63]
    v_cvt_pk_f16_f32 v68, v72, v73
    v_cvt_pk_f16_f32 v69, v74, v75
    v_mfma_f32_32x32x16_bf16 v[80:95], v[240:243], a[88:91], v[80:95]
    v_cvt_pk_f16_f32 v70, v76, v77
    v_cvt_pk_f16_f32 v71, v78, v79
    v_mfma_f32_32x32x16_bf16 v[96:111], v[240:243], a[152:155], v[96:111]
    s_mov_b32 s70, 1130496
    buffer_store_dwordx4 v[68:71], v12, s[28:31], s70 offen sc1
    v_mfma_f32_32x32x16_bf16 v[128:143], v[240:243], a[216:219], v[128:143]
    s_add_u32 s67, s58, 147456
    buffer_load_dwordx4 v[240:243], v7, s[8:11], s67 offen
    s_waitcnt vmcnt(21)
    v_mfma_f32_32x32x16_bf16 v[48:63], v[244:247], a[28:31], v[48:63]
    v_cvt_pk_f16_f32 v112, v112, v113
    v_cvt_pk_f16_f32 v113, v114, v115
    v_mfma_f32_32x32x16_bf16 v[80:95], v[244:247], a[92:95], v[80:95]
    v_cvt_pk_f16_f32 v114, v116, v117
    v_cvt_pk_f16_f32 v115, v118, v119
    v_mfma_f32_32x32x16_bf16 v[96:111], v[244:247], a[156:159], v[96:111]
    s_mov_b32 s70, 1146880
    buffer_store_dwordx4 v[112:115], v12, s[28:31], s70 offen sc1
    v_mfma_f32_32x32x16_bf16 v[128:143], v[244:247], a[220:223], v[128:143]
    s_add_u32 s67, s58, 148480
    buffer_load_dwordx4 v[244:247], v7, s[8:11], s67 offen
    s_waitcnt vmcnt(22)
    v_mfma_f32_32x32x16_bf16 v[48:63], v[248:251], a[32:35], v[48:63]
    v_cvt_pk_f16_f32 v116, v120, v121
    v_cvt_pk_f16_f32 v117, v122, v123
    v_mfma_f32_32x32x16_bf16 v[80:95], v[248:251], a[96:99], v[80:95]
    v_cvt_pk_f16_f32 v118, v124, v125
    v_cvt_pk_f16_f32 v119, v126, v127
    v_mfma_f32_32x32x16_bf16 v[96:111], v[248:251], a[160:163], v[96:111]
    s_mov_b32 s70, 1163264
    buffer_store_dwordx4 v[116:119], v12, s[28:31], s70 offen sc1
    v_mfma_f32_32x32x16_bf16 v[128:143], v[248:251], a[224:227], v[128:143]
    s_add_u32 s67, s58, 221184
    buffer_load_dwordx4 v[248:251], v7, s[8:11], s67 offen
    s_waitcnt vmcnt(23)
    v_mfma_f32_32x32x16_bf16 v[48:63], v[252:255], a[36:39], v[48:63]
    v_mfma_f32_32x32x16_bf16 v[80:95], v[252:255], a[100:103], v[80:95]
    v_mfma_f32_32x32x16_bf16 v[96:111], v[252:255], a[164:167], v[96:111]
    v_mfma_f32_32x32x16_bf16 v[128:143], v[252:255], a[228:231], v[128:143]
    s_add_u32 s67, s58, 222208
    buffer_load_dwordx4 v[252:255], v7, s[8:11], s67 offen
    s_waitcnt vmcnt(23)
    v_mfma_f32_32x32x16_bf16 v[48:63], v[192:195], a[40:43], v[48:63]
    v_mfma_f32_32x32x16_bf16 v[80:95], v[192:195], a[104:107], v[80:95]
    v_mfma_f32_32x32x16_bf16 v[96:111], v[192:195], a[168:171], v[96:111]
    v_mfma_f32_32x32x16_bf16 v[128:143], v[192:195], a[232:235], v[128:143]
    s_add_u32 s67, s58, 294912
    buffer_load_dwordx4 v[192:195], v7, s[8:11], s67 offen
    s_waitcnt vmcnt(23)
    v_mfma_f32_32x32x16_bf16 v[48:63], v[196:199], a[44:47], v[48:63]
    v_mfma_f32_32x32x16_bf16 v[80:95], v[196:199], a[108:111], v[80:95]
    v_mfma_f32_32x32x16_bf16 v[96:111], v[196:199], a[172:175], v[96:111]
    v_mfma_f32_32x32x16_bf16 v[128:143], v[196:199], a[236:239], v[128:143]
    s_add_u32 s67, s58, 295936
    buffer_load_dwordx4 v[196:199], v7, s[8:11], s67 offen
    s_waitcnt vmcnt(23)
    v_mfma_f32_32x32x16_bf16 v[48:63], v[200:203], a[48:51], v[48:63]
    v_mfma_f32_32x32x16_bf16 v[80:95], v[200:203], a[112:115], v[80:95]
    v_mfma_f32_32x32x16_bf16 v[96:111], v[200:203], a[176:179], v[96:111]
    v_mfma_f32_32x32x16_bf16 v[128:143], v[200:203], a[240:243], v[128:143]
    s_add_u32 s67, s58, 368640
    buffer_load_dwordx4 v[200:203], v7, s[8:11], s67 offen
    s_waitcnt vmcnt(23)
    v_mfma_f32_32x32x16_bf16 v[48:63], v[204:207], a[52:55], v[48:63]
    v_mfma_f32_32x32x16_bf16 v[80:95], v[204:207], a[116:119], v[80:95]
    v_mfma_f32_32x32x16_bf16 v[96:111], v[204:207], a[180:183], v[96:111]
    v_mfma_f32_32x32x16_bf16 v[128:143], v[204:207], a[244:247], v[128:143]
    s_add_u32 s67, s58, 369664
    buffer_load_dwordx4 v[204:207], v7, s[8:11], s67 offen
    s_waitcnt vmcnt(23)
    v_mfma_f32_32x32x16_bf16 v[48:63], v[208:211], a[56:59], v[48:63]
    v_mfma_f32_32x32x16_bf16 v[80:95], v[208:211], a[120:123], v[80:95]
    v_mfma_f32_32x32x16_bf16 v[96:111], v[208:211], a[184:187], v[96:111]
    v_mfma_f32_32x32x16_bf16 v[128:143], v[208:211], a[248:251], v[128:143]
    s_add_u32 s67, s58, 442368
    buffer_load_dwordx4 v[208:211], v7, s[8:11], s67 offen
    s_waitcnt vmcnt(23)
    v_mfma_f32_32x32x16_bf16 v[48:63], v[212:215], a[60:63], v[48:63]
    v_mfma_f32_32x32x16_bf16 v[80:95], v[212:215], a[124:127], v[80:95]
    v_mfma_f32_32x32x16_bf16 v[96:111], v[212:215], a[188:191], v[96:111]
    v_mfma_f32_32x32x16_bf16 v[128:143], v[212:215], a[252:255], v[128:143]
    s_add_u32 s67, s58, 443392
    buffer_load_dwordx4 v[212:215], v7, s[8:11], s67 offen
    s_waitcnt vmcnt(23)
    v_mfma_f32_32x32x16_bf16 v[48:63], v[216:219], v[160:163], v[48:63]
    v_mfma_f32_32x32x16_bf16 v[80:95], v[216:219], v[168:171], v[80:95]
    v_mfma_f32_32x32x16_bf16 v[96:111], v[216:219], v[176:179], v[96:111]
    v_mfma_f32_32x32x16_bf16 v[128:143], v[216:219], v[184:187], v[128:143]
    s_add_u32 s67, s58, 516096
    buffer_load_dwordx4 v[216:219], v7, s[8:11], s67 offen
    s_waitcnt vmcnt(22)
    v_mfma_f32_32x32x16_bf16 v[48:63], v[220:223], v[164:167], v[48:63]
    v_mfma_f32_32x32x16_bf16 v[80:95], v[220:223], v[172:175], v[80:95]
    v_mfma_f32_32x32x16_bf16 v[96:111], v[220:223], v[180:183], v[96:111]
    v_mfma_f32_32x32x16_bf16 v[128:143], v[220:223], v[188:191], v[128:143]
    s_add_u32 s67, s58, 517120
    buffer_load_dwordx4 v[220:223], v7, s[8:11], s67 offen
    s_and_b32 s66, s24, 1
    s_cmp_eq_u32 s66, 1
    s_cbranch_scc1 KF_H1
    s_waitcnt vmcnt(21)
    v_mfma_f32_32x32x16_bf16 v[16:31], v[224:227], a[0:3], 0
    v_mfma_f32_32x32x16_bf16 v[32:47], v[224:227], a[64:67], 0
    s_add_u32 s67, s58, 589824
    buffer_load_dwordx4 v[224:227], v7, s[8:11], s67 offen
    s_waitcnt vmcnt(20)
    v_mfma_f32_32x32x16_bf16 v[16:31], v[228:231], a[4:7], v[16:31]
    v_cvt_pk_f16_f32 v48, v48, v49
    v_cvt_pk_f16_f32 v49, v50, v51
    v_cvt_pk_f16_f32 v50, v52, v53
    v_mfma_f32_32x32x16_bf16 v[32:47], v[228:231], a[68:71], v[32:47]
    s_add_u32 s67, s58, 590848
    buffer_load_dwordx4 v[228:231], v7, s[8:11], s67 offen
    s_waitcnt vmcnt(19)
    v_mfma_f32_32x32x16_bf16 v[16:31], v[232:235], a[8:11], v[16:31]
    v_cvt_pk_f16_f32 v51, v54, v55
    s_mov_b32 s70, 1572864
    buffer_store_dwordx4 v[48:51], v12, s[28:31], s70 offen sc1
    v_mfma_f32_32x32x16_bf16 v[32:47], v[232:235], a[72:75], v[32:47]
    s_waitcnt vmcnt(18)
    v_mfma_f32_32x32x16_bf16 v[16:31], v[236:239], a[12:15], v[16:31]
    v_cvt_pk_f16_f32 v52, v56, v57
    v_cvt_pk_f16_f32 v53, v58, v59
    v_cvt_pk_f16_f32 v54, v60, v61
    v_mfma_f32_32x32x16_bf16 v[32:47], v[236:239], a[76:79], v[32:47]
    s_waitcnt vmcnt(16)
    v_mfma_f32_32x32x16_bf16 v[16:31], v[240:243], a[16:19], v[16:31]
    v_cvt_pk_f16_f32 v55, v62, v63
    s_mov_b32 s70, 1589248
    buffer_store_dwordx4 v[52:55], v12, s[28:31], s70 offen sc1
    v_mfma_f32_32x32x16_bf16 v[32:47], v[240:243], a[80:83], v[32:47]
    s_waitcnt vmcnt(15)
    v_mfma_f32_32x32x16_bf16 v[16:31], v[244:247], a[20:23], v[16:31]
    v_cvt_pk_f16_f32 v80, v80, v81
    v_cvt_pk_f16_f32 v81, v82, v83
    v_cvt_pk_f16_f32 v82, v84, v85
    v_mfma_f32_32x32x16_bf16 v[32:47], v[244:247], a[84:87], v[32:47]
    s_waitcnt vmcnt(13)
    v_mfma_f32_32x32x16_bf16 v[16:31], v[248:251], a[24:27], v[16:31]
    v_cvt_pk_f16_f32 v83, v86, v87
    s_mov_b32 s70, 1605632
    buffer_store_dwordx4 v[80:83], v12, s[28:31], s70 offen sc1
    v_mfma_f32_32x32x16_bf16 v[32:47], v[248:251], a[88:91], v[32:47]
    s_waitcnt vmcnt(13)
    v_mfma_f32_32x32x16_bf16 v[16:31], v[252:255], a[28:31], v[16:31]
    v_cvt_pk_f16_f32 v84, v88, v89
    v_cvt_pk_f16_f32 v85, v90, v91
    v_cvt_pk_f16_f32 v86, v92, v93
    v_mfma_f32_32x32x16_bf16 v[32:47], v[252:255], a[92:95], v[32:47]
    s_waitcnt vmcnt(12)
    v_mfma_f32_32x32x16_bf16 v[16:31], v[192:195], a[32:35], v[16:31]
    v_cvt_pk_f16_f32 v87, v94, v95
    s_mov_b32 s70, 1622016
    buffer_store_dwordx4 v[84:87], v12, s[28:31], s70 offen sc1
    v_mfma_f32_32x32x16_bf16 v[32:47], v[192:195], a[96:99], v[32:47]
    s_waitcnt vmcnt(12)
    v_mfma_f32_32x32x16_bf16 v[16:31], v[196:199], a[36:39], v[16:31]
    v_cvt_pk_f16_f32 v96, v96, v97
    v_cvt_pk_f16_f32 v97, v98, v99
    v_cvt_pk_f16_f32 v98, v100, v101
    v_mfma_f32_32x32x16_bf16 v[32:47], v[196:199], a[100:103], v[32:47]
    s_waitcnt vmcnt(11)
    v_mfma_f32_32x32x16_bf16 v[16:31], v[200:203], a[40:43], v[16:31]
    v_cvt_pk_f16_f32 v99, v102, v103
    s_mov_b32 s70, 1638400
    buffer_store_dwordx4 v[96:99], v12, s[28:31], s70 offen sc1
    v_mfma_f32_32x32x16_bf16 v[32:47], v[200:203], a[104:107], v[32:47]
    s_waitcnt vmcnt(11)
    v_mfma_f32_32x32x16_bf16 v[16:31], v[204:207], a[44:47], v[16:31]
    v_cvt_pk_f16_f32 v100, v104, v105
    v_cvt_pk_f16_f32 v101, v106, v107
    v_cvt_pk_f16_f32 v102, v108, v109
    v_mfma_f32_32x32x16_bf16 v[32:47], v[204:207], a[108:111], v[32:47]
    s_waitcnt vmcnt(10)
    v_mfma_f32_32x32x16_bf16 v[16:31], v[208:211], a[48:51], v[16:31]
    v_cvt_pk_f16_f32 v103, v110, v111
    s_mov_b32 s70, 1654784
    buffer_store_dwordx4 v[100:103], v12, s[28:31], s70 offen sc1
    v_mfma_f32_32x32x16_bf16 v[32:47], v[208:211], a[112:115], v[32:47]
    s_waitcnt vmcnt(10)
    v_mfma_f32_32x32x16_bf16 v[16:31], v[212:215], a[52:55], v[16:31]
    v_cvt_pk_f16_f32 v128, v128, v129
    v_cvt_pk_f16_f32 v129, v130, v131
    v_cvt_pk_f16_f32 v130, v132, v133
    v_mfma_f32_32x32x16_bf16 v[32:47], v[212:215], a[116:119], v[32:47]
    s_waitcnt vmcnt(9)
    v_mfma_f32_32x32x16_bf16 v[16:31], v[216:219], a[56:59], v[16:31]
    v_cvt_pk_f16_f32 v131, v134, v135
    s_mov_b32 s70, 1671168
    buffer_store_dwordx4 v[128:131], v12, s[28:31], s70 offen sc1
    v_mfma_f32_32x32x16_bf16 v[32:47], v[216:219], a[120:123], v[32:47]
    s_waitcnt vmcnt(9)
    v_mfma_f32_32x32x16_bf16 v[16:31], v[220:223], a[60:63], v[16:31]
    v_cvt_pk_f16_f32 v132, v136, v137
    v_cvt_pk_f16_f32 v133, v138, v139
    v_cvt_pk_f16_f32 v134, v140, v141
    v_mfma_f32_32x32x16_bf16 v[32:47], v[220:223], a[124:127], v[32:47]
    s_waitcnt vmcnt(8)
    v_mfma_f32_32x32x16_bf16 v[16:31], v[224:227], v[160:163], v[16:31]
    v_cvt_pk_f16_f32 v135, v142, v143
    s_mov_b32 s70, 1687552
    buffer_store_dwordx4 v[132:135], v12, s[28:31], s70 offen sc1
    v_mfma_f32_32x32x16_bf16 v[32:47], v[224:227], v[168:171], v[32:47]
    s_waitcnt vmcnt(8)
    v_mfma_f32_32x32x16_bf16 v[16:31], v[228:231], v[164:167], v[16:31]
    v_mfma_f32_32x32x16_bf16 v[32:47], v[228:231], v[172:175], v[32:47]
    s_branch KF_H2
KF_H1:
    s_waitcnt vmcnt(21)
    v_mfma_f32_32x32x16_bf16 v[16:31], v[224:227], a[128:131], 0
    v_mfma_f32_32x32x16_bf16 v[32:47], v[224:227], a[192:195], 0
    s_add_u32 s67, s58, 589824
    buffer_load_dwordx4 v[224:227], v7, s[8:11], s67 offen
    s_waitcnt vmcnt(20)
    v_mfma_f32_32x32x16_bf16 v[16:31], v[228:231], a[132:135], v[16:31]
    v_cvt_pk_f16_f32 v48, v48, v49
    v_cvt_pk_f16_f32 v49, v50, v51
    v_cvt_pk_f16_f32 v50, v52, v53
    v_mfma_f32_32x32x16_bf16 v[32:47], v[228:231], a[196:199], v[32:47]
    s_add_u32 s67, s58, 590848
    buffer_load_dwordx4 v[228:231], v7, s[8:11], s67 offen
    s_waitcnt vmcnt(19)
    v_mfma_f32_32x32x16_bf16 v[16:31], v[232:235], a[136:139], v[16:31]
    v_cvt_pk_f16_f32 v51, v54, v55
    s_mov_b32 s70, 1572864
    buffer_store_dwordx4 v[48:51], v12, s[28:31], s70 offen sc1
    v_mfma_f32_32x32x16_bf16 v[32:47], v[232:235], a[200:203], v[32:47]
    s_waitcnt vmcnt(18)
    v_mfma_f32_32x32x16_bf16 v[16:31], v[236:239], a[140:143], v[16:31]
    v_cvt_pk_f16_f32 v52, v56, v57
    v_cvt_pk_f16_f32 v53, v58, v59
    v_cvt_pk_f16_f32 v54, v60, v61
    v_mfma_f32_32x32x16_bf16 v[32:47], v[236:239], a[204:207], v[32:47]
    s_waitcnt vmcnt(16)
    v_mfma_f32_32x32x16_bf16 v[16:31], v[240:243], a[144:147], v[16:31]
    v_cvt_pk_f16_f32 v55, v62, v63
    s_mov_b32 s70, 1589248
    buffer_store_dwordx4 v[52:55], v12, s[28:31], s70 offen sc1
    v_mfma_f32_32x32x16_bf16 v[32:47], v[240:243], a[208:211], v[32:47]
    s_waitcnt vmcnt(15)
    v_mfma_f32_32x32x16_bf16 v[16:31], v[244:247], a[148:151], v[16:31]
    v_cvt_pk_f16_f32 v80, v80, v81
    v_cvt_pk_f16_f32 v81, v82, v83
    v_cvt_pk_f16_f32 v82, v84, v85
    v_mfma_f32_32x32x16_bf16 v[32:47], v[244:247], a[212:215], v[32:47]
    s_waitcnt vmcnt(13)
    v_mfma_f32_32x32x16_bf16 v[16:31], v[248:251], a[152:155], v[16:31]
    v_cvt_pk_f16_f32 v83, v86, v87
    s_mov_b32 s70, 1605632
    buffer_store_dwordx4 v[80:83], v12, s[28:31], s70 offen sc1
    v_mfma_f32_32x32x16_bf16 v[32:47], v[248:251], a[216:219], v[32:47]
    s_waitcnt vmcnt(13)
    v_mfma_f32_32x32x16_bf16 v[16:31], v[252:255], a[156:159], v[16:31]
    v_cvt_pk_f16_f32 v84, v88, v89
    v_cvt_pk_f16_f32 v85, v90, v91
    v_cvt_pk_f16_f32 v86, v92, v93
    v_mfma_f32_32x32x16_bf16 v[32:47], v[252:255], a[220:223], v[32:47]
    s_waitcnt vmcnt(12)
    v_mfma_f32_32x32x16_bf16 v[16:31], v[192:195], a[160:163], v[16:31]
    v_cvt_pk_f16_f32 v87, v94, v95
    s_mov_b32 s70, 1622016
    buffer_store_dwordx4 v[84:87], v12, s[28:31], s70 offen sc1
    v_mfma_f32_32x32x16_bf16 v[32:47], v[192:195], a[224:227], v[32:47]
    s_waitcnt vmcnt(12)
    v_mfma_f32_32x32x16_bf16 v[16:31], v[196:199], a[164:167], v[16:31]
    v_cvt_pk_f16_f32 v96, v96, v97
    v_cvt_pk_f16_f32 v97, v98, v99
    v_cvt_pk_f16_f32 v98, v100, v101
    v_mfma_f32_32x32x16_bf16 v[32:47], v[196:199], a[228:231], v[32:47]
    s_waitcnt vmcnt(11)
    v_mfma_f32_32x32x16_bf16 v[16:31], v[200:203], a[168:171], v[16:31]
    v_cvt_pk_f16_f32 v99, v102, v103
    s_mov_b32 s70, 1638400
    buffer_store_dwordx4 v[96:99], v12, s[28:31], s70 offen sc1
    v_mfma_f32_32x32x16_bf16 v[32:47], v[200:203], a[232:235], v[32:47]
    s_waitcnt vmcnt(11)
    v_mfma_f32_32x32x16_bf16 v[16:31], v[204:207], a[172:175], v[16:31]
    v_cvt_pk_f16_f32 v100, v104, v105
    v_cvt_pk_f16_f32 v101, v106, v107
    v_cvt_pk_f16_f32 v102, v108, v109
    v_mfma_f32_32x32x16_bf16 v[32:47], v[204:207], a[236:239], v[32:47]
    s_waitcnt vmcnt(10)
    v_mfma_f32_32x32x16_bf16 v[16:31], v[208:211], a[176:179], v[16:31]
    v_cvt_pk_f16_f32 v103, v110, v111
    s_mov_b32 s70, 1654784
    buffer_store_dwordx4 v[100:103], v12, s[28:31], s70 offen sc1
    v_mfma_f32_32x32x16_bf16 v[32:47], v[208:211], a[240:243], v[32:47]
    s_waitcnt vmcnt(10)
    v_mfma_f32_32x32x16_bf16 v[16:31], v[212:215], a[180:183], v[16:31]
    v_cvt_pk_f16_f32 v128, v128, v129
    v_cvt_pk_f16_f32 v129, v130, v131
    v_cvt_pk_f16_f32 v130, v132, v133
    v_mfma_f32_32x32x16_bf16 v[32:47], v[212:215], a[244:247], v[32:47]
    s_waitcnt vmcnt(9)
    v_mfma_f32_32x32x16_bf16 v[16:31], v[216:219], a[184:187], v[16:31]
    v_cvt_pk_f16_f32 v131, v134, v135
    s_mov_b32 s70, 1671168
    buffer_store_dwordx4 v[128:131], v12, s[28:31], s70 offen sc1
    v_mfma_f32_32x32x16_bf16 v[32:47], v[216:219], a[248:251], v[32:47]
    s_waitcnt vmcnt(9)
    v_mfma_f32_32x32x16_bf16 v[16:31], v[220:223], a[188:191], v[16:31]
    v_cvt_pk_f16_f32 v132, v136, v137
    v_cvt_pk_f16_f32 v133, v138, v139
    v_cvt_pk_f16_f32 v134, v140, v141
    v_mfma_f32_32x32x16_bf16 v[32:47], v[220:223], a[252:255], v[32:47]
    s_waitcnt vmcnt(8)
    v_mfma_f32_32x32x16_bf16 v[16:31], v[224:227], v[176:179], v[16:31]
    v_cvt_pk_f16_f32 v135, v142, v143
    s_mov_b32 s70, 1687552
    buffer_store_dwordx4 v[132:135], v12, s[28:31], s70 offen sc1
    v_mfma_f32_32x32x16_bf16 v[32:47], v[224:227], v[184:187], v[32:47]
    s_waitcnt vmcnt(8)
    v_mfma_f32_32x32x16_bf16 v[16:31], v[228:231], v[180:183], v[16:31]
    v_mfma_f32_32x32x16_bf16 v[32:47], v[228:231], v[188:191], v[32:47]
KF_H2:
    s_nop 7
    s_nop 7
    s_nop 7
    v_cvt_pk_f16_f32 v16, v16, v17
    v_cvt_pk_f16_f32 v17, v18, v19
    v_cvt_pk_f16_f32 v18, v20, v21
    v_cvt_pk_f16_f32 v19, v22, v23
    s_mov_b32 s70, 0
    buffer_store_dwordx4 v[16:19], v13, s[28:31], s70 offen sc1
    v_cvt_pk_f16_f32 v20, v24, v25
    v_cvt_pk_f16_f32 v21, v26, v27
    v_cvt_pk_f16_f32 v22, v28, v29
    v_cvt_pk_f16_f32 v23, v30, v31
    s_mov_b32 s70, 16384
    buffer_store_dwordx4 v[20:23], v13, s[28:31], s70 offen sc1
    v_cvt_pk_f16_f32 v32, v32, v33
    v_cvt_pk_f16_f32 v33, v34, v35
    v_cvt_pk_f16_f32 v34, v36, v37
    v_cvt_pk_f16_f32 v35, v38, v39
    s_mov_b32 s70, 32768
    buffer_store_dwordx4 v[32:35], v13, s[28:31], s70 offen sc1
    v_cvt_pk_f16_f32 v36, v40, v41
    v_cvt_pk_f16_f32 v37, v42, v43
    v_cvt_pk_f16_f32 v38, v44, v45
    v_cvt_pk_f16_f32 v39, v46, v47
    s_mov_b32 s70, 49152
    buffer_store_dwordx4 v[36:39], v13, s[28:31], s70 offen sc1
    s_waitcnt vmcnt(0)
    s_memtime s[66:67]
    s_waitcnt lgkmcnt(0)
    s_cmp_ge_u32 s2, 6
    s_cbranch_scc1 KF_END
    s_and_b32 s70, s2, 1
    s_cmp_lg_u32 s70, 0
    s_cbranch_scc1 KF_END
    s_lshr_b32 s71, s2, 1
    s_sub_u32 s62, s62, s60
    s_sub_u32 s64, s64, s60
    s_sub_u32 s66, s66, s60
    s_lshl_b32 s68, s71, 4
    s_add_u32 s68, s68, 130433024
    v_mov_b32 v1, s68
    v_mov_b32 v2, s62
    v_mov_b32 v3, s64
    v_mov_b32 v4, s66
    s_getreg_b32 s69, hwreg(HW_REG_XCC_ID)
    v_mov_b32 v5, s69
    global_store_dwordx4 v1, v[2:5], s[4:5]
KF_END:
    s_endpgm
.globl k3c_kernel
.p2align 8
.type k3c_kernel,@function
k3c_kernel:
    s_cmp_lg_u32 s2, 0
    s_cbranch_scc1 STK2
    s_load_dwordx2 s[96:97], s[0:1], 120
    s_memrealtime s[98:99]
    s_waitcnt lgkmcnt(0)
    v_mov_b32 v1, 130433080
    v_mov_b32 v2, s98
    global_store_dword v1, v2, s[96:97]
STK2:
    s_load_dwordx2 s[4:5], s[0:1], 120
    s_load_dwordx2 s[6:7], s[0:1], 64
    s_load_dwordx2 s[80:81], s[0:1], 0
    s_load_dwordx2 s[82:83], s[0:1], 104
    s_mov_b32 s90, 0x7fff
    s_cmp_ge_u32 s2, 1024
    s_cbranch_scc1 K3_END
    s_cmp_ge_u32 s2, 576
    s_cbranch_scc1 K3R
    s_and_b32 s20, s2, 7
    s_lshl_b32 s20, s20, 3
    s_bfe_u32 s21, s2, 0x30003
    s_andn2_b32 s2, s2, 63
    s_or_b32 s2, s2, s20
    s_or_b32 s2, s2, s21
    s_waitcnt lgkmcnt(0)
    s_add_u32 s36, s4, 150673408
    s_addc_u32 s37, s5, 0
    s_and_b32 s37, s37, 0xffff
    s_mov_b32 s38, 2949120
    s_mov_b32 s39, 0x00020000
    s_add_u32 s52, s4, 153626624
    s_addc_u32 s53, s5, 0
    s_and_b32 s53, s53, 0xffff
    s_mov_b32 s54, 2372608
    s_mov_b32 s55, 0x00020000
    s_add_u32 s32, s6, 0
    s_addc_u32 s33, s7, 0
    s_and_b32 s33, s33, 0xffff
    s_mov_b32 s34, 1152
    s_mov_b32 s35, 0x00020000
    s_add_u32 s8, s4, 130467840
    s_addc_u32 s9, s5, 0
    s_and_b32 s9, s9, 0xffff
    s_mov_b32 s10, 2433024
    s_mov_b32 s11, 0x00020000
    v_lshlrev_b32 v4, 4, v0
    s_mul_i32 s41, s2, 4224
    v_lshrrev_b32 v1, 6, v0
    s_nop 0
    v_readfirstlane_b32 s20, v1
    buffer_load_dwordx4 v[16:19], v4, s[8:11], s41 offen
    buffer_load_dwordx4 v[20:23], v4, s[8:11], s41 offen offset:16
    buffer_load_dwordx4 v[24:27], v4, s[8:11], s41 offen offset:4
    buffer_load_dwordx4 v[28:31], v4, s[8:11], s41 offen offset:20
    s_lshl_b32 s40, s2, 4
    v_mul_u32_u24 v6, 9216, v0
    buffer_load_dwordx4 v[48:51], v6, s[36:39], s40 offen
    v_lshrrev_b32 v6, 2, v0
    v_lshl_add_u32 v6, v6, 4, v4
    s_lshl_b32 s27, s2, 1
    v_mov_b32 v1, s27
    buffer_load_ushort v1, v1, s[32:35], 0 offen
    v_mov_b32 v15, 4160
    buffer_load_dword v15, v15, s[8:11], s41 offen
    v_and_b32 v2, 63, v0
    v_lshlrev_b32 v3, 4, v2
    v_min_u32 v7, 2464, v4
    v_bfe_u32 v8, v0, 2, 3
    v_bfe_u32 v9, v0, 4, 1
    v_mul_u32_u24 v8, 4144, v8
    v_mul_u32_u24 v9, 0, v9
    v_add_u32 v8, v8, v9
    v_and_b32 v9, 3, v0
    v_min_u32 v9, 2, v9
    v_lshl_add_u32 v8, v9, 4, v8
    v_add_u32 v8, 11696, v8
    v_cmp_gt_u32 vcc, 160, v0
    v_cndmask_b32 v7, v8, v7, vcc
    v_mov_b32 v8, 0
    v_mov_b32 v9, 0
    v_mov_b32 v10, 0
    v_mov_b32 v11, 0
    ds_write_b128 v7, v[8:11]
    s_nop 0
    v_and_b32 v10, 31, v2
    v_lshrrev_b32 v11, 5, v2
    v_lshlrev_b32 v12, 3, v11
    v_sub_u32 v12, v12, v10
    v_add_u32 v12, 2047, v12
    v_and_b32 v13, 7, v12
    v_bfe_u32 v9, v12, 2, 1
    v_mul_u32_u24 v13, 4144, v13
    v_mul_u32_u24 v9, 0, v9
    v_add_u32 v13, v13, v9
    v_and_b32 v12, -8, v12
    v_lshl_add_u32 v12, v12, 1, v13
    v_add_u32 v12, 7600, v12
    v_mul_u32_u24 v14, 80, v10
    v_lshl_add_u32 v14, v11, 4, v14
    s_lshr_b32 s42, s2, 4
    s_lshl_b32 s43, s42, 8
    s_lshl_b32 s71, s20, 6
    s_add_u32 s43, s43, s71
    s_add_u32 s43, s43, 2363392
    v_lshlrev_b32 v5, 2, v2
    v_mov_b32 v13, 1
    s_mov_b64 exec, 0xffff
    buffer_atomic_add v13, v5, s[52:55], s43 offen sc0 sc1
    s_mov_b64 exec, -1
    s_mul_i32 s21, s20, 512
    s_add_u32 s21, s21, 2528
    v_subrev_u32 v12, s21, v12
    s_mul_i32 s21, s20, 640
    s_sub_u32 s21, 1920, s21
    v_add_u32 v14, s21, v14
    s_mov_b32 s30, 0xffff0000
    s_mov_b32 s31, 0xffff0000
    s_waitcnt vmcnt(6)
    ds_write_b128 v4, v[16:19] offset:7600
    ds_write_b128 v4, v[18:21] offset:24176
    v_alignbit_b32 v32, v17, v16, 16
    v_alignbit_b32 v33, v18, v17, 16
    v_alignbit_b32 v34, v19, v18, 16
    v_alignbit_b32 v35, v20, v19, 16
    v_alignbit_b32 v36, v21, v20, 16
    v_alignbit_b32 v37, v22, v21, 16
    v_alignbit_b32 v40, v18, v17, 16
    v_alignbit_b32 v41, v19, v18, 16
    v_alignbit_b32 v42, v20, v19, 16
    v_alignbit_b32 v43, v21, v20, 16
    v_alignbit_b32 v44, v22, v21, 16
    v_alignbit_b32 v45, v23, v22, 16
    ds_write_b128 v4, v[32:35] offset:11744
    ds_write_b128 v4, v[34:37] offset:28320
    ds_write_b128 v4, v[40:43] offset:20032
    ds_write_b128 v4, v[42:45] offset:36608
    s_waitcnt vmcnt(4)
    ds_write_b128 v4, v[24:27] offset:15888
    ds_write_b128 v4, v[26:29] offset:32464
    s_waitcnt vmcnt(3)
    ds_write_b128 v6, v[48:51] offset:2480
    s_waitcnt lgkmcnt(0)
    s_barrier
    ds_read_b128 v[48:51], v12 offset:2560
    ds_read_b128 v[52:55], v12 offset:512
    ds_read_b128 v[24:27], v14 offset:592
    ds_read_b128 v[28:31], v14 offset:3152
    ds_read_b128 v[56:59], v12 offset:2496
    ds_read_b128 v[60:63], v12 offset:448
    ds_read_b128 v[20:23], v14 offset:3120
    ds_read_b128 v[16:19], v14 offset:560
    ds_read_b128 v[40:43], v14 offset:512
    ds_read_b128 v[44:47], v14 offset:3072
    ds_read_b128 v[4:7], v12 offset:2432
    ds_read_b128 v[8:11], v12 offset:384
    ds_read_b128 v[36:39], v14 offset:3040
    ds_read_b128 v[32:35], v14 offset:480
    s_waitcnt lgkmcnt(11)
    v_mfma_f32_32x32x16_f16 v[80:95], v[52:55], v[24:27], 0
    v_mfma_f32_32x32x16_f16 v[64:79], v[48:51], v[24:27], 0
    s_waitcnt lgkmcnt(10)
    v_mfma_f32_32x32x16_f16 v[80:95], v[48:51], v[28:31], v[80:95]
    s_waitcnt lgkmcnt(8)
    v_cndmask_b32 v48, v56, v48, s[30:31]
    v_cndmask_b32 v49, v57, v49, s[30:31]
    v_cndmask_b32 v50, v58, v50, s[30:31]
    v_cndmask_b32 v51, v59, v51, s[30:31]
    v_cndmask_b32 v52, v60, v52, s[30:31]
    v_cndmask_b32 v53, v61, v53, s[30:31]
    v_cndmask_b32 v54, v62, v54, s[30:31]
    v_cndmask_b32 v55, v63, v55, s[30:31]
    s_waitcnt lgkmcnt(7)
    v_mfma_f32_32x32x16_f16 v[112:127], v[48:51], v[20:23], 0
    s_waitcnt lgkmcnt(6)
    v_mfma_f32_32x32x16_f16 v[96:111], v[48:51], v[16:19], 0
    v_mfma_f32_32x32x16_f16 v[112:127], v[52:55], v[16:19], v[112:127]
    ds_read_b128 v[24:27], v14 offset:432
    ds_read_b128 v[28:31], v14 offset:2992
    ds_read_b128 v[48:51], v12 offset:2368
    ds_read_b128 v[52:55], v12 offset:320
    ds_read_b128 v[20:23], v14 offset:2960
    ds_read_b128 v[16:19], v14 offset:400
    s_waitcnt lgkmcnt(11)
    v_mfma_f32_32x32x16_f16 v[80:95], v[60:63], v[40:43], v[80:95]
    v_mfma_f32_32x32x16_f16 v[64:79], v[56:59], v[40:43], v[64:79]
    s_waitcnt lgkmcnt(10)
    v_mfma_f32_32x32x16_f16 v[80:95], v[56:59], v[44:47], v[80:95]
    s_waitcnt lgkmcnt(8)
    v_cndmask_b32 v56, v4, v56, s[30:31]
    v_cndmask_b32 v57, v5, v57, s[30:31]
    v_cndmask_b32 v58, v6, v58, s[30:31]
    v_cndmask_b32 v59, v7, v59, s[30:31]
    v_cndmask_b32 v60, v8, v60, s[30:31]
    v_cndmask_b32 v61, v9, v61, s[30:31]
    v_cndmask_b32 v62, v10, v62, s[30:31]
    v_cndmask_b32 v63, v11, v63, s[30:31]
    s_waitcnt lgkmcnt(7)
    v_mfma_f32_32x32x16_f16 v[112:127], v[56:59], v[36:39], v[112:127]
    s_waitcnt lgkmcnt(6)
    v_mfma_f32_32x32x16_f16 v[96:111], v[56:59], v[32:35], v[96:111]
    v_mfma_f32_32x32x16_f16 v[112:127], v[60:63], v[32:35], v[112:127]
    ds_read_b128 v[40:43], v14 offset:352
    ds_read_b128 v[44:47], v14 offset:2912
    ds_read_b128 v[56:59], v12 offset:2304
    ds_read_b128 v[60:63], v12 offset:256
    ds_read_b128 v[36:39], v14 offset:2880
    ds_read_b128 v[32:35], v14 offset:320
    s_waitcnt lgkmcnt(11)
    v_mfma_f32_32x32x16_f16 v[80:95], v[8:11], v[24:27], v[80:95]
    v_mfma_f32_32x32x16_f16 v[64:79], v[4:7], v[24:27], v[64:79]
    s_waitcnt lgkmcnt(10)
    v_mfma_f32_32x32x16_f16 v[80:95], v[4:7], v[28:31], v[80:95]
    s_waitcnt lgkmcnt(8)
    v_cndmask_b32 v4, v48, v4, s[30:31]
    v_cndmask_b32 v5, v49, v5, s[30:31]
    v_cndmask_b32 v6, v50, v6, s[30:31]
    v_cndmask_b32 v7, v51, v7, s[30:31]
    v_cndmask_b32 v8, v52, v8, s[30:31]
    v_cndmask_b32 v9, v53, v9, s[30:31]
    v_cndmask_b32 v10, v54, v10, s[30:31]
    v_cndmask_b32 v11, v55, v11, s[30:31]
    s_waitcnt lgkmcnt(7)
    v_mfma_f32_32x32x16_f16 v[112:127], v[4:7], v[20:23], v[112:127]
    s_waitcnt lgkmcnt(6)
    v_mfma_f32_32x32x16_f16 v[96:111], v[4:7], v[16:19], v[96:111]
    v_mfma_f32_32x32x16_f16 v[112:127], v[8:11], v[16:19], v[112:127]
    ds_read_b128 v[24:27], v14 offset:272
    ds_read_b128 v[28:31], v14 offset:2832
    ds_read_b128 v[4:7], v12 offset:2240
    ds_read_b128 v[8:11], v12 offset:192
    ds_read_b128 v[20:23], v14 offset:2800
    ds_read_b128 v[16:19], v14 offset:240
    s_waitcnt lgkmcnt(11)
    v_mfma_f32_32x32x16_f16 v[80:95], v[52:55], v[40:43], v[80:95]
    v_mfma_f32_32x32x16_f16 v[64:79], v[48:51], v[40:43], v[64:79]
    s_waitcnt lgkmcnt(10)
    v_mfma_f32_32x32x16_f16 v[80:95], v[48:51], v[44:47], v[80:95]
    s_waitcnt lgkmcnt(8)
    v_cndmask_b32 v48, v56, v48, s[30:31]
    v_cndmask_b32 v49, v57, v49, s[30:31]
    v_cndmask_b32 v50, v58, v50, s[30:31]
    v_cndmask_b32 v51, v59, v51, s[30:31]
    v_cndmask_b32 v52, v60, v52, s[30:31]
    v_cndmask_b32 v53, v61, v53, s[30:31]
    v_cndmask_b32 v54, v62, v54, s[30:31]
    v_cndmask_b32 v55, v63, v55, s[30:31]
    s_waitcnt lgkmcnt(7)
    v_mfma_f32_32x32x16_f16 v[112:127], v[48:51], v[36:39], v[112:127]
    s_waitcnt lgkmcnt(6)
    v_mfma_f32_32x32x16_f16 v[96:111], v[48:51], v[32:35], v[96:111]
    v_mfma_f32_32x32x16_f16 v[112:127], v[52:55], v[32:35], v[112:127]
    ds_read_b128 v[40:43], v14 offset:192
    ds_read_b128 v[44:47], v14 offset:2752
    ds_read_b128 v[48:51], v12 offset:2176
    ds_read_b128 v[52:55], v12 offset:128
    ds_read_b128 v[36:39], v14 offset:2720
    ds_read_b128 v[32:35], v14 offset:160
    s_waitcnt lgkmcnt(11)
    v_mfma_f32_32x32x16_f16 v[80:95], v[60:63], v[24:27], v[80:95]
    v_mfma_f32_32x32x16_f16 v[64:79], v[56:59], v[24:27], v[64:79]
    s_waitcnt lgkmcnt(10)
    v_mfma_f32_32x32x16_f16 v[80:95], v[56:59], v[28:31], v[80:95]
    s_waitcnt lgkmcnt(8)
    v_cndmask_b32 v56, v4, v56, s[30:31]
    v_cndmask_b32 v57, v5, v57, s[30:31]
    v_cndmask_b32 v58, v6, v58, s[30:31]
    v_cndmask_b32 v59, v7, v59, s[30:31]
    v_cndmask_b32 v60, v8, v60, s[30:31]
    v_cndmask_b32 v61, v9, v61, s[30:31]
    v_cndmask_b32 v62, v10, v62, s[30:31]
    v_cndmask_b32 v63, v11, v63, s[30:31]
    s_waitcnt lgkmcnt(7)
    v_mfma_f32_32x32x16_f16 v[112:127], v[56:59], v[20:23], v[112:127]
    s_waitcnt lgkmcnt(6)
    v_mfma_f32_32x32x16_f16 v[96:111], v[56:59], v[16:19], v[96:111]
    v_mfma_f32_32x32x16_f16 v[112:127], v[60:63], v[16:19], v[112:127]
    ds_read_b128 v[24:27], v14 offset:112
    ds_read_b128 v[28:31], v14 offset:2672
    ds_read_b128 v[56:59], v12 offset:2112
    ds_read_b128 v[60:63], v12 offset:64
    ds_read_b128 v[20:23], v14 offset:2640
    ds_read_b128 v[16:19], v14 offset:80
    s_waitcnt lgkmcnt(11)
    v_mfma_f32_32x32x16_f16 v[80:95], v[8:11], v[40:43], v[80:95]
    v_mfma_f32_32x32x16_f16 v[64:79], v[4:7], v[40:43], v[64:79]
    s_waitcnt lgkmcnt(10)
    v_mfma_f32_32x32x16_f16 v[80:95], v[4:7], v[44:47], v[80:95]
    s_waitcnt lgkmcnt(8)
    v_cndmask_b32 v4, v48, v4, s[30:31]
    v_cndmask_b32 v5, v49, v5, s[30:31]
    v_cndmask_b32 v6, v50, v6, s[30:31]
    v_cndmask_b32 v7, v51, v7, s[30:31]
    v_cndmask_b32 v8, v52, v8, s[30:31]
    v_cndmask_b32 v9, v53, v9, s[30:31]
    v_cndmask_b32 v10, v54, v10, s[30:31]
    v_cndmask_b32 v11, v55, v11, s[30:31]
    s_waitcnt lgkmcnt(7)
    v_mfma_f32_32x32x16_f16 v[112:127], v[4:7], v[36:39], v[112:127]
    s_waitcnt lgkmcnt(6)
    v_mfma_f32_32x32x16_f16 v[96:111], v[4:7], v[32:35], v[96:111]
    v_mfma_f32_32x32x16_f16 v[112:127], v[8:11], v[32:35], v[112:127]
    ds_read_b128 v[40:43], v14 offset:32
    ds_read_b128 v[44:47], v14 offset:2592
    ds_read_b128 v[4:7], v12 offset:2048
    ds_read_b128 v[8:11], v12 offset:0
    ds_read_b128 v[36:39], v14 offset:2560
    ds_read_b128 v[32:35], v14 offset:0
    s_waitcnt lgkmcnt(11)
    v_mfma_f32_32x32x16_f16 v[80:95], v[52:55], v[24:27], v[80:95]
    v_mfma_f32_32x32x16_f16 v[64:79], v[48:51], v[24:27], v[64:79]
    s_waitcnt lgkmcnt(10)
    v_mfma_f32_32x32x16_f16 v[80:95], v[48:51], v[28:31], v[80:95]
    s_waitcnt lgkmcnt(8)
    v_cndmask_b32 v48, v56, v48, s[30:31]
    v_cndmask_b32 v49, v57, v49, s[30:31]
    v_cndmask_b32 v50, v58, v50, s[30:31]
    v_cndmask_b32 v51, v59, v51, s[30:31]
    v_cndmask_b32 v52, v60, v52, s[30:31]
    v_cndmask_b32 v53, v61, v53, s[30:31]
    v_cndmask_b32 v54, v62, v54, s[30:31]
    v_cndmask_b32 v55, v63, v55, s[30:31]
    s_waitcnt lgkmcnt(7)
    v_mfma_f32_32x32x16_f16 v[112:127], v[48:51], v[20:23], v[112:127]
    s_waitcnt lgkmcnt(6)
    v_mfma_f32_32x32x16_f16 v[96:111], v[48:51], v[16:19], v[96:111]
    v_mfma_f32_32x32x16_f16 v[112:127], v[52:55], v[16:19], v[112:127]
    s_waitcnt lgkmcnt(5)
    v_mfma_f32_32x32x16_f16 v[80:95], v[60:63], v[40:43], v[80:95]
    v_mfma_f32_32x32x16_f16 v[64:79], v[56:59], v[40:43], v[64:79]
    s_waitcnt lgkmcnt(4)
    v_mfma_f32_32x32x16_f16 v[80:95], v[56:59], v[44:47], v[80:95]
    s_waitcnt lgkmcnt(2)
    v_cndmask_b32 v56, v4, v56, s[30:31]
    v_cndmask_b32 v57, v5, v57, s[30:31]
    v_cndmask_b32 v58, v6, v58, s[30:31]
    v_cndmask_b32 v59, v7, v59, s[30:31]
    v_cndmask_b32 v60, v8, v60, s[30:31]
    v_cndmask_b32 v61, v9, v61, s[30:31]
    v_cndmask_b32 v62, v10, v62, s[30:31]
    v_cndmask_b32 v63, v11, v63, s[30:31]
    s_waitcnt lgkmcnt(1)
    v_mfma_f32_32x32x16_f16 v[112:127], v[56:59], v[36:39], v[112:127]
    s_waitcnt lgkmcnt(0)
    v_mfma_f32_32x32x16_f16 v[96:111], v[56:59], v[32:35], v[96:111]
    v_mfma_f32_32x32x16_f16 v[112:127], v[60:63], v[32:35], v[112:127]
    s_nop 7
    s_nop 7
    s_nop 3
    v_add_f32 v64, v64, v104
    v_add_f32 v65, v65, v105
    v_add_f32 v66, v66, v106
    v_add_f32 v67, v67, v107
    v_add_f32 v68, v68, v108
    v_add_f32 v69, v69, v109
    v_add_f32 v70, v70, v110
    v_add_f32 v71, v71, v111
    v_add_f32 v72, v72, v96
    v_add_f32 v73, v73, v97
    v_add_f32 v74, v74, v98
    v_add_f32 v75, v75, v99
    v_add_f32 v76, v76, v100
    v_add_f32 v77, v77, v101
    v_add_f32 v78, v78, v102
    v_add_f32 v79, v79, v103
    v_add_f32 v80, v80, v120
    v_add_f32 v81, v81, v121
    v_add_f32 v82, v82, v122
    v_add_f32 v83, v83, v123
    v_add_f32 v84, v84, v124
    v_add_f32 v85, v85, v125
    v_add_f32 v86, v86, v126
    v_add_f32 v87, v87, v127
    v_add_f32 v88, v88, v112
    v_add_f32 v89, v89, v113
    v_add_f32 v90, v90, v114
    v_add_f32 v91, v91, v115
    v_add_f32 v92, v92, v116
    v_add_f32 v93, v93, v117
    v_add_f32 v94, v94, v118
    v_add_f32 v95, v95, v119
    s_barrier
    s_lshl_b32 s21, s20, 13
    v_add_u32 v4, s21, v3
    v_xor_b32 v6, 64, v4
    v_xor_b32 v7, 0x80, v4
    v_xor_b32 v8, 0xc0, v4
    ds_write_b128 v4, v[64:67] offset:7600
    ds_write_b128 v6, v[68:71] offset:8624
    ds_write_b128 v7, v[72:75] offset:9648
    ds_write_b128 v8, v[76:79] offset:10672
    ds_write_b128 v4, v[80:83] offset:11696
    ds_write_b128 v6, v[84:87] offset:12720
    ds_write_b128 v7, v[88:91] offset:13744
    ds_write_b128 v8, v[92:95] offset:14768
    v_and_b32 v16, 3, v0
    v_bfe_u32 v17, v0, 2, 5
    v_lshlrev_b32 v9, 2, v16
    v_xor_b32 v17, v17, v9
    v_lshlrev_b32 v17, 4, v17
    v_lshl_add_u32 v17, v16, 10, v17
    v_lshrrev_b32 v9, 7, v0
    v_lshl_add_u32 v9, v9, 12, v17
    v_lshrrev_b32 v17, 2, v0
    v_mul_u32_u24 v17, 80, v17
    v_lshl_add_u32 v10, v16, 4, v17
    ds_read_b128 v[48:51], v10 offset:2480
    s_waitcnt lgkmcnt(0)
    s_barrier
    ds_read_b128 v[16:19], v9 offset:7600
    ds_read_b128 v[20:23], v9 offset:15792
    ds_read_b128 v[24:27], v9 offset:23984
    ds_read_b128 v[28:31], v9 offset:32176
    ds_read_b128 v[32:35], v9 offset:8112
    ds_read_b128 v[36:39], v9 offset:16304
    ds_read_b128 v[40:43], v9 offset:24496
    ds_read_b128 v[44:47], v9 offset:32688
    v_lshlrev_b32 v6, 4, v0
    s_lshl_b32 s23, s2, 12
    s_mov_b32 s24, 0xfffefffe
    s_waitcnt vmcnt(0) lgkmcnt(0)
    v_lshlrev_b32 v5, 16, v1
    v_mul_f32 v5, 0x3a800000, v5
    v_add_f32 v16, v16, v20
    v_add_f32 v24, v24, v28
    v_add_f32 v16, v16, v24
    v_mul_f32 v16, v16, v15
    v_bfe_u32 v7, v16, 16, 1
    v_add3_u32 v7, v16, v7, s90
    v_and_b32 v16, 0xffff0000, v7
    v_fma_mix_f32 v8, v48, v5, 0 op_sel:[0,0,0] op_sel_hi:[1,0,0]
    v_bfe_u32 v7, v8, 16, 1
    v_add3_u32 v7, v8, v7, s90
    v_and_b32 v8, 0xffff0000, v7
    v_add_f32 v16, v16, v8
    v_add_f32 v17, v17, v21
    v_add_f32 v25, v25, v29
    v_add_f32 v17, v17, v25
    v_mul_f32 v17, v17, v15
    v_bfe_u32 v7, v17, 16, 1
    v_add3_u32 v7, v17, v7, s90
    v_and_b32 v17, 0xffff0000, v7
    v_fma_mix_f32 v8, v48, v5, 0 op_sel:[1,0,0] op_sel_hi:[1,0,0]
    v_bfe_u32 v7, v8, 16, 1
    v_add3_u32 v7, v8, v7, s90
    v_and_b32 v8, 0xffff0000, v7
    v_add_f32 v17, v17, v8
    v_add_f32 v18, v18, v22
    v_add_f32 v26, v26, v30
    v_add_f32 v18, v18, v26
    v_mul_f32 v18, v18, v15
    v_bfe_u32 v7, v18, 16, 1
    v_add3_u32 v7, v18, v7, s90
    v_and_b32 v18, 0xffff0000, v7
    v_fma_mix_f32 v8, v49, v5, 0 op_sel:[0,0,0] op_sel_hi:[1,0,0]
    v_bfe_u32 v7, v8, 16, 1
    v_add3_u32 v7, v8, v7, s90
    v_and_b32 v8, 0xffff0000, v7
    v_add_f32 v18, v18, v8
    v_add_f32 v19, v19, v23
    v_add_f32 v27, v27, v31
    v_add_f32 v19, v19, v27
    v_mul_f32 v19, v19, v15
    v_bfe_u32 v7, v19, 16, 1
    v_add3_u32 v7, v19, v7, s90
    v_and_b32 v19, 0xffff0000, v7
    v_fma_mix_f32 v8, v49, v5, 0 op_sel:[1,0,0] op_sel_hi:[1,0,0]
    v_bfe_u32 v7, v8, 16, 1
    v_add3_u32 v7, v8, v7, s90
    v_and_b32 v8, 0xffff0000, v7
    v_add_f32 v19, v19, v8
    v_cvt_pk_bf16_f32 v52, v16, v17
    v_cvt_pk_bf16_f32 v53, v18, v19
    v_pk_min_u16 v52, v52, s24
    v_pk_min_u16 v53, v53, s24
    v_add_f32 v32, v32, v36
    v_add_f32 v40, v40, v44
    v_add_f32 v32, v32, v40
    v_mul_f32 v32, v32, v15
    v_bfe_u32 v7, v32, 16, 1
    v_add3_u32 v7, v32, v7, s90
    v_and_b32 v32, 0xffff0000, v7
    v_fma_mix_f32 v8, v50, v5, 0 op_sel:[0,0,0] op_sel_hi:[1,0,0]
    v_bfe_u32 v7, v8, 16, 1
    v_add3_u32 v7, v8, v7, s90
    v_and_b32 v8, 0xffff0000, v7
    v_add_f32 v32, v32, v8
    v_add_f32 v33, v33, v37
    v_add_f32 v41, v41, v45
    v_add_f32 v33, v33, v41
    v_mul_f32 v33, v33, v15
    v_bfe_u32 v7, v33, 16, 1
    v_add3_u32 v7, v33, v7, s90
    v_and_b32 v33, 0xffff0000, v7
    v_fma_mix_f32 v8, v50, v5, 0 op_sel:[1,0,0] op_sel_hi:[1,0,0]
    v_bfe_u32 v7, v8, 16, 1
    v_add3_u32 v7, v8, v7, s90
    v_and_b32 v8, 0xffff0000, v7
    v_add_f32 v33, v33, v8
    v_add_f32 v34, v34, v38
    v_add_f32 v42, v42, v46
    v_add_f32 v34, v34, v42
    v_mul_f32 v34, v34, v15
    v_bfe_u32 v7, v34, 16, 1
    v_add3_u32 v7, v34, v7, s90
    v_and_b32 v34, 0xffff0000, v7
    v_fma_mix_f32 v8, v51, v5, 0 op_sel:[0,0,0] op_sel_hi:[1,0,0]
    v_bfe_u32 v7, v8, 16, 1
    v_add3_u32 v7, v8, v7, s90
    v_and_b32 v8, 0xffff0000, v7
    v_add_f32 v34, v34, v8
    v_add_f32 v35, v35, v39
    v_add_f32 v43, v43, v47
    v_add_f32 v35, v35, v43
    v_mul_f32 v35, v35, v15
    v_bfe_u32 v7, v35, 16, 1
    v_add3_u32 v7, v35, v7, s90
    v_and_b32 v35, 0xffff0000, v7
    v_fma_mix_f32 v8, v51, v5, 0 op_sel:[1,0,0] op_sel_hi:[1,0,0]
    v_bfe_u32 v7, v8, 16, 1
    v_add3_u32 v7, v8, v7, s90
    v_and_b32 v8, 0xffff0000, v7
    v_add_f32 v35, v35, v8
    v_cvt_pk_bf16_f32 v54, v32, v33
    v_cvt_pk_bf16_f32 v55, v34, v35
    v_pk_min_u16 v54, v54, s24
    v_pk_min_u16 v55, v55, s24
    buffer_store_dwordx4 v[52:55], v6, s[52:55], s23 offen sc0 sc1
    s_mov_b64 exec, 0xffff
    v_cmp_eq_u32 vcc, 0x10f, v13
    s_mov_b64 exec, -1
    s_cbranch_vccz K3_END
    s_mov_b32 s78, vcc_lo
    s_add_u32 s44, s80, 0
    s_addc_u32 s45, s81, 0
    s_and_b32 s45, s45, 0xffff
    s_mov_b32 s46, 2359296
    s_mov_b32 s47, 0x00020000
    s_add_u32 s48, s82, 0
    s_addc_u32 s49, s83, 0
    s_and_b32 s49, s49, 0xffff
    s_mov_b32 s50, 2359296
    s_mov_b32 s51, 0x00020000
    s_add_u32 s56, s4, 128073728
    s_addc_u32 s57, s5, 0
    s_and_b32 s57, s57, 0xffff
    s_mov_b32 s58, 2359296
    s_mov_b32 s59, 0x00020000
    v_and_b32 v4, 31, v0
    v_lshrrev_b32 v7, 6, v0
    v_mul_u32_u24 v7, 1280, v7
    v_lshl_add_u32 v97, v4, 1, v7
    v_mul_u32_u24 v4, 1152, v4
    v_bfe_u32 v5, v0, 5, 1
    v_lshl_add_u32 v4, v5, 3, v4
    v_mul_u32_u24 v5, 320, v5
    v_add_u32 v97, v97, v5
    v_bfe_u32 v5, v0, 2, 4
    v_and_b32 v96, 3, v0
    v_lshlrev_b32 v96, 4, v96
    v_lshl_add_u32 v6, v5, 12, v96
    v_mul_u32_u24 v5, 80, v5
    v_add3_u32 v96, v96, v5, v7
    v_mov_b32 v7, 0
K3CL:
    s_ff1_i32_b32 s72, s78
    s_bitset0_b32 s78, s72
    s_lshl_b32 s71, s20, 4
    s_add_u32 s72, s72, s71
    s_mul_i32 s64, s72, 36864
    s_lshl_b32 s70, s42, 5
    s_add_u32 s64, s64, s70
    s_lshl_b32 s65, s42, 16
    s_lshl_b32 s70, s72, 6
    s_add_u32 s65, s65, s70
    s_lshl_b32 s66, s42, 8
    s_lshl_b32 s70, s72, 2
    s_add_u32 s66, s66, s70
    s_add_u32 s66, s66, 2363392
    buffer_load_dwordx2 v[100:101], v4, s[44:47], s64 offen
    buffer_load_dwordx2 v[102:103], v4, s[44:47], s64 offen offset:16
    buffer_load_dwordx2 v[88:89], v4, s[56:59], s64 offen sc0 sc1
    buffer_load_dwordx2 v[90:91], v4, s[56:59], s64 offen offset:16 sc0 sc1
    s_mov_b32 s79, 0
K3SPC:
    buffer_load_dwordx4 v[108:111], v6, s[52:55], s65 offen sc0 sc1
    s_waitcnt vmcnt(0)
    v_pk_max_u16 v40, v108, v109
    v_pk_max_u16 v40, v40, v110
    v_pk_max_u16 v40, v40, v111
    v_lshrrev_b32 v41, 16, v40
    v_and_b32 v40, 0xffff, v40
    v_max_u32 v40, v40, v41
    v_cmp_eq_u32 vcc, 0xffff, v40
    s_cbranch_vccz K3SGC
    s_sleep 20
    s_add_u32 s79, s79, 1
    s_cmp_lt_u32 s79, 400000
    s_cbranch_scc1 K3SPC
K3SGC:
    ds_write_b128 v96, v[108:111] offset:0
    s_waitcnt lgkmcnt(0)
    ds_read_u16 v16, v97 offset:0
    ds_read_u16 v17, v97 offset:80
    ds_read_u16 v18, v97 offset:160
    ds_read_u16 v19, v97 offset:240
    ds_read_u16 v20, v97 offset:640
    ds_read_u16 v21, v97 offset:720
    ds_read_u16 v22, v97 offset:800
    ds_read_u16 v23, v97 offset:880
    s_waitcnt lgkmcnt(0)
    v_lshlrev_b32 v42, 16, v100
    v_and_b32 v43, 0xffff0000, v100
    v_lshlrev_b32 v44, 16, v16
    v_lshlrev_b32 v45, 16, v17
    v_add_f32 v42, v42, v44
    v_add_f32 v43, v43, v45
    v_bfe_u32 v46, v42, 16, 1
    v_add3_u32 v46, v42, v46, s90
    v_and_b32 v42, 0xffff0000, v46
    v_bfe_u32 v47, v43, 16, 1
    v_add3_u32 v47, v43, v47, s90
    v_and_b32 v43, 0xffff0000, v47
    v_lshlrev_b32 v44, 16, v88
    v_and_b32 v45, 0xffff0000, v88
    v_add_f32 v42, v42, v44
    v_add_f32 v43, v43, v45
    v_cvt_pk_bf16_f32 v48, v42, v43
    v_lshlrev_b32 v42, 16, v101
    v_and_b32 v43, 0xffff0000, v101
    v_lshlrev_b32 v44, 16, v18
    v_lshlrev_b32 v45, 16, v19
    v_add_f32 v42, v42, v44
    v_add_f32 v43, v43, v45
    v_bfe_u32 v46, v42, 16, 1
    v_add3_u32 v46, v42, v46, s90
    v_and_b32 v42, 0xffff0000, v46
    v_bfe_u32 v47, v43, 16, 1
    v_add3_u32 v47, v43, v47, s90
    v_and_b32 v43, 0xffff0000, v47
    v_lshlrev_b32 v44, 16, v89
    v_and_b32 v45, 0xffff0000, v89
    v_add_f32 v42, v42, v44
    v_add_f32 v43, v43, v45
    v_cvt_pk_bf16_f32 v49, v42, v43
    v_lshlrev_b32 v42, 16, v102
    v_and_b32 v43, 0xffff0000, v102
    v_lshlrev_b32 v44, 16, v20
    v_lshlrev_b32 v45, 16, v21
    v_add_f32 v42, v42, v44
    v_add_f32 v43, v43, v45
    v_bfe_u32 v46, v42, 16, 1
    v_add3_u32 v46, v42, v46, s90
    v_and_b32 v42, 0xffff0000, v46
    v_bfe_u32 v47, v43, 16, 1
    v_add3_u32 v47, v43, v47, s90
    v_and_b32 v43, 0xffff0000, v47
    v_lshlrev_b32 v44, 16, v90
    v_and_b32 v45, 0xffff0000, v90
    v_add_f32 v42, v42, v44
    v_add_f32 v43, v43, v45
    v_cvt_pk_bf16_f32 v50, v42, v43
    v_lshlrev_b32 v42, 16, v103
    v_and_b32 v43, 0xffff0000, v103
    v_lshlrev_b32 v44, 16, v22
    v_lshlrev_b32 v45, 16, v23
    v_add_f32 v42, v42, v44
    v_add_f32 v43, v43, v45
    v_bfe_u32 v46, v42, 16, 1
    v_add3_u32 v46, v42, v46, s90
    v_and_b32 v42, 0xffff0000, v46
    v_bfe_u32 v47, v43, 16, 1
    v_add3_u32 v47, v43, v47, s90
    v_and_b32 v43, 0xffff0000, v47
    v_lshlrev_b32 v44, 16, v91
    v_and_b32 v45, 0xffff0000, v91
    v_add_f32 v42, v42, v44
    v_add_f32 v43, v43, v45
    v_cvt_pk_bf16_f32 v51, v42, v43
    buffer_store_dwordx2 v[48:49], v4, s[48:51], s64 offen
    buffer_store_dwordx2 v[50:51], v4, s[48:51], s64 offen offset:16
    s_cmp_lg_u32 s78, 0
    s_cbranch_scc1 K3CL
    s_branch K3_END
K3R:
    s_waitcnt lgkmcnt(0)
    s_sub_u32 s3, s2, 576
    s_add_u32 s8, s4, 52576256
    s_addc_u32 s9, s5, 0
    s_and_b32 s9, s9, 0xffff
    s_mov_b32 s10, 37748736
    s_mov_b32 s11, 0x00020000
    v_lshrrev_b32 v1, 6, v0
    v_lshlrev_b32 v2, 14, v1
    v_and_b32 v3, 63, v0
    v_lshl_add_u32 v2, v3, 4, v2
    s_add_u32 s26, s3, 448
    s_lshr_b32 s22, s3, 4
    s_lshl_b32 s22, s22, 3
    s_and_b32 s23, s3, 7
    s_or_b32 s22, s22, s23
    s_and_b32 s23, s22, 1
    s_lshl_b32 s22, s22, 1
    s_sub_u32 s22, s22, s23
    s_lshr_b32 s23, s3, 2
    s_and_b32 s23, s23, 2
    s_add_u32 s62, s22, s23
    s_lshr_b32 s22, s26, 4
    s_lshl_b32 s22, s22, 3
    s_and_b32 s23, s26, 7
    s_or_b32 s22, s22, s23
    s_and_b32 s23, s22, 1
    s_lshl_b32 s22, s22, 1
    s_sub_u32 s22, s22, s23
    s_lshr_b32 s23, s26, 2
    s_and_b32 s23, s23, 2
    s_add_u32 s63, s22, s23
    s_lshl_b32 s21, s62, 16
    s_lshl_b32 s25, s63, 16
    s_add_u32 s20, s21, 0
    buffer_load_dwordx4 v[8:11], v2, s[8:11], s20 offen offset:0
    s_add_u32 s20, s21, 0
    buffer_load_dwordx4 v[12:15], v2, s[8:11], s20 offen offset:1024
    s_add_u32 s20, s21, 0
    buffer_load_dwordx4 v[16:19], v2, s[8:11], s20 offen offset:2048
    s_add_u32 s20, s21, 0
    buffer_load_dwordx4 v[20:23], v2, s[8:11], s20 offen offset:3072
    s_add_u32 s20, s21, 4096
    buffer_load_dwordx4 v[24:27], v2, s[8:11], s20 offen offset:0
    s_add_u32 s20, s21, 4096
    buffer_load_dwordx4 v[28:31], v2, s[8:11], s20 offen offset:1024
    s_add_u32 s20, s21, 4096
    buffer_load_dwordx4 v[32:35], v2, s[8:11], s20 offen offset:2048
    s_add_u32 s20, s21, 4096
    buffer_load_dwordx4 v[36:39], v2, s[8:11], s20 offen offset:3072
    s_add_u32 s20, s21, 8192
    buffer_load_dwordx4 v[40:43], v2, s[8:11], s20 offen offset:0
    s_add_u32 s20, s21, 8192
    buffer_load_dwordx4 v[44:47], v2, s[8:11], s20 offen offset:1024
    s_add_u32 s20, s21, 8192
    buffer_load_dwordx4 v[48:51], v2, s[8:11], s20 offen offset:2048
    s_add_u32 s20, s21, 8192
    buffer_load_dwordx4 v[52:55], v2, s[8:11], s20 offen offset:3072
    s_add_u32 s20, s21, 12288
    buffer_load_dwordx4 v[56:59], v2, s[8:11], s20 offen offset:0
    s_add_u32 s20, s21, 12288
    buffer_load_dwordx4 v[60:63], v2, s[8:11], s20 offen offset:1024
    s_add_u32 s20, s21, 12288
    buffer_load_dwordx4 v[64:67], v2, s[8:11], s20 offen offset:2048
    s_add_u32 s20, s21, 12288
    buffer_load_dwordx4 v[68:71], v2, s[8:11], s20 offen offset:3072
    s_add_u32 s52, s4, 153626624
    s_addc_u32 s53, s5, 0
    s_and_b32 s53, s53, 0xffff
    s_mov_b32 s54, 2372608
    s_mov_b32 s55, 0x00020000
    s_add_u32 s44, s80, 0
    s_addc_u32 s45, s81, 0
    s_and_b32 s45, s45, 0xffff
    s_mov_b32 s46, 2359296
    s_mov_b32 s47, 0x00020000
    s_add_u32 s48, s82, 0
    s_addc_u32 s49, s83, 0
    s_and_b32 s49, s49, 0xffff
    s_mov_b32 s50, 2359296
    s_mov_b32 s51, 0x00020000
    s_add_u32 s56, s4, 128073728
    s_addc_u32 s57, s5, 0
    s_and_b32 s57, s57, 0xffff
    s_mov_b32 s58, 2359296
    s_mov_b32 s59, 0x00020000
    v_and_b32 v4, 31, v0
    v_lshrrev_b32 v7, 6, v0
    v_mul_u32_u24 v7, 1280, v7
    v_lshl_add_u32 v97, v4, 1, v7
    v_mul_u32_u24 v4, 1152, v4
    v_bfe_u32 v5, v0, 5, 1
    v_lshl_add_u32 v4, v5, 3, v4
    v_mul_u32_u24 v5, 320, v5
    v_add_u32 v97, v97, v5
    v_bfe_u32 v5, v0, 2, 4
    v_and_b32 v96, 3, v0
    v_lshlrev_b32 v96, 4, v96
    v_lshl_add_u32 v6, v5, 12, v96
    v_mul_u32_u24 v5, 80, v5
    v_add3_u32 v96, v96, v5, v7
    v_mov_b32 v7, 0
    v_readfirstlane_b32 s77, v1
    s_lshr_b32 s74, s77, 1
    s_and_b32 s75, s77, 1
    s_mul_hi_u32 s27, s62, 0x71c71c8
    s_mul_i32 s23, s27, 36
    s_sub_u32 s23, s62, s23
    s_and_b32 s24, s23, 1
    s_lshl_b32 s24, s24, 1
    s_lshl_b32 s72, s27, 2
    s_add_u32 s72, s72, s24
    s_add_u32 s72, s72, s74
    s_and_b32 s73, s23, -2
    s_add_u32 s73, s73, s75
    s_mul_i32 s64, s72, 36864
    s_lshl_b32 s70, s73, 5
    s_add_u32 s64, s64, s70
    s_lshl_b32 s65, s73, 16
    s_lshl_b32 s70, s72, 6
    s_add_u32 s65, s65, s70
    s_lshl_b32 s66, s73, 8
    s_lshl_b32 s70, s72, 2
    s_add_u32 s66, s66, s70
    s_add_u32 s66, s66, 2363392
    s_mul_hi_u32 s27, s63, 0x71c71c8
    s_mul_i32 s23, s27, 36
    s_sub_u32 s23, s63, s23
    s_and_b32 s24, s23, 1
    s_lshl_b32 s24, s24, 1
    s_lshl_b32 s72, s27, 2
    s_add_u32 s72, s72, s24
    s_add_u32 s72, s72, s74
    s_and_b32 s73, s23, -2
    s_add_u32 s73, s73, s75
    s_mul_i32 s67, s72, 36864
    s_lshl_b32 s70, s73, 5
    s_add_u32 s67, s67, s70
    s_lshl_b32 s68, s73, 16
    s_lshl_b32 s70, s72, 6
    s_add_u32 s68, s68, s70
    s_lshl_b32 s69, s73, 8
    s_lshl_b32 s70, s72, 2
    s_add_u32 s69, s69, s70
    s_add_u32 s69, s69, 2363392
    s_cmp_lt_u32 s3, 128
    s_cbranch_scc1 K3R2
    buffer_load_dwordx2 v[100:101], v4, s[44:47], s64 offen
    buffer_load_dwordx2 v[102:103], v4, s[44:47], s64 offen offset:16
    s_waitcnt vmcnt(16)
    v_fma_mix_f32 v72, v8, 1.0, v12 op_sel:[0,0,0] op_sel_hi:[1,0,1]
    v_fma_mix_f32 v73, v8, 1.0, v12 op_sel:[1,0,1] op_sel_hi:[1,0,1]
    v_fma_mix_f32 v74, v9, 1.0, v13 op_sel:[0,0,0] op_sel_hi:[1,0,1]
    v_fma_mix_f32 v75, v9, 1.0, v13 op_sel:[1,0,1] op_sel_hi:[1,0,1]
    v_fma_mix_f32 v76, v10, 1.0, v14 op_sel:[0,0,0] op_sel_hi:[1,0,1]
    v_fma_mix_f32 v77, v10, 1.0, v14 op_sel:[1,0,1] op_sel_hi:[1,0,1]
    v_fma_mix_f32 v78, v11, 1.0, v15 op_sel:[0,0,0] op_sel_hi:[1,0,1]
    v_fma_mix_f32 v79, v11, 1.0, v15 op_sel:[1,0,1] op_sel_hi:[1,0,1]
    s_waitcnt vmcnt(14)
    v_fma_mix_f32 v80, v16, 1.0, v20 op_sel:[0,0,0] op_sel_hi:[1,0,1]
    v_fma_mix_f32 v81, v16, 1.0, v20 op_sel:[1,0,1] op_sel_hi:[1,0,1]
    v_fma_mix_f32 v82, v17, 1.0, v21 op_sel:[0,0,0] op_sel_hi:[1,0,1]
    v_fma_mix_f32 v83, v17, 1.0, v21 op_sel:[1,0,1] op_sel_hi:[1,0,1]
    v_fma_mix_f32 v84, v18, 1.0, v22 op_sel:[0,0,0] op_sel_hi:[1,0,1]
    v_fma_mix_f32 v85, v18, 1.0, v22 op_sel:[1,0,1] op_sel_hi:[1,0,1]
    v_fma_mix_f32 v86, v19, 1.0, v23 op_sel:[0,0,0] op_sel_hi:[1,0,1]
    v_fma_mix_f32 v87, v19, 1.0, v23 op_sel:[1,0,1] op_sel_hi:[1,0,1]
    s_waitcnt vmcnt(12)
    v_fma_mix_f32 v72, v24, 1.0, v72 op_sel:[0,0,0] op_sel_hi:[1,0,0]
    v_fma_mix_f32 v73, v24, 1.0, v73 op_sel:[1,0,0] op_sel_hi:[1,0,0]
    v_fma_mix_f32 v74, v25, 1.0, v74 op_sel:[0,0,0] op_sel_hi:[1,0,0]
    v_fma_mix_f32 v75, v25, 1.0, v75 op_sel:[1,0,0] op_sel_hi:[1,0,0]
    v_fma_mix_f32 v76, v26, 1.0, v76 op_sel:[0,0,0] op_sel_hi:[1,0,0]
    v_fma_mix_f32 v77, v26, 1.0, v77 op_sel:[1,0,0] op_sel_hi:[1,0,0]
    v_fma_mix_f32 v78, v27, 1.0, v78 op_sel:[0,0,0] op_sel_hi:[1,0,0]
    v_fma_mix_f32 v79, v27, 1.0, v79 op_sel:[1,0,0] op_sel_hi:[1,0,0]
    v_fma_mix_f32 v72, v28, 1.0, v72 op_sel:[0,0,0] op_sel_hi:[1,0,0]
    v_fma_mix_f32 v73, v28, 1.0, v73 op_sel:[1,0,0] op_sel_hi:[1,0,0]
    v_fma_mix_f32 v74, v29, 1.0, v74 op_sel:[0,0,0] op_sel_hi:[1,0,0]
    v_fma_mix_f32 v75, v29, 1.0, v75 op_sel:[1,0,0] op_sel_hi:[1,0,0]
    v_fma_mix_f32 v76, v30, 1.0, v76 op_sel:[0,0,0] op_sel_hi:[1,0,0]
    v_fma_mix_f32 v77, v30, 1.0, v77 op_sel:[1,0,0] op_sel_hi:[1,0,0]
    v_fma_mix_f32 v78, v31, 1.0, v78 op_sel:[0,0,0] op_sel_hi:[1,0,0]
    v_fma_mix_f32 v79, v31, 1.0, v79 op_sel:[1,0,0] op_sel_hi:[1,0,0]
    s_waitcnt vmcnt(10)
    v_fma_mix_f32 v80, v32, 1.0, v80 op_sel:[0,0,0] op_sel_hi:[1,0,0]
    v_fma_mix_f32 v81, v32, 1.0, v81 op_sel:[1,0,0] op_sel_hi:[1,0,0]
    v_fma_mix_f32 v82, v33, 1.0, v82 op_sel:[0,0,0] op_sel_hi:[1,0,0]
    v_fma_mix_f32 v83, v33, 1.0, v83 op_sel:[1,0,0] op_sel_hi:[1,0,0]
    v_fma_mix_f32 v84, v34, 1.0, v84 op_sel:[0,0,0] op_sel_hi:[1,0,0]
    v_fma_mix_f32 v85, v34, 1.0, v85 op_sel:[1,0,0] op_sel_hi:[1,0,0]
    v_fma_mix_f32 v86, v35, 1.0, v86 op_sel:[0,0,0] op_sel_hi:[1,0,0]
    v_fma_mix_f32 v87, v35, 1.0, v87 op_sel:[1,0,0] op_sel_hi:[1,0,0]
    v_fma_mix_f32 v80, v36, 1.0, v80 op_sel:[0,0,0] op_sel_hi:[1,0,0]
    v_fma_mix_f32 v81, v36, 1.0, v81 op_sel:[1,0,0] op_sel_hi:[1,0,0]
    v_fma_mix_f32 v82, v37, 1.0, v82 op_sel:[0,0,0] op_sel_hi:[1,0,0]
    v_fma_mix_f32 v83, v37, 1.0, v83 op_sel:[1,0,0] op_sel_hi:[1,0,0]
    v_fma_mix_f32 v84, v38, 1.0, v84 op_sel:[0,0,0] op_sel_hi:[1,0,0]
    v_fma_mix_f32 v85, v38, 1.0, v85 op_sel:[1,0,0] op_sel_hi:[1,0,0]
    v_fma_mix_f32 v86, v39, 1.0, v86 op_sel:[0,0,0] op_sel_hi:[1,0,0]
    v_fma_mix_f32 v87, v39, 1.0, v87 op_sel:[1,0,0] op_sel_hi:[1,0,0]
    s_waitcnt vmcnt(8)
    v_fma_mix_f32 v72, v40, 1.0, v72 op_sel:[0,0,0] op_sel_hi:[1,0,0]
    v_fma_mix_f32 v73, v40, 1.0, v73 op_sel:[1,0,0] op_sel_hi:[1,0,0]
    v_fma_mix_f32 v74, v41, 1.0, v74 op_sel:[0,0,0] op_sel_hi:[1,0,0]
    v_fma_mix_f32 v75, v41, 1.0, v75 op_sel:[1,0,0] op_sel_hi:[1,0,0]
    v_fma_mix_f32 v76, v42, 1.0, v76 op_sel:[0,0,0] op_sel_hi:[1,0,0]
    v_fma_mix_f32 v77, v42, 1.0, v77 op_sel:[1,0,0] op_sel_hi:[1,0,0]
    v_fma_mix_f32 v78, v43, 1.0, v78 op_sel:[0,0,0] op_sel_hi:[1,0,0]
    v_fma_mix_f32 v79, v43, 1.0, v79 op_sel:[1,0,0] op_sel_hi:[1,0,0]
    v_fma_mix_f32 v72, v44, 1.0, v72 op_sel:[0,0,0] op_sel_hi:[1,0,0]
    v_fma_mix_f32 v73, v44, 1.0, v73 op_sel:[1,0,0] op_sel_hi:[1,0,0]
    v_fma_mix_f32 v74, v45, 1.0, v74 op_sel:[0,0,0] op_sel_hi:[1,0,0]
    v_fma_mix_f32 v75, v45, 1.0, v75 op_sel:[1,0,0] op_sel_hi:[1,0,0]
    v_fma_mix_f32 v76, v46, 1.0, v76 op_sel:[0,0,0] op_sel_hi:[1,0,0]
    v_fma_mix_f32 v77, v46, 1.0, v77 op_sel:[1,0,0] op_sel_hi:[1,0,0]
    v_fma_mix_f32 v78, v47, 1.0, v78 op_sel:[0,0,0] op_sel_hi:[1,0,0]
    v_fma_mix_f32 v79, v47, 1.0, v79 op_sel:[1,0,0] op_sel_hi:[1,0,0]
    s_waitcnt vmcnt(6)
    v_fma_mix_f32 v80, v48, 1.0, v80 op_sel:[0,0,0] op_sel_hi:[1,0,0]
    v_fma_mix_f32 v81, v48, 1.0, v81 op_sel:[1,0,0] op_sel_hi:[1,0,0]
    v_fma_mix_f32 v82, v49, 1.0, v82 op_sel:[0,0,0] op_sel_hi:[1,0,0]
    v_fma_mix_f32 v83, v49, 1.0, v83 op_sel:[1,0,0] op_sel_hi:[1,0,0]
    v_fma_mix_f32 v84, v50, 1.0, v84 op_sel:[0,0,0] op_sel_hi:[1,0,0]
    v_fma_mix_f32 v85, v50, 1.0, v85 op_sel:[1,0,0] op_sel_hi:[1,0,0]
    v_fma_mix_f32 v86, v51, 1.0, v86 op_sel:[0,0,0] op_sel_hi:[1,0,0]
    v_fma_mix_f32 v87, v51, 1.0, v87 op_sel:[1,0,0] op_sel_hi:[1,0,0]
    v_fma_mix_f32 v80, v52, 1.0, v80 op_sel:[0,0,0] op_sel_hi:[1,0,0]
    v_fma_mix_f32 v81, v52, 1.0, v81 op_sel:[1,0,0] op_sel_hi:[1,0,0]
    v_fma_mix_f32 v82, v53, 1.0, v82 op_sel:[0,0,0] op_sel_hi:[1,0,0]
    v_fma_mix_f32 v83, v53, 1.0, v83 op_sel:[1,0,0] op_sel_hi:[1,0,0]
    v_fma_mix_f32 v84, v54, 1.0, v84 op_sel:[0,0,0] op_sel_hi:[1,0,0]
    v_fma_mix_f32 v85, v54, 1.0, v85 op_sel:[1,0,0] op_sel_hi:[1,0,0]
    v_fma_mix_f32 v86, v55, 1.0, v86 op_sel:[0,0,0] op_sel_hi:[1,0,0]
    v_fma_mix_f32 v87, v55, 1.0, v87 op_sel:[1,0,0] op_sel_hi:[1,0,0]
    s_waitcnt vmcnt(4)
    v_fma_mix_f32 v72, v56, 1.0, v72 op_sel:[0,0,0] op_sel_hi:[1,0,0]
    v_fma_mix_f32 v73, v56, 1.0, v73 op_sel:[1,0,0] op_sel_hi:[1,0,0]
    v_fma_mix_f32 v74, v57, 1.0, v74 op_sel:[0,0,0] op_sel_hi:[1,0,0]
    v_fma_mix_f32 v75, v57, 1.0, v75 op_sel:[1,0,0] op_sel_hi:[1,0,0]
    v_fma_mix_f32 v76, v58, 1.0, v76 op_sel:[0,0,0] op_sel_hi:[1,0,0]
    v_fma_mix_f32 v77, v58, 1.0, v77 op_sel:[1,0,0] op_sel_hi:[1,0,0]
    v_fma_mix_f32 v78, v59, 1.0, v78 op_sel:[0,0,0] op_sel_hi:[1,0,0]
    v_fma_mix_f32 v79, v59, 1.0, v79 op_sel:[1,0,0] op_sel_hi:[1,0,0]
    v_fma_mix_f32 v72, v60, 1.0, v72 op_sel:[0,0,0] op_sel_hi:[1,0,0]
    v_fma_mix_f32 v73, v60, 1.0, v73 op_sel:[1,0,0] op_sel_hi:[1,0,0]
    v_fma_mix_f32 v74, v61, 1.0, v74 op_sel:[0,0,0] op_sel_hi:[1,0,0]
    v_fma_mix_f32 v75, v61, 1.0, v75 op_sel:[1,0,0] op_sel_hi:[1,0,0]
    v_fma_mix_f32 v76, v62, 1.0, v76 op_sel:[0,0,0] op_sel_hi:[1,0,0]
    v_fma_mix_f32 v77, v62, 1.0, v77 op_sel:[1,0,0] op_sel_hi:[1,0,0]
    v_fma_mix_f32 v78, v63, 1.0, v78 op_sel:[0,0,0] op_sel_hi:[1,0,0]
    v_fma_mix_f32 v79, v63, 1.0, v79 op_sel:[1,0,0] op_sel_hi:[1,0,0]
    s_waitcnt vmcnt(2)
    v_fma_mix_f32 v80, v64, 1.0, v80 op_sel:[0,0,0] op_sel_hi:[1,0,0]
    v_fma_mix_f32 v81, v64, 1.0, v81 op_sel:[1,0,0] op_sel_hi:[1,0,0]
    v_fma_mix_f32 v82, v65, 1.0, v82 op_sel:[0,0,0] op_sel_hi:[1,0,0]
    v_fma_mix_f32 v83, v65, 1.0, v83 op_sel:[1,0,0] op_sel_hi:[1,0,0]
    v_fma_mix_f32 v84, v66, 1.0, v84 op_sel:[0,0,0] op_sel_hi:[1,0,0]
    v_fma_mix_f32 v85, v66, 1.0, v85 op_sel:[1,0,0] op_sel_hi:[1,0,0]
    v_fma_mix_f32 v86, v67, 1.0, v86 op_sel:[0,0,0] op_sel_hi:[1,0,0]
    v_fma_mix_f32 v87, v67, 1.0, v87 op_sel:[1,0,0] op_sel_hi:[1,0,0]
    v_fma_mix_f32 v80, v68, 1.0, v80 op_sel:[0,0,0] op_sel_hi:[1,0,0]
    v_fma_mix_f32 v81, v68, 1.0, v81 op_sel:[1,0,0] op_sel_hi:[1,0,0]
    v_fma_mix_f32 v82, v69, 1.0, v82 op_sel:[0,0,0] op_sel_hi:[1,0,0]
    v_fma_mix_f32 v83, v69, 1.0, v83 op_sel:[1,0,0] op_sel_hi:[1,0,0]
    v_fma_mix_f32 v84, v70, 1.0, v84 op_sel:[0,0,0] op_sel_hi:[1,0,0]
    v_fma_mix_f32 v85, v70, 1.0, v85 op_sel:[1,0,0] op_sel_hi:[1,0,0]
    v_fma_mix_f32 v86, v71, 1.0, v86 op_sel:[0,0,0] op_sel_hi:[1,0,0]
    v_fma_mix_f32 v87, v71, 1.0, v87 op_sel:[1,0,0] op_sel_hi:[1,0,0]
    buffer_load_dwordx4 v[108:111], v6, s[52:55], s65 offen sc0 sc1
    v_add_f32 v72, v72, v80
    v_add_f32 v73, v73, v81
    v_add_f32 v74, v74, v82
    v_add_f32 v75, v75, v83
    v_add_f32 v76, v76, v84
    v_add_f32 v77, v77, v85
    v_add_f32 v78, v78, v86
    v_add_f32 v79, v79, v87
    v_cvt_pk_bf16_f32 v88, v72, v73
    v_cvt_pk_bf16_f32 v89, v74, v75
    v_cvt_pk_bf16_f32 v90, v76, v77
    v_cvt_pk_bf16_f32 v91, v78, v79
    s_mov_b32 s76, 0
K3P1:
    s_waitcnt vmcnt(0)
    v_pk_max_u16 v40, v108, v109
    v_pk_max_u16 v40, v40, v110
    v_pk_max_u16 v40, v40, v111
    v_lshrrev_b32 v41, 16, v40
    v_and_b32 v40, 0xffff, v40
    v_max_u32 v40, v40, v41
    v_cmp_eq_u32 vcc, 0xffff, v40
    s_cbranch_vccz K3G1
    s_add_u32 s76, s76, 1
    s_cmp_ge_u32 s76, 200
    s_cbranch_scc1 K3S1
    s_sleep 20
    buffer_load_dwordx4 v[108:111], v6, s[52:55], s65 offen sc0 sc1
    s_branch K3P1
K3G1:
    ds_write_b128 v96, v[108:111] offset:0
    s_waitcnt lgkmcnt(0)
    ds_read_u16 v16, v97 offset:0
    ds_read_u16 v17, v97 offset:80
    ds_read_u16 v18, v97 offset:160
    ds_read_u16 v19, v97 offset:240
    ds_read_u16 v20, v97 offset:640
    ds_read_u16 v21, v97 offset:720
    ds_read_u16 v22, v97 offset:800
    ds_read_u16 v23, v97 offset:880
    s_waitcnt lgkmcnt(0)
    v_lshlrev_b32 v42, 16, v100
    v_and_b32 v43, 0xffff0000, v100
    v_lshlrev_b32 v44, 16, v16
    v_lshlrev_b32 v45, 16, v17
    v_add_f32 v42, v42, v44
    v_add_f32 v43, v43, v45
    v_bfe_u32 v46, v42, 16, 1
    v_add3_u32 v46, v42, v46, s90
    v_and_b32 v42, 0xffff0000, v46
    v_bfe_u32 v47, v43, 16, 1
    v_add3_u32 v47, v43, v47, s90
    v_and_b32 v43, 0xffff0000, v47
    v_lshlrev_b32 v44, 16, v88
    v_and_b32 v45, 0xffff0000, v88
    v_add_f32 v42, v42, v44
    v_add_f32 v43, v43, v45
    v_cvt_pk_bf16_f32 v48, v42, v43
    v_lshlrev_b32 v42, 16, v101
    v_and_b32 v43, 0xffff0000, v101
    v_lshlrev_b32 v44, 16, v18
    v_lshlrev_b32 v45, 16, v19
    v_add_f32 v42, v42, v44
    v_add_f32 v43, v43, v45
    v_bfe_u32 v46, v42, 16, 1
    v_add3_u32 v46, v42, v46, s90
    v_and_b32 v42, 0xffff0000, v46
    v_bfe_u32 v47, v43, 16, 1
    v_add3_u32 v47, v43, v47, s90
    v_and_b32 v43, 0xffff0000, v47
    v_lshlrev_b32 v44, 16, v89
    v_and_b32 v45, 0xffff0000, v89
    v_add_f32 v42, v42, v44
    v_add_f32 v43, v43, v45
    v_cvt_pk_bf16_f32 v49, v42, v43
    v_lshlrev_b32 v42, 16, v102
    v_and_b32 v43, 0xffff0000, v102
    v_lshlrev_b32 v44, 16, v20
    v_lshlrev_b32 v45, 16, v21
    v_add_f32 v42, v42, v44
    v_add_f32 v43, v43, v45
    v_bfe_u32 v46, v42, 16, 1
    v_add3_u32 v46, v42, v46, s90
    v_and_b32 v42, 0xffff0000, v46
    v_bfe_u32 v47, v43, 16, 1
    v_add3_u32 v47, v43, v47, s90
    v_and_b32 v43, 0xffff0000, v47
    v_lshlrev_b32 v44, 16, v90
    v_and_b32 v45, 0xffff0000, v90
    v_add_f32 v42, v42, v44
    v_add_f32 v43, v43, v45
    v_cvt_pk_bf16_f32 v50, v42, v43
    v_lshlrev_b32 v42, 16, v103
    v_and_b32 v43, 0xffff0000, v103
    v_lshlrev_b32 v44, 16, v22
    v_lshlrev_b32 v45, 16, v23
    v_add_f32 v42, v42, v44
    v_add_f32 v43, v43, v45
    v_bfe_u32 v46, v42, 16, 1
    v_add3_u32 v46, v42, v46, s90
    v_and_b32 v42, 0xffff0000, v46
    v_bfe_u32 v47, v43, 16, 1
    v_add3_u32 v47, v43, v47, s90
    v_and_b32 v43, 0xffff0000, v47
    v_lshlrev_b32 v44, 16, v91
    v_and_b32 v45, 0xffff0000, v91
    v_add_f32 v42, v42, v44
    v_add_f32 v43, v43, v45
    v_cvt_pk_bf16_f32 v51, v42, v43
    buffer_store_dwordx2 v[48:49], v4, s[48:51], s64 offen
    buffer_store_dwordx2 v[50:51], v4, s[48:51], s64 offen offset:16
    s_branch K3_END
K3S1:
    buffer_store_dwordx2 v[88:89], v4, s[56:59], s64 offen sc0 sc1
    buffer_store_dwordx2 v[90:91], v4, s[56:59], s64 offen offset:16 sc0 sc1
    v_mov_b32 v41, 0x100
    s_waitcnt vmcnt(0)
    s_mov_b64 exec, 1
    buffer_atomic_add v41, v7, s[52:55], s66 offen sc0 sc1
    s_waitcnt vmcnt(0)
    s_mov_b64 exec, -1
    v_readfirstlane_b32 s70, v41
    s_cmp_lg_u32 s70, 16
    s_cbranch_scc1 K3K10
    s_mov_b32 s79, 0
K3SP10:
    buffer_load_dwordx4 v[108:111], v6, s[52:55], s65 offen sc0 sc1
    s_waitcnt vmcnt(0)
    v_pk_max_u16 v40, v108, v109
    v_pk_max_u16 v40, v40, v110
    v_pk_max_u16 v40, v40, v111
    v_lshrrev_b32 v41, 16, v40
    v_and_b32 v40, 0xffff, v40
    v_max_u32 v40, v40, v41
    v_cmp_eq_u32 vcc, 0xffff, v40
    s_cbranch_vccz K3SG10
    s_sleep 20
    s_add_u32 s79, s79, 1
    s_cmp_lt_u32 s79, 400000
    s_cbranch_scc1 K3SP10
K3SG10:
    ds_write_b128 v96, v[108:111] offset:0
    s_waitcnt lgkmcnt(0)
    ds_read_u16 v16, v97 offset:0
    ds_read_u16 v17, v97 offset:80
    ds_read_u16 v18, v97 offset:160
    ds_read_u16 v19, v97 offset:240
    ds_read_u16 v20, v97 offset:640
    ds_read_u16 v21, v97 offset:720
    ds_read_u16 v22, v97 offset:800
    ds_read_u16 v23, v97 offset:880
    s_waitcnt lgkmcnt(0)
    v_lshlrev_b32 v42, 16, v100
    v_and_b32 v43, 0xffff0000, v100
    v_lshlrev_b32 v44, 16, v16
    v_lshlrev_b32 v45, 16, v17
    v_add_f32 v42, v42, v44
    v_add_f32 v43, v43, v45
    v_bfe_u32 v46, v42, 16, 1
    v_add3_u32 v46, v42, v46, s90
    v_and_b32 v42, 0xffff0000, v46
    v_bfe_u32 v47, v43, 16, 1
    v_add3_u32 v47, v43, v47, s90
    v_and_b32 v43, 0xffff0000, v47
    v_lshlrev_b32 v44, 16, v88
    v_and_b32 v45, 0xffff0000, v88
    v_add_f32 v42, v42, v44
    v_add_f32 v43, v43, v45
    v_cvt_pk_bf16_f32 v48, v42, v43
    v_lshlrev_b32 v42, 16, v101
    v_and_b32 v43, 0xffff0000, v101
    v_lshlrev_b32 v44, 16, v18
    v_lshlrev_b32 v45, 16, v19
    v_add_f32 v42, v42, v44
    v_add_f32 v43, v43, v45
    v_bfe_u32 v46, v42, 16, 1
    v_add3_u32 v46, v42, v46, s90
    v_and_b32 v42, 0xffff0000, v46
    v_bfe_u32 v47, v43, 16, 1
    v_add3_u32 v47, v43, v47, s90
    v_and_b32 v43, 0xffff0000, v47
    v_lshlrev_b32 v44, 16, v89
    v_and_b32 v45, 0xffff0000, v89
    v_add_f32 v42, v42, v44
    v_add_f32 v43, v43, v45
    v_cvt_pk_bf16_f32 v49, v42, v43
    v_lshlrev_b32 v42, 16, v102
    v_and_b32 v43, 0xffff0000, v102
    v_lshlrev_b32 v44, 16, v20
    v_lshlrev_b32 v45, 16, v21
    v_add_f32 v42, v42, v44
    v_add_f32 v43, v43, v45
    v_bfe_u32 v46, v42, 16, 1
    v_add3_u32 v46, v42, v46, s90
    v_and_b32 v42, 0xffff0000, v46
    v_bfe_u32 v47, v43, 16, 1
    v_add3_u32 v47, v43, v47, s90
    v_and_b32 v43, 0xffff0000, v47
    v_lshlrev_b32 v44, 16, v90
    v_and_b32 v45, 0xffff0000, v90
    v_add_f32 v42, v42, v44
    v_add_f32 v43, v43, v45
    v_cvt_pk_bf16_f32 v50, v42, v43
    v_lshlrev_b32 v42, 16, v103
    v_and_b32 v43, 0xffff0000, v103
    v_lshlrev_b32 v44, 16, v22
    v_lshlrev_b32 v45, 16, v23
    v_add_f32 v42, v42, v44
    v_add_f32 v43, v43, v45
    v_bfe_u32 v46, v42, 16, 1
    v_add3_u32 v46, v42, v46, s90
    v_and_b32 v42, 0xffff0000, v46
    v_bfe_u32 v47, v43, 16, 1
    v_add3_u32 v47, v43, v47, s90
    v_and_b32 v43, 0xffff0000, v47
    v_lshlrev_b32 v44, 16, v91
    v_and_b32 v45, 0xffff0000, v91
    v_add_f32 v42, v42, v44
    v_add_f32 v43, v43, v45
    v_cvt_pk_bf16_f32 v51, v42, v43
    buffer_store_dwordx2 v[48:49], v4, s[48:51], s64 offen
    buffer_store_dwordx2 v[50:51], v4, s[48:51], s64 offen offset:16
K3K10:
    s_branch K3_END
K3R2:
    buffer_load_dwordx2 v[100:101], v4, s[44:47], s64 offen
    buffer_load_dwordx2 v[102:103], v4, s[44:47], s64 offen offset:16
    buffer_load_dwordx2 v[104:105], v4, s[44:47], s67 offen
    buffer_load_dwordx2 v[106:107], v4, s[44:47], s67 offen offset:16
    s_waitcnt vmcnt(18)
    v_fma_mix_f32 v72, v8, 1.0, v12 op_sel:[0,0,0] op_sel_hi:[1,0,1]
    v_fma_mix_f32 v73, v8, 1.0, v12 op_sel:[1,0,1] op_sel_hi:[1,0,1]
    v_fma_mix_f32 v74, v9, 1.0, v13 op_sel:[0,0,0] op_sel_hi:[1,0,1]
    v_fma_mix_f32 v75, v9, 1.0, v13 op_sel:[1,0,1] op_sel_hi:[1,0,1]
    v_fma_mix_f32 v76, v10, 1.0, v14 op_sel:[0,0,0] op_sel_hi:[1,0,1]
    v_fma_mix_f32 v77, v10, 1.0, v14 op_sel:[1,0,1] op_sel_hi:[1,0,1]
    v_fma_mix_f32 v78, v11, 1.0, v15 op_sel:[0,0,0] op_sel_hi:[1,0,1]
    v_fma_mix_f32 v79, v11, 1.0, v15 op_sel:[1,0,1] op_sel_hi:[1,0,1]
    s_add_u32 s20, s25, 0
    buffer_load_dwordx4 v[8:11], v2, s[8:11], s20 offen offset:0
    s_add_u32 s20, s25, 0
    buffer_load_dwordx4 v[12:15], v2, s[8:11], s20 offen offset:1024
    s_waitcnt vmcnt(18)
    v_fma_mix_f32 v80, v16, 1.0, v20 op_sel:[0,0,0] op_sel_hi:[1,0,1]
    v_fma_mix_f32 v81, v16, 1.0, v20 op_sel:[1,0,1] op_sel_hi:[1,0,1]
    v_fma_mix_f32 v82, v17, 1.0, v21 op_sel:[0,0,0] op_sel_hi:[1,0,1]
    v_fma_mix_f32 v83, v17, 1.0, v21 op_sel:[1,0,1] op_sel_hi:[1,0,1]
    v_fma_mix_f32 v84, v18, 1.0, v22 op_sel:[0,0,0] op_sel_hi:[1,0,1]
    v_fma_mix_f32 v85, v18, 1.0, v22 op_sel:[1,0,1] op_sel_hi:[1,0,1]
    v_fma_mix_f32 v86, v19, 1.0, v23 op_sel:[0,0,0] op_sel_hi:[1,0,1]
    v_fma_mix_f32 v87, v19, 1.0, v23 op_sel:[1,0,1] op_sel_hi:[1,0,1]
    s_add_u32 s20, s25, 0
    buffer_load_dwordx4 v[16:19], v2, s[8:11], s20 offen offset:2048
    s_add_u32 s20, s25, 0
    buffer_load_dwordx4 v[20:23], v2, s[8:11], s20 offen offset:3072
    s_waitcnt vmcnt(18)
    v_fma_mix_f32 v72, v24, 1.0, v72 op_sel:[0,0,0] op_sel_hi:[1,0,0]
    v_fma_mix_f32 v73, v24, 1.0, v73 op_sel:[1,0,0] op_sel_hi:[1,0,0]
    v_fma_mix_f32 v74, v25, 1.0, v74 op_sel:[0,0,0] op_sel_hi:[1,0,0]
    v_fma_mix_f32 v75, v25, 1.0, v75 op_sel:[1,0,0] op_sel_hi:[1,0,0]
    v_fma_mix_f32 v76, v26, 1.0, v76 op_sel:[0,0,0] op_sel_hi:[1,0,0]
    v_fma_mix_f32 v77, v26, 1.0, v77 op_sel:[1,0,0] op_sel_hi:[1,0,0]
    v_fma_mix_f32 v78, v27, 1.0, v78 op_sel:[0,0,0] op_sel_hi:[1,0,0]
    v_fma_mix_f32 v79, v27, 1.0, v79 op_sel:[1,0,0] op_sel_hi:[1,0,0]
    v_fma_mix_f32 v72, v28, 1.0, v72 op_sel:[0,0,0] op_sel_hi:[1,0,0]
    v_fma_mix_f32 v73, v28, 1.0, v73 op_sel:[1,0,0] op_sel_hi:[1,0,0]
    v_fma_mix_f32 v74, v29, 1.0, v74 op_sel:[0,0,0] op_sel_hi:[1,0,0]
    v_fma_mix_f32 v75, v29, 1.0, v75 op_sel:[1,0,0] op_sel_hi:[1,0,0]
    v_fma_mix_f32 v76, v30, 1.0, v76 op_sel:[0,0,0] op_sel_hi:[1,0,0]
    v_fma_mix_f32 v77, v30, 1.0, v77 op_sel:[1,0,0] op_sel_hi:[1,0,0]
    v_fma_mix_f32 v78, v31, 1.0, v78 op_sel:[0,0,0] op_sel_hi:[1,0,0]
    v_fma_mix_f32 v79, v31, 1.0, v79 op_sel:[1,0,0] op_sel_hi:[1,0,0]
    s_add_u32 s20, s25, 4096
    buffer_load_dwordx4 v[24:27], v2, s[8:11], s20 offen offset:0
    s_add_u32 s20, s25, 4096
    buffer_load_dwordx4 v[28:31], v2, s[8:11], s20 offen offset:1024
    s_waitcnt vmcnt(18)
    v_fma_mix_f32 v80, v32, 1.0, v80 op_sel:[0,0,0] op_sel_hi:[1,0,0]
    v_fma_mix_f32 v81, v32, 1.0, v81 op_sel:[1,0,0] op_sel_hi:[1,0,0]
    v_fma_mix_f32 v82, v33, 1.0, v82 op_sel:[0,0,0] op_sel_hi:[1,0,0]
    v_fma_mix_f32 v83, v33, 1.0, v83 op_sel:[1,0,0] op_sel_hi:[1,0,0]
    v_fma_mix_f32 v84, v34, 1.0, v84 op_sel:[0,0,0] op_sel_hi:[1,0,0]
    v_fma_mix_f32 v85, v34, 1.0, v85 op_sel:[1,0,0] op_sel_hi:[1,0,0]
    v_fma_mix_f32 v86, v35, 1.0, v86 op_sel:[0,0,0] op_sel_hi:[1,0,0]
    v_fma_mix_f32 v87, v35, 1.0, v87 op_sel:[1,0,0] op_sel_hi:[1,0,0]
    v_fma_mix_f32 v80, v36, 1.0, v80 op_sel:[0,0,0] op_sel_hi:[1,0,0]
    v_fma_mix_f32 v81, v36, 1.0, v81 op_sel:[1,0,0] op_sel_hi:[1,0,0]
    v_fma_mix_f32 v82, v37, 1.0, v82 op_sel:[0,0,0] op_sel_hi:[1,0,0]
    v_fma_mix_f32 v83, v37, 1.0, v83 op_sel:[1,0,0] op_sel_hi:[1,0,0]
    v_fma_mix_f32 v84, v38, 1.0, v84 op_sel:[0,0,0] op_sel_hi:[1,0,0]
    v_fma_mix_f32 v85, v38, 1.0, v85 op_sel:[1,0,0] op_sel_hi:[1,0,0]
    v_fma_mix_f32 v86, v39, 1.0, v86 op_sel:[0,0,0] op_sel_hi:[1,0,0]
    v_fma_mix_f32 v87, v39, 1.0, v87 op_sel:[1,0,0] op_sel_hi:[1,0,0]
    s_add_u32 s20, s25, 4096
    buffer_load_dwordx4 v[32:35], v2, s[8:11], s20 offen offset:2048
    s_add_u32 s20, s25, 4096
    buffer_load_dwordx4 v[36:39], v2, s[8:11], s20 offen offset:3072
    s_waitcnt vmcnt(18)
    v_fma_mix_f32 v72, v40, 1.0, v72 op_sel:[0,0,0] op_sel_hi:[1,0,0]
    v_fma_mix_f32 v73, v40, 1.0, v73 op_sel:[1,0,0] op_sel_hi:[1,0,0]
    v_fma_mix_f32 v74, v41, 1.0, v74 op_sel:[0,0,0] op_sel_hi:[1,0,0]
    v_fma_mix_f32 v75, v41, 1.0, v75 op_sel:[1,0,0] op_sel_hi:[1,0,0]
    v_fma_mix_f32 v76, v42, 1.0, v76 op_sel:[0,0,0] op_sel_hi:[1,0,0]
    v_fma_mix_f32 v77, v42, 1.0, v77 op_sel:[1,0,0] op_sel_hi:[1,0,0]
    v_fma_mix_f32 v78, v43, 1.0, v78 op_sel:[0,0,0] op_sel_hi:[1,0,0]
    v_fma_mix_f32 v79, v43, 1.0, v79 op_sel:[1,0,0] op_sel_hi:[1,0,0]
    v_fma_mix_f32 v72, v44, 1.0, v72 op_sel:[0,0,0] op_sel_hi:[1,0,0]
    v_fma_mix_f32 v73, v44, 1.0, v73 op_sel:[1,0,0] op_sel_hi:[1,0,0]
    v_fma_mix_f32 v74, v45, 1.0, v74 op_sel:[0,0,0] op_sel_hi:[1,0,0]
    v_fma_mix_f32 v75, v45, 1.0, v75 op_sel:[1,0,0] op_sel_hi:[1,0,0]
    v_fma_mix_f32 v76, v46, 1.0, v76 op_sel:[0,0,0] op_sel_hi:[1,0,0]
    v_fma_mix_f32 v77, v46, 1.0, v77 op_sel:[1,0,0] op_sel_hi:[1,0,0]
    v_fma_mix_f32 v78, v47, 1.0, v78 op_sel:[0,0,0] op_sel_hi:[1,0,0]
    v_fma_mix_f32 v79, v47, 1.0, v79 op_sel:[1,0,0] op_sel_hi:[1,0,0]
    s_add_u32 s20, s25, 8192
    buffer_load_dwordx4 v[40:43], v2, s[8:11], s20 offen offset:0
    s_add_u32 s20, s25, 8192
    buffer_load_dwordx4 v[44:47], v2, s[8:11], s20 offen offset:1024
    s_waitcnt vmcnt(18)
    v_fma_mix_f32 v80, v48, 1.0, v80 op_sel:[0,0,0] op_sel_hi:[1,0,0]
    v_fma_mix_f32 v81, v48, 1.0, v81 op_sel:[1,0,0] op_sel_hi:[1,0,0]
    v_fma_mix_f32 v82, v49, 1.0, v82 op_sel:[0,0,0] op_sel_hi:[1,0,0]
    v_fma_mix_f32 v83, v49, 1.0, v83 op_sel:[1,0,0] op_sel_hi:[1,0,0]
    v_fma_mix_f32 v84, v50, 1.0, v84 op_sel:[0,0,0] op_sel_hi:[1,0,0]
    v_fma_mix_f32 v85, v50, 1.0, v85 op_sel:[1,0,0] op_sel_hi:[1,0,0]
    v_fma_mix_f32 v86, v51, 1.0, v86 op_sel:[0,0,0] op_sel_hi:[1,0,0]
    v_fma_mix_f32 v87, v51, 1.0, v87 op_sel:[1,0,0] op_sel_hi:[1,0,0]
    v_fma_mix_f32 v80, v52, 1.0, v80 op_sel:[0,0,0] op_sel_hi:[1,0,0]
    v_fma_mix_f32 v81, v52, 1.0, v81 op_sel:[1,0,0] op_sel_hi:[1,0,0]
    v_fma_mix_f32 v82, v53, 1.0, v82 op_sel:[0,0,0] op_sel_hi:[1,0,0]
    v_fma_mix_f32 v83, v53, 1.0, v83 op_sel:[1,0,0] op_sel_hi:[1,0,0]
    v_fma_mix_f32 v84, v54, 1.0, v84 op_sel:[0,0,0] op_sel_hi:[1,0,0]
    v_fma_mix_f32 v85, v54, 1.0, v85 op_sel:[1,0,0] op_sel_hi:[1,0,0]
    v_fma_mix_f32 v86, v55, 1.0, v86 op_sel:[0,0,0] op_sel_hi:[1,0,0]
    v_fma_mix_f32 v87, v55, 1.0, v87 op_sel:[1,0,0] op_sel_hi:[1,0,0]
    s_add_u32 s20, s25, 8192
    buffer_load_dwordx4 v[48:51], v2, s[8:11], s20 offen offset:2048
    s_add_u32 s20, s25, 8192
    buffer_load_dwordx4 v[52:55], v2, s[8:11], s20 offen offset:3072
    s_waitcnt vmcnt(18)
    v_fma_mix_f32 v72, v56, 1.0, v72 op_sel:[0,0,0] op_sel_hi:[1,0,0]
    v_fma_mix_f32 v73, v56, 1.0, v73 op_sel:[1,0,0] op_sel_hi:[1,0,0]
    v_fma_mix_f32 v74, v57, 1.0, v74 op_sel:[0,0,0] op_sel_hi:[1,0,0]
    v_fma_mix_f32 v75, v57, 1.0, v75 op_sel:[1,0,0] op_sel_hi:[1,0,0]
    v_fma_mix_f32 v76, v58, 1.0, v76 op_sel:[0,0,0] op_sel_hi:[1,0,0]
    v_fma_mix_f32 v77, v58, 1.0, v77 op_sel:[1,0,0] op_sel_hi:[1,0,0]
    v_fma_mix_f32 v78, v59, 1.0, v78 op_sel:[0,0,0] op_sel_hi:[1,0,0]
    v_fma_mix_f32 v79, v59, 1.0, v79 op_sel:[1,0,0] op_sel_hi:[1,0,0]
    v_fma_mix_f32 v72, v60, 1.0, v72 op_sel:[0,0,0] op_sel_hi:[1,0,0]
    v_fma_mix_f32 v73, v60, 1.0, v73 op_sel:[1,0,0] op_sel_hi:[1,0,0]
    v_fma_mix_f32 v74, v61, 1.0, v74 op_sel:[0,0,0] op_sel_hi:[1,0,0]
    v_fma_mix_f32 v75, v61, 1.0, v75 op_sel:[1,0,0] op_sel_hi:[1,0,0]
    v_fma_mix_f32 v76, v62, 1.0, v76 op_sel:[0,0,0] op_sel_hi:[1,0,0]
    v_fma_mix_f32 v77, v62, 1.0, v77 op_sel:[1,0,0] op_sel_hi:[1,0,0]
    v_fma_mix_f32 v78, v63, 1.0, v78 op_sel:[0,0,0] op_sel_hi:[1,0,0]
    v_fma_mix_f32 v79, v63, 1.0, v79 op_sel:[1,0,0] op_sel_hi:[1,0,0]
    s_add_u32 s20, s25, 12288
    buffer_load_dwordx4 v[56:59], v2, s[8:11], s20 offen offset:0
    s_add_u32 s20, s25, 12288
    buffer_load_dwordx4 v[60:63], v2, s[8:11], s20 offen offset:1024
    s_waitcnt vmcnt(18)
    v_fma_mix_f32 v80, v64, 1.0, v80 op_sel:[0,0,0] op_sel_hi:[1,0,0]
    v_fma_mix_f32 v81, v64, 1.0, v81 op_sel:[1,0,0] op_sel_hi:[1,0,0]
    v_fma_mix_f32 v82, v65, 1.0, v82 op_sel:[0,0,0] op_sel_hi:[1,0,0]
    v_fma_mix_f32 v83, v65, 1.0, v83 op_sel:[1,0,0] op_sel_hi:[1,0,0]
    v_fma_mix_f32 v84, v66, 1.0, v84 op_sel:[0,0,0] op_sel_hi:[1,0,0]
    v_fma_mix_f32 v85, v66, 1.0, v85 op_sel:[1,0,0] op_sel_hi:[1,0,0]
    v_fma_mix_f32 v86, v67, 1.0, v86 op_sel:[0,0,0] op_sel_hi:[1,0,0]
    v_fma_mix_f32 v87, v67, 1.0, v87 op_sel:[1,0,0] op_sel_hi:[1,0,0]
    v_fma_mix_f32 v80, v68, 1.0, v80 op_sel:[0,0,0] op_sel_hi:[1,0,0]
    v_fma_mix_f32 v81, v68, 1.0, v81 op_sel:[1,0,0] op_sel_hi:[1,0,0]
    v_fma_mix_f32 v82, v69, 1.0, v82 op_sel:[0,0,0] op_sel_hi:[1,0,0]
    v_fma_mix_f32 v83, v69, 1.0, v83 op_sel:[1,0,0] op_sel_hi:[1,0,0]
    v_fma_mix_f32 v84, v70, 1.0, v84 op_sel:[0,0,0] op_sel_hi:[1,0,0]
    v_fma_mix_f32 v85, v70, 1.0, v85 op_sel:[1,0,0] op_sel_hi:[1,0,0]
    v_fma_mix_f32 v86, v71, 1.0, v86 op_sel:[0,0,0] op_sel_hi:[1,0,0]
    v_fma_mix_f32 v87, v71, 1.0, v87 op_sel:[1,0,0] op_sel_hi:[1,0,0]
    s_add_u32 s20, s25, 12288
    buffer_load_dwordx4 v[64:67], v2, s[8:11], s20 offen offset:2048
    s_add_u32 s20, s25, 12288
    buffer_load_dwordx4 v[68:71], v2, s[8:11], s20 offen offset:3072
    v_add_f32 v72, v72, v80
    v_add_f32 v73, v73, v81
    v_add_f32 v74, v74, v82
    v_add_f32 v75, v75, v83
    v_add_f32 v76, v76, v84
    v_add_f32 v77, v77, v85
    v_add_f32 v78, v78, v86
    v_add_f32 v79, v79, v87
    v_cvt_pk_bf16_f32 v88, v72, v73
    v_cvt_pk_bf16_f32 v89, v74, v75
    v_cvt_pk_bf16_f32 v90, v76, v77
    v_cvt_pk_bf16_f32 v91, v78, v79
    s_waitcnt vmcnt(14)
    v_fma_mix_f32 v72, v8, 1.0, v12 op_sel:[0,0,0] op_sel_hi:[1,0,1]
    v_fma_mix_f32 v73, v8, 1.0, v12 op_sel:[1,0,1] op_sel_hi:[1,0,1]
    v_fma_mix_f32 v74, v9, 1.0, v13 op_sel:[0,0,0] op_sel_hi:[1,0,1]
    v_fma_mix_f32 v75, v9, 1.0, v13 op_sel:[1,0,1] op_sel_hi:[1,0,1]
    v_fma_mix_f32 v76, v10, 1.0, v14 op_sel:[0,0,0] op_sel_hi:[1,0,1]
    v_fma_mix_f32 v77, v10, 1.0, v14 op_sel:[1,0,1] op_sel_hi:[1,0,1]
    v_fma_mix_f32 v78, v11, 1.0, v15 op_sel:[0,0,0] op_sel_hi:[1,0,1]
    v_fma_mix_f32 v79, v11, 1.0, v15 op_sel:[1,0,1] op_sel_hi:[1,0,1]
    s_waitcnt vmcnt(12)
    v_fma_mix_f32 v80, v16, 1.0, v20 op_sel:[0,0,0] op_sel_hi:[1,0,1]
    v_fma_mix_f32 v81, v16, 1.0, v20 op_sel:[1,0,1] op_sel_hi:[1,0,1]
    v_fma_mix_f32 v82, v17, 1.0, v21 op_sel:[0,0,0] op_sel_hi:[1,0,1]
    v_fma_mix_f32 v83, v17, 1.0, v21 op_sel:[1,0,1] op_sel_hi:[1,0,1]
    v_fma_mix_f32 v84, v18, 1.0, v22 op_sel:[0,0,0] op_sel_hi:[1,0,1]
    v_fma_mix_f32 v85, v18, 1.0, v22 op_sel:[1,0,1] op_sel_hi:[1,0,1]
    v_fma_mix_f32 v86, v19, 1.0, v23 op_sel:[0,0,0] op_sel_hi:[1,0,1]
    v_fma_mix_f32 v87, v19, 1.0, v23 op_sel:[1,0,1] op_sel_hi:[1,0,1]
    s_waitcnt vmcnt(10)
    v_fma_mix_f32 v72, v24, 1.0, v72 op_sel:[0,0,0] op_sel_hi:[1,0,0]
    v_fma_mix_f32 v73, v24, 1.0, v73 op_sel:[1,0,0] op_sel_hi:[1,0,0]
    v_fma_mix_f32 v74, v25, 1.0, v74 op_sel:[0,0,0] op_sel_hi:[1,0,0]
    v_fma_mix_f32 v75, v25, 1.0, v75 op_sel:[1,0,0] op_sel_hi:[1,0,0]
    v_fma_mix_f32 v76, v26, 1.0, v76 op_sel:[0,0,0] op_sel_hi:[1,0,0]
    v_fma_mix_f32 v77, v26, 1.0, v77 op_sel:[1,0,0] op_sel_hi:[1,0,0]
    v_fma_mix_f32 v78, v27, 1.0, v78 op_sel:[0,0,0] op_sel_hi:[1,0,0]
    v_fma_mix_f32 v79, v27, 1.0, v79 op_sel:[1,0,0] op_sel_hi:[1,0,0]
    v_fma_mix_f32 v72, v28, 1.0, v72 op_sel:[0,0,0] op_sel_hi:[1,0,0]
    v_fma_mix_f32 v73, v28, 1.0, v73 op_sel:[1,0,0] op_sel_hi:[1,0,0]
    v_fma_mix_f32 v74, v29, 1.0, v74 op_sel:[0,0,0] op_sel_hi:[1,0,0]
    v_fma_mix_f32 v75, v29, 1.0, v75 op_sel:[1,0,0] op_sel_hi:[1,0,0]
    v_fma_mix_f32 v76, v30, 1.0, v76 op_sel:[0,0,0] op_sel_hi:[1,0,0]
    v_fma_mix_f32 v77, v30, 1.0, v77 op_sel:[1,0,0] op_sel_hi:[1,0,0]
    v_fma_mix_f32 v78, v31, 1.0, v78 op_sel:[0,0,0] op_sel_hi:[1,0,0]
    v_fma_mix_f32 v79, v31, 1.0, v79 op_sel:[1,0,0] op_sel_hi:[1,0,0]
    s_waitcnt vmcnt(8)
    v_fma_mix_f32 v80, v32, 1.0, v80 op_sel:[0,0,0] op_sel_hi:[1,0,0]
    v_fma_mix_f32 v81, v32, 1.0, v81 op_sel:[1,0,0] op_sel_hi:[1,0,0]
    v_fma_mix_f32 v82, v33, 1.0, v82 op_sel:[0,0,0] op_sel_hi:[1,0,0]
    v_fma_mix_f32 v83, v33, 1.0, v83 op_sel:[1,0,0] op_sel_hi:[1,0,0]
    v_fma_mix_f32 v84, v34, 1.0, v84 op_sel:[0,0,0] op_sel_hi:[1,0,0]
    v_fma_mix_f32 v85, v34, 1.0, v85 op_sel:[1,0,0] op_sel_hi:[1,0,0]
    v_fma_mix_f32 v86, v35, 1.0, v86 op_sel:[0,0,0] op_sel_hi:[1,0,0]
    v_fma_mix_f32 v87, v35, 1.0, v87 op_sel:[1,0,0] op_sel_hi:[1,0,0]
    v_fma_mix_f32 v80, v36, 1.0, v80 op_sel:[0,0,0] op_sel_hi:[1,0,0]
    v_fma_mix_f32 v81, v36, 1.0, v81 op_sel:[1,0,0] op_sel_hi:[1,0,0]
    v_fma_mix_f32 v82, v37, 1.0, v82 op_sel:[0,0,0] op_sel_hi:[1,0,0]
    v_fma_mix_f32 v83, v37, 1.0, v83 op_sel:[1,0,0] op_sel_hi:[1,0,0]
    v_fma_mix_f32 v84, v38, 1.0, v84 op_sel:[0,0,0] op_sel_hi:[1,0,0]
    v_fma_mix_f32 v85, v38, 1.0, v85 op_sel:[1,0,0] op_sel_hi:[1,0,0]
    v_fma_mix_f32 v86, v39, 1.0, v86 op_sel:[0,0,0] op_sel_hi:[1,0,0]
    v_fma_mix_f32 v87, v39, 1.0, v87 op_sel:[1,0,0] op_sel_hi:[1,0,0]
    s_waitcnt vmcnt(6)
    v_fma_mix_f32 v72, v40, 1.0, v72 op_sel:[0,0,0] op_sel_hi:[1,0,0]
    v_fma_mix_f32 v73, v40, 1.0, v73 op_sel:[1,0,0] op_sel_hi:[1,0,0]
    v_fma_mix_f32 v74, v41, 1.0, v74 op_sel:[0,0,0] op_sel_hi:[1,0,0]
    v_fma_mix_f32 v75, v41, 1.0, v75 op_sel:[1,0,0] op_sel_hi:[1,0,0]
    v_fma_mix_f32 v76, v42, 1.0, v76 op_sel:[0,0,0] op_sel_hi:[1,0,0]
    v_fma_mix_f32 v77, v42, 1.0, v77 op_sel:[1,0,0] op_sel_hi:[1,0,0]
    v_fma_mix_f32 v78, v43, 1.0, v78 op_sel:[0,0,0] op_sel_hi:[1,0,0]
    v_fma_mix_f32 v79, v43, 1.0, v79 op_sel:[1,0,0] op_sel_hi:[1,0,0]
    v_fma_mix_f32 v72, v44, 1.0, v72 op_sel:[0,0,0] op_sel_hi:[1,0,0]
    v_fma_mix_f32 v73, v44, 1.0, v73 op_sel:[1,0,0] op_sel_hi:[1,0,0]
    v_fma_mix_f32 v74, v45, 1.0, v74 op_sel:[0,0,0] op_sel_hi:[1,0,0]
    v_fma_mix_f32 v75, v45, 1.0, v75 op_sel:[1,0,0] op_sel_hi:[1,0,0]
    v_fma_mix_f32 v76, v46, 1.0, v76 op_sel:[0,0,0] op_sel_hi:[1,0,0]
    v_fma_mix_f32 v77, v46, 1.0, v77 op_sel:[1,0,0] op_sel_hi:[1,0,0]
    v_fma_mix_f32 v78, v47, 1.0, v78 op_sel:[0,0,0] op_sel_hi:[1,0,0]
    v_fma_mix_f32 v79, v47, 1.0, v79 op_sel:[1,0,0] op_sel_hi:[1,0,0]
    s_waitcnt vmcnt(4)
    v_fma_mix_f32 v80, v48, 1.0, v80 op_sel:[0,0,0] op_sel_hi:[1,0,0]
    v_fma_mix_f32 v81, v48, 1.0, v81 op_sel:[1,0,0] op_sel_hi:[1,0,0]
    v_fma_mix_f32 v82, v49, 1.0, v82 op_sel:[0,0,0] op_sel_hi:[1,0,0]
    v_fma_mix_f32 v83, v49, 1.0, v83 op_sel:[1,0,0] op_sel_hi:[1,0,0]
    v_fma_mix_f32 v84, v50, 1.0, v84 op_sel:[0,0,0] op_sel_hi:[1,0,0]
    v_fma_mix_f32 v85, v50, 1.0, v85 op_sel:[1,0,0] op_sel_hi:[1,0,0]
    v_fma_mix_f32 v86, v51, 1.0, v86 op_sel:[0,0,0] op_sel_hi:[1,0,0]
    v_fma_mix_f32 v87, v51, 1.0, v87 op_sel:[1,0,0] op_sel_hi:[1,0,0]
    v_fma_mix_f32 v80, v52, 1.0, v80 op_sel:[0,0,0] op_sel_hi:[1,0,0]
    v_fma_mix_f32 v81, v52, 1.0, v81 op_sel:[1,0,0] op_sel_hi:[1,0,0]
    v_fma_mix_f32 v82, v53, 1.0, v82 op_sel:[0,0,0] op_sel_hi:[1,0,0]
    v_fma_mix_f32 v83, v53, 1.0, v83 op_sel:[1,0,0] op_sel_hi:[1,0,0]
    v_fma_mix_f32 v84, v54, 1.0, v84 op_sel:[0,0,0] op_sel_hi:[1,0,0]
    v_fma_mix_f32 v85, v54, 1.0, v85 op_sel:[1,0,0] op_sel_hi:[1,0,0]
    v_fma_mix_f32 v86, v55, 1.0, v86 op_sel:[0,0,0] op_sel_hi:[1,0,0]
    v_fma_mix_f32 v87, v55, 1.0, v87 op_sel:[1,0,0] op_sel_hi:[1,0,0]
    s_waitcnt vmcnt(2)
    v_fma_mix_f32 v72, v56, 1.0, v72 op_sel:[0,0,0] op_sel_hi:[1,0,0]
    v_fma_mix_f32 v73, v56, 1.0, v73 op_sel:[1,0,0] op_sel_hi:[1,0,0]
    v_fma_mix_f32 v74, v57, 1.0, v74 op_sel:[0,0,0] op_sel_hi:[1,0,0]
    v_fma_mix_f32 v75, v57, 1.0, v75 op_sel:[1,0,0] op_sel_hi:[1,0,0]
    v_fma_mix_f32 v76, v58, 1.0, v76 op_sel:[0,0,0] op_sel_hi:[1,0,0]
    v_fma_mix_f32 v77, v58, 1.0, v77 op_sel:[1,0,0] op_sel_hi:[1,0,0]
    v_fma_mix_f32 v78, v59, 1.0, v78 op_sel:[0,0,0] op_sel_hi:[1,0,0]
    v_fma_mix_f32 v79, v59, 1.0, v79 op_sel:[1,0,0] op_sel_hi:[1,0,0]
    v_fma_mix_f32 v72, v60, 1.0, v72 op_sel:[0,0,0] op_sel_hi:[1,0,0]
    v_fma_mix_f32 v73, v60, 1.0, v73 op_sel:[1,0,0] op_sel_hi:[1,0,0]
    v_fma_mix_f32 v74, v61, 1.0, v74 op_sel:[0,0,0] op_sel_hi:[1,0,0]
    v_fma_mix_f32 v75, v61, 1.0, v75 op_sel:[1,0,0] op_sel_hi:[1,0,0]
    v_fma_mix_f32 v76, v62, 1.0, v76 op_sel:[0,0,0] op_sel_hi:[1,0,0]
    v_fma_mix_f32 v77, v62, 1.0, v77 op_sel:[1,0,0] op_sel_hi:[1,0,0]
    v_fma_mix_f32 v78, v63, 1.0, v78 op_sel:[0,0,0] op_sel_hi:[1,0,0]
    v_fma_mix_f32 v79, v63, 1.0, v79 op_sel:[1,0,0] op_sel_hi:[1,0,0]
    s_waitcnt vmcnt(0)
    v_fma_mix_f32 v80, v64, 1.0, v80 op_sel:[0,0,0] op_sel_hi:[1,0,0]
    v_fma_mix_f32 v81, v64, 1.0, v81 op_sel:[1,0,0] op_sel_hi:[1,0,0]
    v_fma_mix_f32 v82, v65, 1.0, v82 op_sel:[0,0,0] op_sel_hi:[1,0,0]
    v_fma_mix_f32 v83, v65, 1.0, v83 op_sel:[1,0,0] op_sel_hi:[1,0,0]
    v_fma_mix_f32 v84, v66, 1.0, v84 op_sel:[0,0,0] op_sel_hi:[1,0,0]
    v_fma_mix_f32 v85, v66, 1.0, v85 op_sel:[1,0,0] op_sel_hi:[1,0,0]
    v_fma_mix_f32 v86, v67, 1.0, v86 op_sel:[0,0,0] op_sel_hi:[1,0,0]
    v_fma_mix_f32 v87, v67, 1.0, v87 op_sel:[1,0,0] op_sel_hi:[1,0,0]
    v_fma_mix_f32 v80, v68, 1.0, v80 op_sel:[0,0,0] op_sel_hi:[1,0,0]
    v_fma_mix_f32 v81, v68, 1.0, v81 op_sel:[1,0,0] op_sel_hi:[1,0,0]
    v_fma_mix_f32 v82, v69, 1.0, v82 op_sel:[0,0,0] op_sel_hi:[1,0,0]
    v_fma_mix_f32 v83, v69, 1.0, v83 op_sel:[1,0,0] op_sel_hi:[1,0,0]
    v_fma_mix_f32 v84, v70, 1.0, v84 op_sel:[0,0,0] op_sel_hi:[1,0,0]
    v_fma_mix_f32 v85, v70, 1.0, v85 op_sel:[1,0,0] op_sel_hi:[1,0,0]
    v_fma_mix_f32 v86, v71, 1.0, v86 op_sel:[0,0,0] op_sel_hi:[1,0,0]
    v_fma_mix_f32 v87, v71, 1.0, v87 op_sel:[1,0,0] op_sel_hi:[1,0,0]
    buffer_load_dwordx4 v[108:111], v6, s[52:55], s65 offen sc0 sc1
    buffer_load_dwordx4 v[112:115], v6, s[52:55], s68 offen sc0 sc1
    v_add_f32 v72, v72, v80
    v_add_f32 v73, v73, v81
    v_add_f32 v74, v74, v82
    v_add_f32 v75, v75, v83
    v_add_f32 v76, v76, v84
    v_add_f32 v77, v77, v85
    v_add_f32 v78, v78, v86
    v_add_f32 v79, v79, v87
    v_cvt_pk_bf16_f32 v92, v72, v73
    v_cvt_pk_bf16_f32 v93, v74, v75
    v_cvt_pk_bf16_f32 v94, v76, v77
    v_cvt_pk_bf16_f32 v95, v78, v79
    s_mov_b32 s76, 0
K3P2:
    s_waitcnt vmcnt(0)
    v_pk_max_u16 v40, v108, v109
    v_pk_max_u16 v40, v40, v110
    v_pk_max_u16 v40, v40, v111
    v_pk_max_u16 v40, v40, v112
    v_pk_max_u16 v40, v40, v113
    v_pk_max_u16 v40, v40, v114
    v_pk_max_u16 v40, v40, v115
    v_lshrrev_b32 v41, 16, v40
    v_and_b32 v40, 0xffff, v40
    v_max_u32 v40, v40, v41
    v_cmp_eq_u32 vcc, 0xffff, v40
    s_cbranch_vccz K3G2
    s_add_u32 s76, s76, 1
    s_cmp_ge_u32 s76, 200
    s_cbranch_scc1 K3S2
    s_sleep 20
    buffer_load_dwordx4 v[108:111], v6, s[52:55], s65 offen sc0 sc1
    buffer_load_dwordx4 v[112:115], v6, s[52:55], s68 offen sc0 sc1
    s_branch K3P2
K3G2:
    ds_write_b128 v96, v[108:111] offset:0
    ds_write_b128 v96, v[112:115] offset:5120
    s_waitcnt lgkmcnt(0)
    ds_read_u16 v16, v97 offset:0
    ds_read_u16 v17, v97 offset:80
    ds_read_u16 v18, v97 offset:160
    ds_read_u16 v19, v97 offset:240
    ds_read_u16 v20, v97 offset:640
    ds_read_u16 v21, v97 offset:720
    ds_read_u16 v22, v97 offset:800
    ds_read_u16 v23, v97 offset:880
    ds_read_u16 v24, v97 offset:5120
    ds_read_u16 v25, v97 offset:5200
    ds_read_u16 v26, v97 offset:5280
    ds_read_u16 v27, v97 offset:5360
    ds_read_u16 v28, v97 offset:5760
    ds_read_u16 v29, v97 offset:5840
    ds_read_u16 v30, v97 offset:5920
    ds_read_u16 v31, v97 offset:6000
    s_waitcnt lgkmcnt(0)
    v_lshlrev_b32 v42, 16, v100
    v_and_b32 v43, 0xffff0000, v100
    v_lshlrev_b32 v44, 16, v16
    v_lshlrev_b32 v45, 16, v17
    v_add_f32 v42, v42, v44
    v_add_f32 v43, v43, v45
    v_bfe_u32 v46, v42, 16, 1
    v_add3_u32 v46, v42, v46, s90
    v_and_b32 v42, 0xffff0000, v46
    v_bfe_u32 v47, v43, 16, 1
    v_add3_u32 v47, v43, v47, s90
    v_and_b32 v43, 0xffff0000, v47
    v_lshlrev_b32 v44, 16, v88
    v_and_b32 v45, 0xffff0000, v88
    v_add_f32 v42, v42, v44
    v_add_f32 v43, v43, v45
    v_cvt_pk_bf16_f32 v48, v42, v43
    v_lshlrev_b32 v42, 16, v101
    v_and_b32 v43, 0xffff0000, v101
    v_lshlrev_b32 v44, 16, v18
    v_lshlrev_b32 v45, 16, v19
    v_add_f32 v42, v42, v44
    v_add_f32 v43, v43, v45
    v_bfe_u32 v46, v42, 16, 1
    v_add3_u32 v46, v42, v46, s90
    v_and_b32 v42, 0xffff0000, v46
    v_bfe_u32 v47, v43, 16, 1
    v_add3_u32 v47, v43, v47, s90
    v_and_b32 v43, 0xffff0000, v47
    v_lshlrev_b32 v44, 16, v89
    v_and_b32 v45, 0xffff0000, v89
    v_add_f32 v42, v42, v44
    v_add_f32 v43, v43, v45
    v_cvt_pk_bf16_f32 v49, v42, v43
    v_lshlrev_b32 v42, 16, v102
    v_and_b32 v43, 0xffff0000, v102
    v_lshlrev_b32 v44, 16, v20
    v_lshlrev_b32 v45, 16, v21
    v_add_f32 v42, v42, v44
    v_add_f32 v43, v43, v45
    v_bfe_u32 v46, v42, 16, 1
    v_add3_u32 v46, v42, v46, s90
    v_and_b32 v42, 0xffff0000, v46
    v_bfe_u32 v47, v43, 16, 1
    v_add3_u32 v47, v43, v47, s90
    v_and_b32 v43, 0xffff0000, v47
    v_lshlrev_b32 v44, 16, v90
    v_and_b32 v45, 0xffff0000, v90
    v_add_f32 v42, v42, v44
    v_add_f32 v43, v43, v45
    v_cvt_pk_bf16_f32 v50, v42, v43
    v_lshlrev_b32 v42, 16, v103
    v_and_b32 v43, 0xffff0000, v103
    v_lshlrev_b32 v44, 16, v22
    v_lshlrev_b32 v45, 16, v23
    v_add_f32 v42, v42, v44
    v_add_f32 v43, v43, v45
    v_bfe_u32 v46, v42, 16, 1
    v_add3_u32 v46, v42, v46, s90
    v_and_b32 v42, 0xffff0000, v46
    v_bfe_u32 v47, v43, 16, 1
    v_add3_u32 v47, v43, v47, s90
    v_and_b32 v43, 0xffff0000, v47
    v_lshlrev_b32 v44, 16, v91
    v_and_b32 v45, 0xffff0000, v91
    v_add_f32 v42, v42, v44
    v_add_f32 v43, v43, v45
    v_cvt_pk_bf16_f32 v51, v42, v43
    buffer_store_dwordx2 v[48:49], v4, s[48:51], s64 offen
    buffer_store_dwordx2 v[50:51], v4, s[48:51], s64 offen offset:16
    v_lshlrev_b32 v42, 16, v104
    v_and_b32 v43, 0xffff0000, v104
    v_lshlrev_b32 v44, 16, v24
    v_lshlrev_b32 v45, 16, v25
    v_add_f32 v42, v42, v44
    v_add_f32 v43, v43, v45
    v_bfe_u32 v46, v42, 16, 1
    v_add3_u32 v46, v42, v46, s90
    v_and_b32 v42, 0xffff0000, v46
    v_bfe_u32 v47, v43, 16, 1
    v_add3_u32 v47, v43, v47, s90
    v_and_b32 v43, 0xffff0000, v47
    v_lshlrev_b32 v44, 16, v92
    v_and_b32 v45, 0xffff0000, v92
    v_add_f32 v42, v42, v44
    v_add_f32 v43, v43, v45
    v_cvt_pk_bf16_f32 v52, v42, v43
    v_lshlrev_b32 v42, 16, v105
    v_and_b32 v43, 0xffff0000, v105
    v_lshlrev_b32 v44, 16, v26
    v_lshlrev_b32 v45, 16, v27
    v_add_f32 v42, v42, v44
    v_add_f32 v43, v43, v45
    v_bfe_u32 v46, v42, 16, 1
    v_add3_u32 v46, v42, v46, s90
    v_and_b32 v42, 0xffff0000, v46
    v_bfe_u32 v47, v43, 16, 1
    v_add3_u32 v47, v43, v47, s90
    v_and_b32 v43, 0xffff0000, v47
    v_lshlrev_b32 v44, 16, v93
    v_and_b32 v45, 0xffff0000, v93
    v_add_f32 v42, v42, v44
    v_add_f32 v43, v43, v45
    v_cvt_pk_bf16_f32 v53, v42, v43
    v_lshlrev_b32 v42, 16, v106
    v_and_b32 v43, 0xffff0000, v106
    v_lshlrev_b32 v44, 16, v28
    v_lshlrev_b32 v45, 16, v29
    v_add_f32 v42, v42, v44
    v_add_f32 v43, v43, v45
    v_bfe_u32 v46, v42, 16, 1
    v_add3_u32 v46, v42, v46, s90
    v_and_b32 v42, 0xffff0000, v46
    v_bfe_u32 v47, v43, 16, 1
    v_add3_u32 v47, v43, v47, s90
    v_and_b32 v43, 0xffff0000, v47
    v_lshlrev_b32 v44, 16, v94
    v_and_b32 v45, 0xffff0000, v94
    v_add_f32 v42, v42, v44
    v_add_f32 v43, v43, v45
    v_cvt_pk_bf16_f32 v54, v42, v43
    v_lshlrev_b32 v42, 16, v107
    v_and_b32 v43, 0xffff0000, v107
    v_lshlrev_b32 v44, 16, v30
    v_lshlrev_b32 v45, 16, v31
    v_add_f32 v42, v42, v44
    v_add_f32 v43, v43, v45
    v_bfe_u32 v46, v42, 16, 1
    v_add3_u32 v46, v42, v46, s90
    v_and_b32 v42, 0xffff0000, v46
    v_bfe_u32 v47, v43, 16, 1
    v_add3_u32 v47, v43, v47, s90
    v_and_b32 v43, 0xffff0000, v47
    v_lshlrev_b32 v44, 16, v95
    v_and_b32 v45, 0xffff0000, v95
    v_add_f32 v42, v42, v44
    v_add_f32 v43, v43, v45
    v_cvt_pk_bf16_f32 v55, v42, v43
    buffer_store_dwordx2 v[52:53], v4, s[48:51], s67 offen
    buffer_store_dwordx2 v[54:55], v4, s[48:51], s67 offen offset:16
    s_branch K3_END
K3S2:
    buffer_store_dwordx2 v[88:89], v4, s[56:59], s64 offen sc0 sc1
    buffer_store_dwordx2 v[90:91], v4, s[56:59], s64 offen offset:16 sc0 sc1
    v_mov_b32 v41, 0x100
    s_waitcnt vmcnt(0)
    s_mov_b64 exec, 1
    buffer_atomic_add v41, v7, s[52:55], s66 offen sc0 sc1
    s_waitcnt vmcnt(0)
    s_mov_b64 exec, -1
    v_readfirstlane_b32 s70, v41
    s_cmp_lg_u32 s70, 16
    s_cbranch_scc1 K3K20
    s_mov_b32 s79, 0
K3SP20:
    buffer_load_dwordx4 v[108:111], v6, s[52:55], s65 offen sc0 sc1
    s_waitcnt vmcnt(0)
    v_pk_max_u16 v40, v108, v109
    v_pk_max_u16 v40, v40, v110
    v_pk_max_u16 v40, v40, v111
    v_lshrrev_b32 v41, 16, v40
    v_and_b32 v40, 0xffff, v40
    v_max_u32 v40, v40, v41
    v_cmp_eq_u32 vcc, 0xffff, v40
    s_cbranch_vccz K3SG20
    s_sleep 20
    s_add_u32 s79, s79, 1
    s_cmp_lt_u32 s79, 400000
    s_cbranch_scc1 K3SP20
K3SG20:
    ds_write_b128 v96, v[108:111] offset:0
    s_waitcnt lgkmcnt(0)
    ds_read_u16 v16, v97 offset:0
    ds_read_u16 v17, v97 offset:80
    ds_read_u16 v18, v97 offset:160
    ds_read_u16 v19, v97 offset:240
    ds_read_u16 v20, v97 offset:640
    ds_read_u16 v21, v97 offset:720
    ds_read_u16 v22, v97 offset:800
    ds_read_u16 v23, v97 offset:880
    s_waitcnt lgkmcnt(0)
    v_lshlrev_b32 v42, 16, v100
    v_and_b32 v43, 0xffff0000, v100
    v_lshlrev_b32 v44, 16, v16
    v_lshlrev_b32 v45, 16, v17
    v_add_f32 v42, v42, v44
    v_add_f32 v43, v43, v45
    v_bfe_u32 v46, v42, 16, 1
    v_add3_u32 v46, v42, v46, s90
    v_and_b32 v42, 0xffff0000, v46
    v_bfe_u32 v47, v43, 16, 1
    v_add3_u32 v47, v43, v47, s90
    v_and_b32 v43, 0xffff0000, v47
    v_lshlrev_b32 v44, 16, v88
    v_and_b32 v45, 0xffff0000, v88
    v_add_f32 v42, v42, v44
    v_add_f32 v43, v43, v45
    v_cvt_pk_bf16_f32 v48, v42, v43
    v_lshlrev_b32 v42, 16, v101
    v_and_b32 v43, 0xffff0000, v101
    v_lshlrev_b32 v44, 16, v18
    v_lshlrev_b32 v45, 16, v19
    v_add_f32 v42, v42, v44
    v_add_f32 v43, v43, v45
    v_bfe_u32 v46, v42, 16, 1
    v_add3_u32 v46, v42, v46, s90
    v_and_b32 v42, 0xffff0000, v46
    v_bfe_u32 v47, v43, 16, 1
    v_add3_u32 v47, v43, v47, s90
    v_and_b32 v43, 0xffff0000, v47
    v_lshlrev_b32 v44, 16, v89
    v_and_b32 v45, 0xffff0000, v89
    v_add_f32 v42, v42, v44
    v_add_f32 v43, v43, v45
    v_cvt_pk_bf16_f32 v49, v42, v43
    v_lshlrev_b32 v42, 16, v102
    v_and_b32 v43, 0xffff0000, v102
    v_lshlrev_b32 v44, 16, v20
    v_lshlrev_b32 v45, 16, v21
    v_add_f32 v42, v42, v44
    v_add_f32 v43, v43, v45
    v_bfe_u32 v46, v42, 16, 1
    v_add3_u32 v46, v42, v46, s90
    v_and_b32 v42, 0xffff0000, v46
    v_bfe_u32 v47, v43, 16, 1
    v_add3_u32 v47, v43, v47, s90
    v_and_b32 v43, 0xffff0000, v47
    v_lshlrev_b32 v44, 16, v90
    v_and_b32 v45, 0xffff0000, v90
    v_add_f32 v42, v42, v44
    v_add_f32 v43, v43, v45
    v_cvt_pk_bf16_f32 v50, v42, v43
    v_lshlrev_b32 v42, 16, v103
    v_and_b32 v43, 0xffff0000, v103
    v_lshlrev_b32 v44, 16, v22
    v_lshlrev_b32 v45, 16, v23
    v_add_f32 v42, v42, v44
    v_add_f32 v43, v43, v45
    v_bfe_u32 v46, v42, 16, 1
    v_add3_u32 v46, v42, v46, s90
    v_and_b32 v42, 0xffff0000, v46
    v_bfe_u32 v47, v43, 16, 1
    v_add3_u32 v47, v43, v47, s90
    v_and_b32 v43, 0xffff0000, v47
    v_lshlrev_b32 v44, 16, v91
    v_and_b32 v45, 0xffff0000, v91
    v_add_f32 v42, v42, v44
    v_add_f32 v43, v43, v45
    v_cvt_pk_bf16_f32 v51, v42, v43
    buffer_store_dwordx2 v[48:49], v4, s[48:51], s64 offen
    buffer_store_dwordx2 v[50:51], v4, s[48:51], s64 offen offset:16
K3K20:
    buffer_store_dwordx2 v[92:93], v4, s[56:59], s67 offen sc0 sc1
    buffer_store_dwordx2 v[94:95], v4, s[56:59], s67 offen offset:16 sc0 sc1
    v_mov_b32 v41, 0x100
    s_waitcnt vmcnt(0)
    s_mov_b64 exec, 1
    buffer_atomic_add v41, v7, s[52:55], s69 offen sc0 sc1
    s_waitcnt vmcnt(0)
    s_mov_b64 exec, -1
    v_readfirstlane_b32 s70, v41
    s_cmp_lg_u32 s70, 16
    s_cbranch_scc1 K3K21
    s_mov_b32 s79, 0
K3SP21:
    buffer_load_dwordx4 v[112:115], v6, s[52:55], s68 offen sc0 sc1
    s_waitcnt vmcnt(0)
    v_pk_max_u16 v40, v112, v113
    v_pk_max_u16 v40, v40, v114
    v_pk_max_u16 v40, v40, v115
    v_lshrrev_b32 v41, 16, v40
    v_and_b32 v40, 0xffff, v40
    v_max_u32 v40, v40, v41
    v_cmp_eq_u32 vcc, 0xffff, v40
    s_cbranch_vccz K3SG21
    s_sleep 20
    s_add_u32 s79, s79, 1
    s_cmp_lt_u32 s79, 400000
    s_cbranch_scc1 K3SP21
K3SG21:
    ds_write_b128 v96, v[112:115] offset:5120
    s_waitcnt lgkmcnt(0)
    ds_read_u16 v24, v97 offset:5120
    ds_read_u16 v25, v97 offset:5200
    ds_read_u16 v26, v97 offset:5280
    ds_read_u16 v27, v97 offset:5360
    ds_read_u16 v28, v97 offset:5760
    ds_read_u16 v29, v97 offset:5840
    ds_read_u16 v30, v97 offset:5920
    ds_read_u16 v31, v97 offset:6000
    s_waitcnt lgkmcnt(0)
    v_lshlrev_b32 v42, 16, v104
    v_and_b32 v43, 0xffff0000, v104
    v_lshlrev_b32 v44, 16, v24
    v_lshlrev_b32 v45, 16, v25
    v_add_f32 v42, v42, v44
    v_add_f32 v43, v43, v45
    v_bfe_u32 v46, v42, 16, 1
    v_add3_u32 v46, v42, v46, s90
    v_and_b32 v42, 0xffff0000, v46
    v_bfe_u32 v47, v43, 16, 1
    v_add3_u32 v47, v43, v47, s90
    v_and_b32 v43, 0xffff0000, v47
    v_lshlrev_b32 v44, 16, v92
    v_and_b32 v45, 0xffff0000, v92
    v_add_f32 v42, v42, v44
    v_add_f32 v43, v43, v45
    v_cvt_pk_bf16_f32 v48, v42, v43
    v_lshlrev_b32 v42, 16, v105
    v_and_b32 v43, 0xffff0000, v105
    v_lshlrev_b32 v44, 16, v26
    v_lshlrev_b32 v45, 16, v27
    v_add_f32 v42, v42, v44
    v_add_f32 v43, v43, v45
    v_bfe_u32 v46, v42, 16, 1
    v_add3_u32 v46, v42, v46, s90
    v_and_b32 v42, 0xffff0000, v46
    v_bfe_u32 v47, v43, 16, 1
    v_add3_u32 v47, v43, v47, s90
    v_and_b32 v43, 0xffff0000, v47
    v_lshlrev_b32 v44, 16, v93
    v_and_b32 v45, 0xffff0000, v93
    v_add_f32 v42, v42, v44
    v_add_f32 v43, v43, v45
    v_cvt_pk_bf16_f32 v49, v42, v43
    v_lshlrev_b32 v42, 16, v106
    v_and_b32 v43, 0xffff0000, v106
    v_lshlrev_b32 v44, 16, v28
    v_lshlrev_b32 v45, 16, v29
    v_add_f32 v42, v42, v44
    v_add_f32 v43, v43, v45
    v_bfe_u32 v46, v42, 16, 1
    v_add3_u32 v46, v42, v46, s90
    v_and_b32 v42, 0xffff0000, v46
    v_bfe_u32 v47, v43, 16, 1
    v_add3_u32 v47, v43, v47, s90
    v_and_b32 v43, 0xffff0000, v47
    v_lshlrev_b32 v44, 16, v94
    v_and_b32 v45, 0xffff0000, v94
    v_add_f32 v42, v42, v44
    v_add_f32 v43, v43, v45
    v_cvt_pk_bf16_f32 v50, v42, v43
    v_lshlrev_b32 v42, 16, v107
    v_and_b32 v43, 0xffff0000, v107
    v_lshlrev_b32 v44, 16, v30
    v_lshlrev_b32 v45, 16, v31
    v_add_f32 v42, v42, v44
    v_add_f32 v43, v43, v45
    v_bfe_u32 v46, v42, 16, 1
    v_add3_u32 v46, v42, v46, s90
    v_and_b32 v42, 0xffff0000, v46
    v_bfe_u32 v47, v43, 16, 1
    v_add3_u32 v47, v43, v47, s90
    v_and_b32 v43, 0xffff0000, v47
    v_lshlrev_b32 v44, 16, v95
    v_and_b32 v45, 0xffff0000, v95
    v_add_f32 v42, v42, v44
    v_add_f32 v43, v43, v45
    v_cvt_pk_bf16_f32 v51, v42, v43
    buffer_store_dwordx2 v[48:49], v4, s[48:51], s67 offen
    buffer_store_dwordx2 v[50:51], v4, s[48:51], s67 offen offset:16
K3K21:
K3_END:
    s_endpgm
.section .rodata,"a"
.p2align 6
.amdhsa_kernel k1_kernel
  .amdhsa_next_free_vgpr 64
  .amdhsa_next_free_sgpr 102
  .amdhsa_accum_offset 64
  .amdhsa_group_segment_fixed_size 0
  .amdhsa_kernarg_size 128
  .amdhsa_user_sgpr_count 2
  .amdhsa_user_sgpr_kernarg_segment_ptr 1
  .amdhsa_system_sgpr_workgroup_id_x 1
.end_amdhsa_kernel
.p2align 6
.amdhsa_kernel k2f_kernel
  .amdhsa_next_free_vgpr 512
  .amdhsa_next_free_sgpr 102
  .amdhsa_accum_offset 256
  .amdhsa_group_segment_fixed_size 0
  .amdhsa_kernarg_size 128
  .amdhsa_user_sgpr_count 2
  .amdhsa_user_sgpr_kernarg_segment_ptr 1
  .amdhsa_system_sgpr_workgroup_id_x 1
.end_amdhsa_kernel
.p2align 6
.amdhsa_kernel k3c_kernel
  .amdhsa_next_free_vgpr 128
  .amdhsa_next_free_sgpr 102
  .amdhsa_accum_offset 128
  .amdhsa_group_segment_fixed_size 0
  .amdhsa_kernarg_size 128
  .amdhsa_user_sgpr_count 2
  .amdhsa_user_sgpr_kernarg_segment_ptr 1
  .amdhsa_system_sgpr_workgroup_id_x 1
.end_amdhsa_kernel
```
